```python
import torch

def _softmax(x, axis=-1):
    return torch.softmax(x, dim=axis)
def _gelu(x):
    return torch.nn.functional.gelu(x, approximate="tanh")
def _silu(x):
    return torch.nn.functional.silu(x)
def _sigmoid(x):
    return torch.sigmoid(x)
def _layernorm(x, axis=-1, eps=1e-5):
    m = x.mean(dim=axis, keepdim=True)
    v = x.var(dim=axis, keepdim=True, unbiased=False)
    return (x - m) / torch.sqrt(v + eps)
def _scatter_add(tgt, idx, src, axis=0):
    return tgt.clone().index_add_(axis, idx, src)
def _segment_sum(src, seg, n):
    out = torch.zeros((n,) + src.shape[1:], dtype=src.dtype)
    return out.index_add_(0, seg, src)
def _pad(x, pw):
    flat = tuple(v for pair in reversed(pw) for v in pair)
    return torch.nn.functional.pad(x, flat)

kernel_name = 'concat_heads__mha_block_cached__gqa_block_cached__near_ridge'

def setup_inputs():

    _w = (lambda a: (lambda t: t.to(torch.bfloat16) if t.is_floating_point() else t)(torch.as_tensor(a)))
    def _A_setup():
        B, Sq, D = 8, 192, 448
        H, Sk, Dh = 16, 512, 256
        return {
            "x": _w((lambda *s: torch.randn(*s, dtype=torch.bfloat16) * 0.8)(B, Sq, D)),
            "k_cache": _w((lambda *s: torch.randn(*s, dtype=torch.bfloat16) * 0.8)(B, H, Sk, Dh)),
            "v_cache": _w((lambda *s: torch.randn(*s, dtype=torch.bfloat16) * 0.05)(B, H, Sk, Dh)),
            "wq": _w((lambda *s: torch.randn(*s, dtype=torch.bfloat16) * 0.8)(D, H * Dh) * (D ** -0.5)),
            "wo": _w((lambda *s: torch.randn(*s, dtype=torch.bfloat16) * 0.05)(H * Dh, D) * ((H * Dh) ** -0.5)),
        }
    _A_in = _A_setup()

    def _B_setup():
        B, Sq, D = 8, 192, 448
        Hq, Hkv, Sk, Dh = 16, 16, 512, 256
        assert Hq % Hkv == 0, (Hq, Hkv)
        return {
            "x": _w((lambda *s: torch.randn(*s, dtype=torch.bfloat16) * 0.8)(B, Sq, D)),
            "k_cache": _w((lambda *s: torch.randn(*s, dtype=torch.bfloat16) * 0.8)(B, Hkv, Sk, Dh)),
            "v_cache": _w((lambda *s: torch.randn(*s, dtype=torch.bfloat16) * 0.05)(B, Hkv, Sk, Dh)),
            "wq": _w((lambda *s: torch.randn(*s, dtype=torch.bfloat16) * 0.8)(D, Hq * Dh) * (D ** -0.5)),
            "wo": _w((lambda *s: torch.randn(*s, dtype=torch.bfloat16) * 0.05)(Hq * Dh, D) * ((Hq * Dh) ** -0.5)),
        }
    _B_in = _B_setup()

    return {
        "A_x": _A_in["x"],
        "A_k_cache": _A_in["k_cache"],
        "A_v_cache": _A_in["v_cache"],
        "A_wq": _A_in["wq"],
        "A_wo": _A_in["wo"],
        "B_x": _B_in["x"],
        "B_k_cache": _B_in["k_cache"],
        "B_v_cache": _B_in["v_cache"],
        "B_wq": _B_in["wq"],
        "B_wo": _B_in["wo"],
    }

def reference(A_x, A_k_cache, A_v_cache, A_wq, A_wo, B_x, B_k_cache, B_v_cache, B_wq, B_wo):
    def _A_ref(x, k_cache, v_cache, wq, wo):
        B, Sq, D = x.shape
        H, Dh = 16, 256
        q = (lambda x, *d: x.permute(*d))((x @ wq).reshape(B, Sq, H, Dh), 0, 2, 1, 3)
        scores = torch.einsum("bhqd,bhkd->bhqk", q, k_cache) * (Dh ** -0.5)
        p = _softmax(scores, axis=-1)
        o = torch.einsum("bhqk,bhkd->bhqd", p, v_cache)
        return (lambda x, *d: x.permute(*d))(o, 0, 2, 1, 3).reshape(B, Sq, H * Dh) @ wo

    def _B_ref(x, k_cache, v_cache, wq, wo):
        B, Sq, D = x.shape
        Hq, Dh = 16, 256
        Hkv = k_cache.shape[1]
        rep = Hq // Hkv
        q = (lambda x, *d: x.permute(*d))((x @ wq).reshape(B, Sq, Hq, Dh), 0, 2, 1, 3)
        k = (lambda x, n, axis: torch.repeat_interleave(x, n, dim=axis))(k_cache, rep, axis=1)
        v = (lambda x, n, axis: torch.repeat_interleave(x, n, dim=axis))(v_cache, rep, axis=1)
        scores = torch.einsum("bhqd,bhkd->bhqk", q, k) * (Dh ** -0.5)
        p = _softmax(scores, axis=-1)
        o = torch.einsum("bhqk,bhkd->bhqd", p, v)
        return (lambda x, *d: x.permute(*d))(o, 0, 2, 1, 3).reshape(B, Sq, Hq * Dh) @ wo

    a = _A_ref(A_x, A_k_cache, A_v_cache, A_wq, A_wo)
    b = _B_ref(B_x, B_k_cache, B_v_cache, B_wq, B_wo)
    return torch.concatenate([a, b], axis=-1)
```

```asm
; @launch grid=(256,1,1) block=(256,1,1) lds=163840
.amdgcn_target "amdgcn-amd-amdhsa--gfx950"
.text
.globl concat_heads__mha_block_cached__gqa_block_cached__near_ridge_kernel
.p2align 8
.type concat_heads__mha_block_cached__gqa_block_cached__near_ridge_kernel,@function
concat_heads__mha_block_cached__gqa_block_cached__near_ridge_kernel:
    s_cmp_ge_u32 s2, 256
    s_cbranch_scc1 L_end
    s_load_dwordx16 s[36:51], s[0:1], 0
    s_load_dwordx4 s[52:55], s[0:1], 64
    s_load_dwordx2 s[56:57], s[0:1], 96
    s_load_dwordx2 s[86:87], s[0:1], 80
    s_load_dwordx2 s[88:89], s[0:1], 88
    v_lshrrev_b32 v64, 6, v0
    v_and_b32 v0, 63, v0
    v_readfirstlane_b32 s58, v64
    s_getpc_b64 s[92:93]
L_code_ref:
    s_lshr_b32 s96, s2, 3
    s_lshl_b32 s96, s96, 2
    s_add_u32 s96, s96, s58
    s_lshl_b32 s96, s96, 6
    s_min_u32 s95, s96, L_code_end-L_code_ref
    s_load_dword s97, s[92:93], s95
    s_add_u32 s96, s96, 8192
    s_and_b32 s59, s2, 3
    s_lshl_b32 s59, s59, 2
    s_bfe_u32 s63, s2, 131075
    s_add_u32 s59, s59, s63
    s_lshr_b32 s60, s2, 5
    s_bfe_u32 s61, s2, 65538
    s_lshl_b32 s28, s58, 12
    s_add_u32 s33, s63, s60
    s_mul_i32 s3, s33, 11
    s_lshr_b32 s3, s3, 5
    s_mul_i32 s3, s3, 3
    s_sub_u32 s33, s33, s3
    s_lshl_b32 s33, s33, 7
    s_and_b32 s3, s60, 6
    s_lshl_b32 s3, s3, 6
    v_lshrrev_b32 v70, 5, v0
    v_bfe_u32 v71, v0, 1, 4
    v_and_b32 v72, 1, v0
    v_xor_b32 v71, v71, v70
    v_lshlrev_b32 v71, 5, v71
    v_lshl_add_u32 v65, v72, 4, v71
    v_xor_b32 v65, s3, v65
    s_and_b32 s30, s58, 1
    s_lshl_b32 s30, s30, 4
    v_xor_b32 v65, s30, v65
    v_xor_b32 v66, 64, v65
    v_xor_b32 v67, 128, v65
    v_xor_b32 v68, 192, v65
    s_and_b32 s30, s58, 1
    s_lshl_b32 s30, s30, 4
    s_lshr_b32 s31, s58, 1
    s_lshl_b32 s31, s31, 2
    s_add_u32 s30, s30, s31
    v_add_u32 v73, s30, v70
    v_lshlrev_b32 v73, 13, v73
    v_bfe_u32 v69, v0, 4, 1
    v_lshl_add_u32 v73, v69, 18, v73
    s_and_b32 s64, s3, 256
    s_xor_b32 s65, s64, 256
    v_and_b32 v53, 255, v65
    v_add_u32 v53, v73, v53
    v_and_b32 v54, 255, v66
    v_add_u32 v54, v73, v54
    v_add_u32 v54, 15360, v54
    v_and_b32 v55, 255, v67
    v_add_u32 v55, v73, v55
    v_add_u32 v55, 63488, v55
    v_and_b32 v56, 255, v68
    v_add_u32 v56, v73, v56
    v_add_u32 v56, 78848, v56
    s_mul_i32 s30, s58, 48
    s_mul_i32 s32, s58, 6144
    v_and_b32 v74, 15, v0
    v_lshrrev_b32 v76, 4, v0
    v_lshrrev_b32 v78, 3, v0
    v_add_u32 v75, s30, v78
    v_mul_u32_u24 v75, 896, v75
    v_and_b32 v77, 7, v0
    v_xor_b32 v77, v77, v76
    v_lshl_add_u32 v58, v77, 4, v75
    v_xor_b32 v59, 64, v58
    s_mov_b32 s7, 0x20000
    s_mov_b32 s11, 0x20000
    s_mov_b32 s15, 0x20000
    s_mov_b32 s19, 0x20000
    s_mov_b32 s23, 0x20000
    s_mov_b32 s27, 0x20000
    s_mov_b32 s6, 172032
    s_mov_b32 s14, 262144
    s_mov_b32 s18, 262144
    s_mul_i32 s22, s63, 224
    s_lshl_b32 s30, s59, 9
    s_sub_u32 s10, 3670016, s30
    s_mul_i32 s31, s60, 172032
    s_waitcnt lgkmcnt(0)
    s_cmp_eq_u32 s61, 0
    s_cselect_b64 s[4:5], s[36:37], s[46:47]
    s_cselect_b64 s[8:9], s[42:43], s[52:53]
    s_cselect_b64 s[12:13], s[38:39], s[48:49]
    s_cselect_b64 s[16:17], s[40:41], s[50:51]
    s_cselect_b64 s[20:21], s[44:45], s[54:55]
    s_add_u32 s8, s8, s30
    s_addc_u32 s9, s9, 0
    s_add_u32 s4, s4, s31
    s_addc_u32 s5, s5, 0
    s_add_u32 m0, s28, 0
    s_lshl_b32 s29, s33, 12
    s_add_u32 s29, s29, s64
    buffer_load_dwordx4 v53, s[8:11], s29 offen lds
    buffer_load_dwordx4 v54, s[8:11], s29 offen offset:1024 lds
    buffer_load_dwordx4 v55, s[8:11], s29 offen offset:2048 lds
    buffer_load_dwordx4 v56, s[8:11], s29 offen offset:3072 lds
    s_add_u32 m0, s32, 139264
    s_add_u32 s29, s33, 0
    buffer_load_dwordx4 v58, s[4:7], s29 offen lds
    s_add_u32 s29, s33, 6144
    buffer_load_dwordx4 v59, s[4:7], s29 offen offset:1024 lds
    s_add_u32 s29, s33, 12288
    buffer_load_dwordx4 v58, s[4:7], s29 offen offset:2048 lds
    s_add_u32 s29, s33, 18432
    buffer_load_dwordx4 v59, s[4:7], s29 offen offset:3072 lds
    s_add_u32 m0, s32, 143360
    s_add_u32 s29, s33, 28672
    buffer_load_dwordx4 v58, s[4:7], s29 offen lds
    s_add_u32 s29, s33, 34816
    buffer_load_dwordx4 v59, s[4:7], s29 offen offset:1024 lds
    s_add_u32 m0, s28, 16384
    s_lshl_b32 s29, s33, 12
    s_add_u32 s29, s29, s65
    buffer_load_dwordx4 v53, s[8:11], s29 offen lds
    buffer_load_dwordx4 v54, s[8:11], s29 offen offset:1024 lds
    buffer_load_dwordx4 v55, s[8:11], s29 offen offset:2048 lds
    buffer_load_dwordx4 v56, s[8:11], s29 offen offset:3072 lds
    s_mov_b32 s48, s3
    s_lshl_b32 s30, s60, 4
    s_add_u32 s30, s30, s59
    s_lshl_b32 s30, s30, 18
    s_add_u32 s12, s12, s30
    s_addc_u32 s13, s13, 0
    s_add_u32 s16, s16, s30
    s_addc_u32 s17, s17, 0
    s_lshr_b32 s30, s59, 2
    s_mul_i32 s30, s30, 917504
    s_add_u32 s30, s30, s22
    s_add_u32 s20, s20, s30
    s_addc_u32 s21, s21, 0
    s_sub_u32 s22, 917504, s22
    s_lshl_b32 s85, s61, 3
    s_add_u32 s85, s85, s60
    s_mul_i32 s30, s85, 4456448
    s_add_u32 s24, s56, s30
    s_addc_u32 s25, s57, 0
    s_mov_b32 s26, 4456448
    s_lshl_b32 s30, s60, 15
    s_add_u32 s30, s30, 100663296
    s_add_u32 s36, s56, s30
    s_addc_u32 s37, s57, 0
    s_mov_b32 s38, 32768
    s_mov_b32 s39, 0x20000
    s_mov_b64 s[40:41], s[88:89]
    s_mov_b32 s42, 256
    s_mov_b32 s43, 0x20000
    s_mov_b64 s[44:45], s[86:87]
    s_mov_b32 s46, 2752512
    s_mov_b32 s47, 0x20000
    s_lshl_b32 s85, s60, 5
    s_mov_b32 s34, 0x3db8aa3b
    s_mov_b32 s35, 0x4b800000
    s_add_u32 s53, s33, 128
    s_sub_u32 s30, s53, 384
    s_min_u32 s53, s53, s30
    s_add_u32 s54, s33, 256
    s_sub_u32 s30, s54, 384
    s_min_u32 s54, s54, s30
    s_lshl_b32 s31, s60, 1
    s_add_u32 s31, s31, s63
    s_add_u32 s30, s31, 0
    s_and_b32 s30, s30, 3
    s_lshl_b32 s30, s30, 7
    s_add_u32 s55, s30, 384
    s_add_u32 s30, s31, 1
    s_and_b32 s30, s30, 3
    s_lshl_b32 s30, s30, 7
    s_add_u32 s62, s30, 384
    s_add_u32 s30, s31, 2
    s_and_b32 s30, s30, 3
    s_lshl_b32 s30, s30, 7
    s_add_u32 s86, s30, 384
    s_add_u32 s30, s31, 3
    s_and_b32 s30, s30, 3
    s_lshl_b32 s30, s30, 7
    s_add_u32 s87, s30, 384
    s_and_b32 s31, s58, 1
    s_lshl_b32 s31, s31, 18
    s_add_u32 s31, s31, s48
    s_cmp_lt_u32 s58, 2
    s_cselect_b32 s30, s55, s62
    s_lshl_b32 s30, s30, 12
    s_add_u32 s96, s30, s31
    s_cmp_lt_u32 s58, 2
    s_cselect_b32 s30, s86, s87
    s_lshl_b32 s30, s30, 12
    s_add_u32 s97, s30, s31
    s_xor_b32 s88, s63, 0
    s_mul_i32 s88, s88, 229376
    s_xor_b32 s93, s48, 0
    s_mul_i32 s93, s93, 448
    s_xor_b32 s89, s63, 1
    s_mul_i32 s89, s89, 229376
    s_xor_b32 s94, s48, 128
    s_mul_i32 s94, s94, 448
    s_xor_b32 s90, s63, 2
    s_mul_i32 s90, s90, 229376
    s_xor_b32 s95, s48, 256
    s_mul_i32 s95, s95, 448
    s_xor_b32 s92, s63, 3
    s_mul_i32 s92, s92, 229376
    s_xor_b32 s0, s48, 384
    s_mul_i32 s0, s0, 448
    s_lshr_b32 s30, s59, 2
    s_lshl_b32 s31, s58, 4
    s_mul_i32 s50, s30, 48
    s_add_u32 s50, s50, s31
    s_mul_i32 s52, s60, 192
    s_add_u32 s50, s50, s52
    s_mul_i32 s50, s50, 1792
    s_mul_i32 s52, s61, 896
    s_add_u32 s50, s50, s52
    s_mul_i32 s52, s63, 224
    s_add_u32 s50, s50, s52
    s_lshl_b32 s31, s58, 7
    s_lshl_b32 s1, s30, 12
    s_add_u32 s1, s1, s31
    s_lshl_b32 s52, s63, 2
    s_add_u32 s1, s1, s52
    s_lshl_b32 s48, s59, 10
    s_add_u32 s48, s48, s31
    s_lshl_b32 s49, s58, 2
    s_add_u32 s49, s49, s63
    s_lshl_b32 s49, s49, 10
    s_lshl_b32 s52, s30, 2
    s_add_u32 s49, s49, s52
    s_add_u32 s49, s49, 512
    s_mov_b32 s51, 16256
    s_lshl_b32 s52, s61, 14
    s_add_u32 s1, s1, s52
    s_add_u32 s48, s48, s52
    s_add_u32 s49, s49, s52
    s_mov_b32 s91, 0
    v_lshrrev_b32 v75, 1, v74
    v_xor_b32 v75, v75, v76
    v_lshlrev_b32 v75, 4, v75
    v_lshl_add_u32 v75, v74, 7, v75
    s_add_u32 s52, s32, 90112
    v_add_u32 v60, s52, v75
    v_xor_b32 v61, 64, v60
    s_and_b32 s52, s58, 1
    s_lshl_b32 s52, s52, 15
    s_lshr_b32 s30, s58, 1
    s_lshl_b32 s30, s30, 16
    s_add_u32 s52, s52, s30
    v_lshl_add_u32 v73, v70, 9, s52
    v_add_u32 v49, v73, v65
    v_add_u32 v50, v73, v66
    v_add_u32 v50, 7168, v50
    v_add_u32 v51, v73, v67
    v_add_u32 v51, 14336, v51
    v_add_u32 v52, v73, v68
    v_add_u32 v52, 21504, v52
    s_mul_i32 s30, s2, 9
    s_lshr_b32 s30, s30, 3
    s_mov_b32 s61, 0
    s_bfe_u32 s52, s30, 65536
    s_lshl_b32 s52, s52, 10
    s_add_u32 s61, s61, s52
    s_bfe_u32 s52, s30, 65537
    s_lshl_b32 s52, s52, 11
    s_add_u32 s61, s61, s52
    s_bfe_u32 s52, s30, 65538
    s_lshl_b32 s52, s52, 12
    s_add_u32 s61, s61, s52
    s_bfe_u32 s52, s30, 65539
    s_lshl_b32 s52, s52, 17
    s_add_u32 s61, s61, s52
    v_bfe_u32 v79, v0, 1, 2
    v_xor_b32 v79, v79, v76
    v_lshlrev_b32 v79, 5, v79
    v_lshl_add_u32 v79, v72, 4, v79
    s_lshl_b32 s52, s58, 3
    v_and_b32 v80, 1, v76
    v_lshl_add_u32 v80, v80, 5, v70
    v_add_u32 v80, s52, v80
    v_mul_u32_u24 v63, 896, v80
    v_bfe_u32 v80, v0, 1, 3
    v_xor_b32 v80, v80, v70
    v_lshlrev_b32 v80, 5, v80
    v_lshl_add_u32 v57, v72, 4, v80
    s_and_b32 s52, s58, 1
    s_lshl_b32 s52, s52, 4
    v_xor_b32 v57, s52, v57
    v_and_b32 v80, 3, v78
    v_lshl_add_u32 v80, v70, 3, v80
    v_lshl_add_u32 v62, v80, 13, v79
    v_lshrrev_b32 v70, 2, v0
    v_and_b32 v71, 7, v70
    v_and_b32 v72, 3, v0
    v_lshlrev_b32 v72, 3, v72
    v_lshl_add_u32 v73, v70, 9, v72
    v_lshl_add_u32 v1, v71, 5, v73
    v_lshrrev_b32 v71, 5, v0
    v_lshlrev_b32 v71, 4, v71
    v_xor_b32 v1, v71, v1
    v_xor_b32 v2, 32, v1
    v_xor_b32 v3, 64, v1
    v_xor_b32 v4, 96, v1
    v_xor_b32 v5, 128, v1
    v_xor_b32 v6, 160, v1
    v_xor_b32 v7, 192, v1
    v_xor_b32 v8, 224, v1
    v_xor_b32 v9, 65536, v1
    v_xor_b32 v10, 65568, v1
    v_xor_b32 v11, 65600, v1
    v_xor_b32 v12, 65632, v1
    v_xor_b32 v13, 65664, v1
    v_xor_b32 v14, 65696, v1
    v_xor_b32 v15, 65728, v1
    v_xor_b32 v16, 65760, v1
    v_xor_b32 v17, 131072, v1
    v_xor_b32 v18, 131104, v1
    v_xor_b32 v19, 131136, v1
    v_xor_b32 v20, 131168, v1
    v_xor_b32 v21, 131200, v1
    v_xor_b32 v22, 131232, v1
    v_xor_b32 v23, 131264, v1
    v_xor_b32 v24, 131296, v1
    v_lshl_add_u32 v73, v70, 7, v72
    v_bfe_u32 v71, v0, 3, 2
    v_lshl_add_u32 v37, v71, 5, v73
    v_xor_b32 v38, 32, v37
    v_xor_b32 v39, 64, v37
    v_xor_b32 v40, 96, v37
    v_xor_b32 v41, 65536, v37
    v_xor_b32 v42, 65568, v37
    v_xor_b32 v43, 65600, v37
    v_xor_b32 v44, 65632, v37
    v_xor_b32 v45, 131072, v37
    v_xor_b32 v46, 131104, v37
    v_xor_b32 v47, 131136, v37
    v_xor_b32 v48, 131168, v37
    v_and_b32 v70, 7, v0
    v_bfe_u32 v71, v0, 4, 1
    v_xor_b32 v70, v70, v71
    v_lshlrev_b32 v70, 5, v70
    v_lshl_add_u32 v70, v74, 9, v70
    v_lshrrev_b32 v71, 5, v0
    v_bfe_u32 v72, v0, 3, 1
    v_xor_b32 v71, v71, v72
    v_lshl_add_u32 v25, v71, 4, v70
    v_xor_b32 v26, 64, v25
    v_xor_b32 v27, 128, v25
    v_xor_b32 v28, 192, v25
    v_xor_b32 v29, 65536, v25
    v_xor_b32 v30, 65600, v25
    v_xor_b32 v31, 65664, v25
    v_xor_b32 v32, 65728, v25
    v_xor_b32 v33, 131072, v25
    v_xor_b32 v34, 131136, v25
    v_xor_b32 v35, 131200, v25
    v_xor_b32 v36, 131264, v25
    s_lshr_b32 s30, s2, 3
    s_lshl_b32 s30, s30, 2
    s_add_u32 s30, s30, s58
    s_mul_i32 s30, s30, 7168
    s_mul_i32 s31, s63, 224
    s_sub_u32 s30, s30, s31
    v_min_u32 v0, 27, v0
    v_lshlrev_b32 v0, 7, v0
    s_add_u32 s3, s30, 0
    buffer_load_dword a255, v0, s[20:23], s3 offen
    s_waitcnt vmcnt(5)
    ds_read_b128 a[0:3], v60 offset:49152
    ds_read_b128 a[4:7], v60 offset:51200
    ds_read_b128 a[8:11], v60 offset:53248
    ds_read_b128 a[12:15], v61 offset:49152
    ds_read_b128 a[16:19], v61 offset:51200
    ds_read_b128 a[20:23], v61 offset:53248
    s_barrier
    ds_read_b64_tr_b16 a[192:193], v1 offset:0
    ds_read_b64_tr_b16 a[194:195], v1 offset:8192
    ds_read_b64_tr_b16 a[196:197], v1 offset:256
    ds_read_b64_tr_b16 a[198:199], v1 offset:8448
    ds_read_b64_tr_b16 a[200:201], v2 offset:0
    ds_read_b64_tr_b16 a[202:203], v2 offset:8192
    ds_read_b64_tr_b16 a[204:205], v2 offset:256
    ds_read_b64_tr_b16 a[206:207], v2 offset:8448
    s_waitcnt lgkmcnt(4)
    v_mfma_f32_16x16x32_bf16 v[64:67], a[192:195], a[0:3], 0
    s_add_u32 m0, s32, 114688
    ds_read_b64_tr_b16 a[208:209], v3 offset:0
    v_mfma_f32_16x16x32_bf16 v[64:67], a[196:199], a[12:15], v[64:67]
    s_add_u32 s29, s53, 0
    ds_read_b64_tr_b16 a[210:211], v3 offset:8192
    buffer_load_dwordx4 v58, s[4:7], s29 offen lds
    v_mfma_f32_16x16x32_bf16 v[128:131], a[196:199], a[16:19], 0
    v_mfma_f32_16x16x32_bf16 v[128:131], a[192:195], a[4:7], v[128:131]
    s_add_u32 s29, s53, 6144
    ds_read_b64_tr_b16 a[212:213], v3 offset:256
    buffer_load_dwordx4 v59, s[4:7], s29 offen offset:1024 lds
    v_mfma_f32_16x16x32_bf16 v[192:195], a[192:195], a[8:11], 0
    ds_read_b64_tr_b16 a[214:215], v3 offset:8448
    v_mfma_f32_16x16x32_bf16 v[192:195], a[196:199], a[20:23], v[192:195]
    s_waitcnt lgkmcnt(4)
    s_add_u32 s29, s53, 12288
    buffer_load_dwordx4 v58, s[4:7], s29 offen offset:2048 lds
    v_mfma_f32_16x16x32_bf16 v[196:199], a[200:203], a[8:11], 0
    ds_read_b64_tr_b16 a[216:217], v4 offset:0
    v_mfma_f32_16x16x32_bf16 v[196:199], a[204:207], a[20:23], v[196:199]
    s_add_u32 s29, s53, 18432
    ds_read_b64_tr_b16 a[218:219], v4 offset:8192
    buffer_load_dwordx4 v59, s[4:7], s29 offen offset:3072 lds
    v_mfma_f32_16x16x32_bf16 v[132:135], a[204:207], a[16:19], 0
    s_add_u32 m0, s32, 118784
    v_mfma_f32_16x16x32_bf16 v[132:135], a[200:203], a[4:7], v[132:135]
    s_add_u32 s29, s53, 28672
    ds_read_b64_tr_b16 a[220:221], v4 offset:256
    buffer_load_dwordx4 v58, s[4:7], s29 offen lds
    v_mfma_f32_16x16x32_bf16 v[68:71], a[200:203], a[0:3], 0
    ds_read_b64_tr_b16 a[222:223], v4 offset:8448
    v_mfma_f32_16x16x32_bf16 v[68:71], a[204:207], a[12:15], v[68:71]
    s_waitcnt lgkmcnt(4)
    s_add_u32 s29, s53, 34816
    buffer_load_dwordx4 v59, s[4:7], s29 offen offset:1024 lds
    v_mfma_f32_16x16x32_bf16 v[72:75], a[208:211], a[0:3], 0
    s_add_u32 m0, s28, 32768
    s_lshl_b32 s29, s53, 12
    ds_read_b64_tr_b16 a[224:225], v5 offset:0
    v_mfma_f32_16x16x32_bf16 v[72:75], a[212:215], a[12:15], v[72:75]
    s_add_u32 s29, s29, s64
    ds_read_b64_tr_b16 a[226:227], v5 offset:8192
    buffer_load_dwordx4 v53, s[8:11], s29 offen lds
    v_mfma_f32_16x16x32_bf16 v[136:139], a[212:215], a[16:19], 0
    v_mfma_f32_16x16x32_bf16 v[136:139], a[208:211], a[4:7], v[136:139]
    ds_read_b64_tr_b16 a[228:229], v5 offset:256
    buffer_load_dwordx4 v54, s[8:11], s29 offen offset:1024 lds
    v_mfma_f32_16x16x32_bf16 v[200:203], a[208:211], a[8:11], 0
    ds_read_b64_tr_b16 a[230:231], v5 offset:8448
    v_mfma_f32_16x16x32_bf16 v[200:203], a[212:215], a[20:23], v[200:203]
    s_waitcnt lgkmcnt(4)
    buffer_load_dwordx4 v55, s[8:11], s29 offen offset:2048 lds
    v_mfma_f32_16x16x32_bf16 v[204:207], a[216:219], a[8:11], 0
    ds_read_b64_tr_b16 a[232:233], v6 offset:0
    v_mfma_f32_16x16x32_bf16 v[204:207], a[220:223], a[20:23], v[204:207]
    ds_read_b64_tr_b16 a[234:235], v6 offset:8192
    buffer_load_dwordx4 v56, s[8:11], s29 offen offset:3072 lds
    v_mfma_f32_16x16x32_bf16 v[140:143], a[220:223], a[16:19], 0
    s_add_u32 m0, s28, 49152
    s_lshl_b32 s29, s53, 12
    v_mfma_f32_16x16x32_bf16 v[140:143], a[216:219], a[4:7], v[140:143]
    s_add_u32 s29, s29, s65
    ds_read_b64_tr_b16 a[236:237], v6 offset:256
    buffer_load_dwordx4 v53, s[8:11], s29 offen lds
    v_mfma_f32_16x16x32_bf16 v[76:79], a[216:219], a[0:3], 0
    ds_read_b64_tr_b16 a[238:239], v6 offset:8448
    v_mfma_f32_16x16x32_bf16 v[76:79], a[220:223], a[12:15], v[76:79]
    s_waitcnt lgkmcnt(4)
    buffer_load_dwordx4 v54, s[8:11], s29 offen offset:1024 lds
    v_mfma_f32_16x16x32_bf16 v[80:83], a[224:227], a[0:3], 0
    ds_read_b64_tr_b16 a[192:193], v7 offset:0
    v_mfma_f32_16x16x32_bf16 v[80:83], a[228:231], a[12:15], v[80:83]
    ds_read_b64_tr_b16 a[194:195], v7 offset:8192
    buffer_load_dwordx4 v55, s[8:11], s29 offen offset:2048 lds
    v_mfma_f32_16x16x32_bf16 v[144:147], a[228:231], a[16:19], 0
    v_mfma_f32_16x16x32_bf16 v[144:147], a[224:227], a[4:7], v[144:147]
    ds_read_b64_tr_b16 a[196:197], v7 offset:256
    buffer_load_dwordx4 v56, s[8:11], s29 offen offset:3072 lds
    v_mfma_f32_16x16x32_bf16 v[208:211], a[224:227], a[8:11], 0
    s_add_u32 m0, s32, 90112
    ds_read_b64_tr_b16 a[198:199], v7 offset:8448
    v_mfma_f32_16x16x32_bf16 v[208:211], a[228:231], a[20:23], v[208:211]
    s_waitcnt lgkmcnt(4)
    s_add_u32 s29, s54, 0
    buffer_load_dwordx4 v58, s[4:7], s29 offen lds
    v_mfma_f32_16x16x32_bf16 v[212:215], a[232:235], a[8:11], 0
    ds_read_b64_tr_b16 a[200:201], v8 offset:0
    v_mfma_f32_16x16x32_bf16 v[212:215], a[236:239], a[20:23], v[212:215]
    s_add_u32 s29, s54, 6144
    ds_read_b64_tr_b16 a[202:203], v8 offset:8192
    buffer_load_dwordx4 v59, s[4:7], s29 offen offset:1024 lds
    v_mfma_f32_16x16x32_bf16 v[148:151], a[236:239], a[16:19], 0
    v_mfma_f32_16x16x32_bf16 v[148:151], a[232:235], a[4:7], v[148:151]
    s_add_u32 s29, s54, 12288
    ds_read_b64_tr_b16 a[204:205], v8 offset:256
    buffer_load_dwordx4 v58, s[4:7], s29 offen offset:2048 lds
    v_mfma_f32_16x16x32_bf16 v[84:87], a[232:235], a[0:3], 0
    ds_read_b64_tr_b16 a[206:207], v8 offset:8448
    v_mfma_f32_16x16x32_bf16 v[84:87], a[236:239], a[12:15], v[84:87]
    s_waitcnt lgkmcnt(4)
    s_waitcnt vmcnt(18)
    s_add_u32 s29, s54, 18432
    buffer_load_dwordx4 v59, s[4:7], s29 offen offset:3072 lds
    s_barrier
    v_mfma_f32_16x16x32_bf16 v[88:91], a[192:195], a[0:3], 0
    s_add_u32 m0, s32, 94208
    ds_read_b64_tr_b16 a[208:209], v1 offset:16384
    v_mfma_f32_16x16x32_bf16 v[88:91], a[196:199], a[12:15], v[88:91]
    s_add_u32 s29, s54, 28672
    ds_read_b64_tr_b16 a[210:211], v1 offset:24576
    buffer_load_dwordx4 v58, s[4:7], s29 offen lds
    v_mfma_f32_16x16x32_bf16 v[152:155], a[196:199], a[16:19], 0
    v_mfma_f32_16x16x32_bf16 v[152:155], a[192:195], a[4:7], v[152:155]
    s_add_u32 s29, s54, 34816
    ds_read_b64_tr_b16 a[212:213], v1 offset:16640
    buffer_load_dwordx4 v59, s[4:7], s29 offen offset:1024 lds
    v_mfma_f32_16x16x32_bf16 v[216:219], a[192:195], a[8:11], 0
    s_add_u32 m0, s28, 65536
    s_lshl_b32 s29, s54, 12
    ds_read_b64_tr_b16 a[214:215], v1 offset:24832
    v_mfma_f32_16x16x32_bf16 v[216:219], a[196:199], a[20:23], v[216:219]
    s_waitcnt lgkmcnt(4)
    s_add_u32 s29, s29, s64
    buffer_load_dwordx4 v53, s[8:11], s29 offen lds
    v_mfma_f32_16x16x32_bf16 v[220:223], a[200:203], a[8:11], 0
    ds_read_b64_tr_b16 a[216:217], v2 offset:16384
    v_mfma_f32_16x16x32_bf16 v[220:223], a[204:207], a[20:23], v[220:223]
    ds_read_b64_tr_b16 a[218:219], v2 offset:24576
    buffer_load_dwordx4 v54, s[8:11], s29 offen offset:1024 lds
    v_mfma_f32_16x16x32_bf16 v[156:159], a[204:207], a[16:19], 0
    v_mfma_f32_16x16x32_bf16 v[156:159], a[200:203], a[4:7], v[156:159]
    ds_read_b64_tr_b16 a[220:221], v2 offset:16640
    buffer_load_dwordx4 v55, s[8:11], s29 offen offset:2048 lds
    v_mfma_f32_16x16x32_bf16 v[92:95], a[200:203], a[0:3], 0
    ds_read_b64_tr_b16 a[222:223], v2 offset:24832
    v_mfma_f32_16x16x32_bf16 v[92:95], a[204:207], a[12:15], v[92:95]
    s_waitcnt lgkmcnt(4)
    buffer_load_dwordx4 v56, s[8:11], s29 offen offset:3072 lds
    v_mfma_f32_16x16x32_bf16 v[96:99], a[208:211], a[0:3], 0
    s_waitcnt vmcnt(18)
    ds_read_b64_tr_b16 a[224:225], v3 offset:16384
    ds_read_b128 a[24:27], v60 offset:24576
    v_mfma_f32_16x16x32_bf16 v[96:99], a[212:215], a[12:15], v[96:99]
    ds_read_b64_tr_b16 a[226:227], v3 offset:24576
    ds_read_b128 a[28:31], v60 offset:26624
    v_mfma_f32_16x16x32_bf16 v[160:163], a[212:215], a[16:19], 0
    ds_read_b128 a[32:35], v60 offset:28672
    v_mfma_f32_16x16x32_bf16 v[160:163], a[208:211], a[4:7], v[160:163]
    ds_read_b64_tr_b16 a[228:229], v3 offset:16640
    ds_read_b128 a[36:39], v61 offset:24576
    v_mfma_f32_16x16x32_bf16 v[224:227], a[208:211], a[8:11], 0
    ds_read_b64_tr_b16 a[230:231], v3 offset:24832
    ds_read_b128 a[40:43], v61 offset:26624
    v_mfma_f32_16x16x32_bf16 v[224:227], a[212:215], a[20:23], v[224:227]
    s_waitcnt lgkmcnt(9)
    ds_read_b128 a[44:47], v61 offset:28672
    v_mfma_f32_16x16x32_bf16 v[228:231], a[216:219], a[8:11], 0
    s_add_u32 m0, s32, 139264
    ds_read_b64_tr_b16 a[232:233], v4 offset:16384
    v_mfma_f32_16x16x32_bf16 v[228:231], a[220:223], a[20:23], v[228:231]
    s_add_u32 s29, s55, 0
    ds_read_b64_tr_b16 a[234:235], v4 offset:24576
    buffer_load_dwordx4 v58, s[4:7], s29 offen lds
    v_mfma_f32_16x16x32_bf16 v[164:167], a[220:223], a[16:19], 0
    v_mfma_f32_16x16x32_bf16 v[164:167], a[216:219], a[4:7], v[164:167]
    s_add_u32 s29, s55, 6144
    ds_read_b64_tr_b16 a[236:237], v4 offset:16640
    buffer_load_dwordx4 v59, s[4:7], s29 offen offset:1024 lds
    v_mfma_f32_16x16x32_bf16 v[100:103], a[216:219], a[0:3], 0
    ds_read_b64_tr_b16 a[238:239], v4 offset:24832
    v_mfma_f32_16x16x32_bf16 v[100:103], a[220:223], a[12:15], v[100:103]
    s_waitcnt lgkmcnt(6)
    s_add_u32 s29, s55, 12288
    buffer_load_dwordx4 v58, s[4:7], s29 offen offset:2048 lds
    v_mfma_f32_16x16x32_bf16 v[104:107], a[224:227], a[0:3], 0
    ds_read_b64_tr_b16 a[192:193], v5 offset:16384
    v_mfma_f32_16x16x32_bf16 v[104:107], a[228:231], a[12:15], v[104:107]
    s_add_u32 s29, s55, 18432
    ds_read_b64_tr_b16 a[194:195], v5 offset:24576
    buffer_load_dwordx4 v59, s[4:7], s29 offen offset:3072 lds
    v_mfma_f32_16x16x32_bf16 v[168:171], a[228:231], a[16:19], 0
    s_add_u32 m0, s32, 143360
    v_mfma_f32_16x16x32_bf16 v[168:171], a[224:227], a[4:7], v[168:171]
    s_add_u32 s29, s55, 28672
    ds_read_b64_tr_b16 a[196:197], v5 offset:16640
    buffer_load_dwordx4 v58, s[4:7], s29 offen lds
    v_mfma_f32_16x16x32_bf16 v[232:235], a[224:227], a[8:11], 0
    ds_read_b64_tr_b16 a[198:199], v5 offset:24832
    v_mfma_f32_16x16x32_bf16 v[232:235], a[228:231], a[20:23], v[232:235]
    s_waitcnt lgkmcnt(4)
    s_add_u32 s29, s55, 34816
    buffer_load_dwordx4 v59, s[4:7], s29 offen offset:1024 lds
    v_mfma_f32_16x16x32_bf16 v[236:239], a[232:235], a[8:11], 0
    ds_read_b64_tr_b16 a[200:201], v6 offset:16384
    v_mfma_f32_16x16x32_bf16 v[236:239], a[236:239], a[20:23], v[236:239]
    ds_read_b64_tr_b16 a[202:203], v6 offset:24576
    v_mfma_f32_16x16x32_bf16 v[172:175], a[236:239], a[16:19], 0
    v_mfma_f32_16x16x32_bf16 v[172:175], a[232:235], a[4:7], v[172:175]
    ds_read_b64_tr_b16 a[204:205], v6 offset:16640
    v_mfma_f32_16x16x32_bf16 v[108:111], a[232:235], a[0:3], 0
    ds_read_b64_tr_b16 a[206:207], v6 offset:24832
    v_mfma_f32_16x16x32_bf16 v[108:111], a[236:239], a[12:15], v[108:111]
    s_waitcnt lgkmcnt(4)
    v_mfma_f32_16x16x32_bf16 v[112:115], a[192:195], a[0:3], 0
    s_add_u32 m0, s32, 114688
    ds_read_b64_tr_b16 a[208:209], v7 offset:16384
    v_mfma_f32_16x16x32_bf16 v[112:115], a[196:199], a[12:15], v[112:115]
    s_add_u32 s29, s62, 0
    ds_read_b64_tr_b16 a[210:211], v7 offset:24576
    buffer_load_dwordx4 v58, s[4:7], s29 offen lds
    v_mfma_f32_16x16x32_bf16 v[176:179], a[196:199], a[16:19], 0
    v_mfma_f32_16x16x32_bf16 v[176:179], a[192:195], a[4:7], v[176:179]
    s_add_u32 s29, s62, 6144
    ds_read_b64_tr_b16 a[212:213], v7 offset:16640
    buffer_load_dwordx4 v59, s[4:7], s29 offen offset:1024 lds
    v_mfma_f32_16x16x32_bf16 v[240:243], a[192:195], a[8:11], 0
    ds_read_b64_tr_b16 a[214:215], v7 offset:24832
    v_mfma_f32_16x16x32_bf16 v[240:243], a[196:199], a[20:23], v[240:243]
    s_waitcnt lgkmcnt(4)
    s_add_u32 s29, s62, 12288
    buffer_load_dwordx4 v58, s[4:7], s29 offen offset:2048 lds
    v_mfma_f32_16x16x32_bf16 v[244:247], a[200:203], a[8:11], 0
    ds_read_b64_tr_b16 a[216:217], v8 offset:16384
    v_mfma_f32_16x16x32_bf16 v[244:247], a[204:207], a[20:23], v[244:247]
    s_add_u32 s29, s62, 18432
    ds_read_b64_tr_b16 a[218:219], v8 offset:24576
    buffer_load_dwordx4 v59, s[4:7], s29 offen offset:3072 lds
    v_mfma_f32_16x16x32_bf16 v[180:183], a[204:207], a[16:19], 0
    s_add_u32 m0, s32, 118784
    v_mfma_f32_16x16x32_bf16 v[180:183], a[200:203], a[4:7], v[180:183]
    s_add_u32 s29, s62, 28672
    ds_read_b64_tr_b16 a[220:221], v8 offset:16640
    buffer_load_dwordx4 v58, s[4:7], s29 offen lds
    v_mfma_f32_16x16x32_bf16 v[116:119], a[200:203], a[0:3], 0
    ds_read_b64_tr_b16 a[222:223], v8 offset:24832
    v_mfma_f32_16x16x32_bf16 v[116:119], a[204:207], a[12:15], v[116:119]
    s_waitcnt lgkmcnt(4)
    s_waitcnt vmcnt(25)
    s_add_u32 s29, s62, 34816
    buffer_load_dwordx4 v59, s[4:7], s29 offen offset:1024 lds
    s_barrier
    v_mfma_f32_16x16x32_bf16 v[120:123], a[208:211], a[0:3], 0
    s_add_u32 m0, s28, 0
    s_lshl_b32 s29, s54, 12
    ds_read_b64_tr_b16 a[224:225], v1 offset:32768
    v_mfma_f32_16x16x32_bf16 v[120:123], a[212:215], a[12:15], v[120:123]
    s_add_u32 s29, s29, s65
    ds_read_b64_tr_b16 a[226:227], v1 offset:40960
    v_mfma_f32_16x16x32_bf16 v[184:187], a[212:215], a[16:19], 0
    buffer_load_dwordx4 v53, s[8:11], s29 offen lds
    v_mfma_f32_16x16x32_bf16 v[184:187], a[208:211], a[4:7], v[184:187]
    ds_read_b64_tr_b16 a[228:229], v1 offset:33024
    v_mfma_f32_16x16x32_bf16 v[248:251], a[208:211], a[8:11], 0
    s_waitcnt vmcnt(17)
    ds_read_b64_tr_b16 a[230:231], v1 offset:41216
    ds_read_b128 a[48:51], v60 offset:0
    v_mfma_f32_16x16x32_bf16 v[248:251], a[212:215], a[20:23], v[248:251]
    s_waitcnt lgkmcnt(5)
    buffer_load_dwordx4 v54, s[8:11], s29 offen offset:1024 lds
    ds_read_b128 a[52:55], v60 offset:2048
    v_mfma_f32_16x16x32_bf16 v[252:255], a[216:219], a[8:11], 0
    ds_read_b64_tr_b16 a[232:233], v2 offset:32768
    ds_read_b128 a[56:59], v60 offset:4096
    v_mfma_f32_16x16x32_bf16 v[252:255], a[220:223], a[20:23], v[252:255]
    ds_read_b64_tr_b16 a[234:235], v2 offset:40960
    ds_read_b128 a[60:63], v61 offset:0
    v_mfma_f32_16x16x32_bf16 v[188:191], a[220:223], a[16:19], 0
    buffer_load_dwordx4 v55, s[8:11], s29 offen offset:2048 lds
    ds_read_b128 a[64:67], v61 offset:2048
    v_mfma_f32_16x16x32_bf16 v[188:191], a[216:219], a[4:7], v[188:191]
    ds_read_b64_tr_b16 a[236:237], v2 offset:33024
    ds_read_b128 a[68:71], v61 offset:4096
    v_mfma_f32_16x16x32_bf16 v[124:127], a[216:219], a[0:3], 0
    ds_read_b64_tr_b16 a[238:239], v2 offset:41216
    v_mfma_f32_16x16x32_bf16 v[124:127], a[220:223], a[12:15], v[124:127]
    s_waitcnt lgkmcnt(10)
    buffer_load_dwordx4 v56, s[8:11], s29 offen offset:3072 lds
    v_mfma_f32_16x16x32_bf16 v[64:67], a[224:227], a[24:27], v[64:67]
    ds_read_b64_tr_b16 a[192:193], v3 offset:32768
    v_add_u32 v53, 0, v62
    v_mfma_f32_16x16x32_bf16 v[64:67], a[228:231], a[36:39], v[64:67]
    ds_read_b64_tr_b16 a[194:195], v3 offset:40960
    v_add_u32 v54, 130048, v62
    v_mfma_f32_16x16x32_bf16 v[128:131], a[228:231], a[40:43], v[128:131]
    v_add_u32 v55, 30720, v62
    v_add_u32 v56, 160768, v62
    v_mfma_f32_16x16x32_bf16 v[128:131], a[224:227], a[28:31], v[128:131]
    ds_read_b64_tr_b16 a[196:197], v3 offset:33024
    v_mfma_f32_16x16x32_bf16 v[192:195], a[224:227], a[32:35], v[192:195]
    ds_read_b64_tr_b16 a[198:199], v3 offset:41216
    v_mfma_f32_16x16x32_bf16 v[192:195], a[228:231], a[44:47], v[192:195]
    s_waitcnt lgkmcnt(4)
    v_mfma_f32_16x16x32_bf16 v[196:199], a[232:235], a[32:35], v[196:199]
    ds_read_b64_tr_b16 a[200:201], v4 offset:32768
    v_mfma_f32_16x16x32_bf16 v[196:199], a[236:239], a[44:47], v[196:199]
    ds_read_b64_tr_b16 a[202:203], v4 offset:40960
    v_mfma_f32_16x16x32_bf16 v[132:135], a[236:239], a[40:43], v[132:135]
    v_mfma_f32_16x16x32_bf16 v[132:135], a[232:235], a[28:31], v[132:135]
    s_add_u32 s3, s30, 3584
    ds_read_b64_tr_b16 a[204:205], v4 offset:33024
    buffer_load_dword a255, v0, s[20:23], s3 offen
    v_mfma_f32_16x16x32_bf16 v[68:71], a[232:235], a[24:27], v[68:71]
    ds_read_b64_tr_b16 a[206:207], v4 offset:41216
    v_mfma_f32_16x16x32_bf16 v[68:71], a[236:239], a[36:39], v[68:71]
    s_waitcnt lgkmcnt(4)
    v_mfma_f32_16x16x32_bf16 v[72:75], a[192:195], a[24:27], v[72:75]
    ds_read_b64_tr_b16 a[208:209], v5 offset:32768
    v_mfma_f32_16x16x32_bf16 v[72:75], a[196:199], a[36:39], v[72:75]
    ds_read_b64_tr_b16 a[210:211], v5 offset:40960
    v_mfma_f32_16x16x32_bf16 v[136:139], a[196:199], a[40:43], v[136:139]
    v_mfma_f32_16x16x32_bf16 v[136:139], a[192:195], a[28:31], v[136:139]
    ds_read_b64_tr_b16 a[212:213], v5 offset:33024
    v_mfma_f32_16x16x32_bf16 v[200:203], a[192:195], a[32:35], v[200:203]
    ds_read_b64_tr_b16 a[214:215], v5 offset:41216
    v_mfma_f32_16x16x32_bf16 v[200:203], a[196:199], a[44:47], v[200:203]
    s_waitcnt lgkmcnt(4)
    v_mfma_f32_16x16x32_bf16 v[204:207], a[200:203], a[32:35], v[204:207]
    s_add_u32 m0, s32, 90112
    ds_read_b64_tr_b16 a[216:217], v6 offset:32768
    v_mfma_f32_16x16x32_bf16 v[204:207], a[204:207], a[44:47], v[204:207]
    s_add_u32 s29, s86, 0
    ds_read_b64_tr_b16 a[218:219], v6 offset:40960
    v_mfma_f32_16x16x32_bf16 v[140:143], a[204:207], a[40:43], v[140:143]
    buffer_load_dwordx4 v58, s[4:7], s29 offen lds
    v_mfma_f32_16x16x32_bf16 v[140:143], a[200:203], a[28:31], v[140:143]
    ds_read_b64_tr_b16 a[220:221], v6 offset:33024
    v_mfma_f32_16x16x32_bf16 v[76:79], a[200:203], a[24:27], v[76:79]
    s_add_u32 s29, s86, 6144
    ds_read_b64_tr_b16 a[222:223], v6 offset:41216
    v_mfma_f32_16x16x32_bf16 v[76:79], a[204:207], a[36:39], v[76:79]
    s_waitcnt lgkmcnt(4)
    buffer_load_dwordx4 v59, s[4:7], s29 offen offset:1024 lds
    v_mfma_f32_16x16x32_bf16 v[80:83], a[208:211], a[24:27], v[80:83]
    ds_read_b64_tr_b16 a[224:225], v7 offset:32768
    v_mfma_f32_16x16x32_bf16 v[80:83], a[212:215], a[36:39], v[80:83]
    s_add_u32 s29, s86, 12288
    ds_read_b64_tr_b16 a[226:227], v7 offset:40960
    v_mfma_f32_16x16x32_bf16 v[144:147], a[212:215], a[40:43], v[144:147]
    buffer_load_dwordx4 v58, s[4:7], s29 offen offset:2048 lds
    v_mfma_f32_16x16x32_bf16 v[144:147], a[208:211], a[28:31], v[144:147]
    ds_read_b64_tr_b16 a[228:229], v7 offset:33024
    v_mfma_f32_16x16x32_bf16 v[208:211], a[208:211], a[32:35], v[208:211]
    s_add_u32 s29, s86, 18432
    ds_read_b64_tr_b16 a[230:231], v7 offset:41216
    v_mfma_f32_16x16x32_bf16 v[208:211], a[212:215], a[44:47], v[208:211]
    s_waitcnt lgkmcnt(4)
    buffer_load_dwordx4 v59, s[4:7], s29 offen offset:3072 lds
    v_mfma_f32_16x16x32_bf16 v[212:215], a[216:219], a[32:35], v[212:215]
    s_add_u32 m0, s32, 94208
    ds_read_b64_tr_b16 a[232:233], v8 offset:32768
    v_mfma_f32_16x16x32_bf16 v[212:215], a[220:223], a[44:47], v[212:215]
    s_add_u32 s29, s86, 28672
    ds_read_b64_tr_b16 a[234:235], v8 offset:40960
    v_mfma_f32_16x16x32_bf16 v[148:151], a[220:223], a[40:43], v[148:151]
    buffer_load_dwordx4 v58, s[4:7], s29 offen lds
    v_mfma_f32_16x16x32_bf16 v[148:151], a[216:219], a[28:31], v[148:151]
    ds_read_b64_tr_b16 a[236:237], v8 offset:33024
    v_mfma_f32_16x16x32_bf16 v[84:87], a[216:219], a[24:27], v[84:87]
    s_add_u32 s29, s86, 34816
    ds_read_b64_tr_b16 a[238:239], v8 offset:41216
    v_mfma_f32_16x16x32_bf16 v[84:87], a[220:223], a[36:39], v[84:87]
    s_waitcnt lgkmcnt(4)
    s_waitcnt vmcnt(32)
    buffer_load_dwordx4 v59, s[4:7], s29 offen offset:1024 lds
    s_barrier
    v_mfma_f32_16x16x32_bf16 v[88:91], a[224:227], a[24:27], v[88:91]
    ds_read_b64_tr_b16 a[192:193], v1 offset:49152
    v_mfma_f32_16x16x32_bf16 v[88:91], a[228:231], a[36:39], v[88:91]
    ds_read_b64_tr_b16 a[194:195], v1 offset:57344
    v_mfma_f32_16x16x32_bf16 v[152:155], a[228:231], a[40:43], v[152:155]
    v_mfma_f32_16x16x32_bf16 v[152:155], a[224:227], a[28:31], v[152:155]
    s_add_u32 m0, s28, 16384
    ds_read_b64_tr_b16 a[196:197], v1 offset:49408
    v_mfma_f32_16x16x32_bf16 v[216:219], a[224:227], a[32:35], v[216:219]
    s_xor_b32 s29, s96, 0
    s_waitcnt vmcnt(17)
    ds_read_b64_tr_b16 a[198:199], v1 offset:57600
    v_mfma_f32_16x16x32_bf16 v[216:219], a[228:231], a[44:47], v[216:219]
    s_waitcnt lgkmcnt(4)
    buffer_load_dwordx4 v53, s[8:11], s29 offen lds
    ds_read_b128 a[72:75], v60 offset:49152
    v_mfma_f32_16x16x32_bf16 v[220:223], a[232:235], a[32:35], v[220:223]
    ds_read_b64_tr_b16 a[200:201], v2 offset:49152
    ds_read_b128 a[76:79], v60 offset:51200
    v_mfma_f32_16x16x32_bf16 v[220:223], a[236:239], a[44:47], v[220:223]
    ds_read_b64_tr_b16 a[202:203], v2 offset:57344
    ds_read_b128 a[80:83], v60 offset:53248
    v_mfma_f32_16x16x32_bf16 v[156:159], a[236:239], a[40:43], v[156:159]
    buffer_load_dwordx4 v54, s[8:11], s29 offen offset:1024 lds
    ds_read_b128 a[84:87], v61 offset:49152
    v_mfma_f32_16x16x32_bf16 v[156:159], a[232:235], a[28:31], v[156:159]
    ds_read_b64_tr_b16 a[204:205], v2 offset:49408
    ds_read_b128 a[88:91], v61 offset:51200
    v_mfma_f32_16x16x32_bf16 v[92:95], a[232:235], a[24:27], v[92:95]
    ds_read_b64_tr_b16 a[206:207], v2 offset:57600
    ds_read_b128 a[92:95], v61 offset:53248
    v_mfma_f32_16x16x32_bf16 v[92:95], a[236:239], a[36:39], v[92:95]
    s_waitcnt lgkmcnt(10)
    buffer_load_dwordx4 v55, s[8:11], s29 offen offset:2048 lds
    v_mfma_f32_16x16x32_bf16 v[96:99], a[192:195], a[24:27], v[96:99]
    ds_read_b64_tr_b16 a[208:209], v3 offset:49152
    v_mfma_f32_16x16x32_bf16 v[96:99], a[196:199], a[36:39], v[96:99]
    ds_read_b64_tr_b16 a[210:211], v3 offset:57344
    v_mfma_f32_16x16x32_bf16 v[160:163], a[196:199], a[40:43], v[160:163]
    buffer_load_dwordx4 v56, s[8:11], s29 offen offset:3072 lds
    v_mfma_f32_16x16x32_bf16 v[160:163], a[192:195], a[28:31], v[160:163]
    ds_read_b64_tr_b16 a[212:213], v3 offset:49408
    v_mfma_f32_16x16x32_bf16 v[224:227], a[192:195], a[32:35], v[224:227]
    ds_read_b64_tr_b16 a[214:215], v3 offset:57600
    v_mfma_f32_16x16x32_bf16 v[224:227], a[196:199], a[44:47], v[224:227]
    s_waitcnt lgkmcnt(5)
    v_mfma_f32_16x16x32_bf16 v[228:231], a[200:203], a[32:35], v[228:231]
    ds_read_b64_tr_b16 a[216:217], v4 offset:49152
    v_mfma_f32_16x16x32_bf16 v[228:231], a[204:207], a[44:47], v[228:231]
    ds_read_b64_tr_b16 a[218:219], v4 offset:57344
    v_mfma_f32_16x16x32_bf16 v[164:167], a[204:207], a[40:43], v[164:167]
    v_mfma_f32_16x16x32_bf16 v[164:167], a[200:203], a[28:31], v[164:167]
    ds_read_b64_tr_b16 a[220:221], v4 offset:49408
    v_mfma_f32_16x16x32_bf16 v[100:103], a[200:203], a[24:27], v[100:103]
    ds_read_b64_tr_b16 a[222:223], v4 offset:57600
    v_mfma_f32_16x16x32_bf16 v[100:103], a[204:207], a[36:39], v[100:103]
    s_waitcnt lgkmcnt(4)
    v_mfma_f32_16x16x32_bf16 v[104:107], a[208:211], a[24:27], v[104:107]
    ds_read_b64_tr_b16 a[224:225], v5 offset:49152
    v_mfma_f32_16x16x32_bf16 v[104:107], a[212:215], a[36:39], v[104:107]
    ds_read_b64_tr_b16 a[226:227], v5 offset:57344
    v_mfma_f32_16x16x32_bf16 v[168:171], a[212:215], a[40:43], v[168:171]
    v_mfma_f32_16x16x32_bf16 v[168:171], a[208:211], a[28:31], v[168:171]
    ds_read_b64_tr_b16 a[228:229], v5 offset:49408
    v_mfma_f32_16x16x32_bf16 v[232:235], a[208:211], a[32:35], v[232:235]
    ds_read_b64_tr_b16 a[230:231], v5 offset:57600
    v_mfma_f32_16x16x32_bf16 v[232:235], a[212:215], a[44:47], v[232:235]
    s_waitcnt lgkmcnt(4)
    v_mfma_f32_16x16x32_bf16 v[236:239], a[216:219], a[32:35], v[236:239]
    s_add_u32 m0, s32, 139264
    ds_read_b64_tr_b16 a[232:233], v6 offset:49152
    v_mfma_f32_16x16x32_bf16 v[236:239], a[220:223], a[44:47], v[236:239]
    s_add_u32 s29, s87, 0
    ds_read_b64_tr_b16 a[234:235], v6 offset:57344
    v_mfma_f32_16x16x32_bf16 v[172:175], a[220:223], a[40:43], v[172:175]
    buffer_load_dwordx4 v58, s[4:7], s29 offen lds
    v_mfma_f32_16x16x32_bf16 v[172:175], a[216:219], a[28:31], v[172:175]
    ds_read_b64_tr_b16 a[236:237], v6 offset:49408
    v_mfma_f32_16x16x32_bf16 v[108:111], a[216:219], a[24:27], v[108:111]
    s_add_u32 s29, s87, 6144
    ds_read_b64_tr_b16 a[238:239], v6 offset:57600
    v_mfma_f32_16x16x32_bf16 v[108:111], a[220:223], a[36:39], v[108:111]
    s_waitcnt lgkmcnt(4)
    buffer_load_dwordx4 v59, s[4:7], s29 offen offset:1024 lds
    v_mfma_f32_16x16x32_bf16 v[112:115], a[224:227], a[24:27], v[112:115]
    ds_read_b64_tr_b16 a[192:193], v7 offset:49152
    v_mfma_f32_16x16x32_bf16 v[112:115], a[228:231], a[36:39], v[112:115]
    s_add_u32 s29, s87, 12288
    ds_read_b64_tr_b16 a[194:195], v7 offset:57344
    v_mfma_f32_16x16x32_bf16 v[176:179], a[228:231], a[40:43], v[176:179]
    buffer_load_dwordx4 v58, s[4:7], s29 offen offset:2048 lds
    v_mfma_f32_16x16x32_bf16 v[176:179], a[224:227], a[28:31], v[176:179]
    ds_read_b64_tr_b16 a[196:197], v7 offset:49408
    v_mfma_f32_16x16x32_bf16 v[240:243], a[224:227], a[32:35], v[240:243]
    s_add_u32 s29, s87, 18432
    ds_read_b64_tr_b16 a[198:199], v7 offset:57600
    v_mfma_f32_16x16x32_bf16 v[240:243], a[228:231], a[44:47], v[240:243]
    s_waitcnt lgkmcnt(4)
    buffer_load_dwordx4 v59, s[4:7], s29 offen offset:3072 lds
    v_mfma_f32_16x16x32_bf16 v[244:247], a[232:235], a[32:35], v[244:247]
    s_add_u32 m0, s32, 143360
    ds_read_b64_tr_b16 a[200:201], v8 offset:49152
    v_mfma_f32_16x16x32_bf16 v[244:247], a[236:239], a[44:47], v[244:247]
    s_add_u32 s29, s87, 28672
    ds_read_b64_tr_b16 a[202:203], v8 offset:57344
    v_mfma_f32_16x16x32_bf16 v[180:183], a[236:239], a[40:43], v[180:183]
    buffer_load_dwordx4 v58, s[4:7], s29 offen lds
    v_mfma_f32_16x16x32_bf16 v[180:183], a[232:235], a[28:31], v[180:183]
    ds_read_b64_tr_b16 a[204:205], v8 offset:49408
    v_mfma_f32_16x16x32_bf16 v[116:119], a[232:235], a[24:27], v[116:119]
    s_add_u32 s29, s87, 34816
    ds_read_b64_tr_b16 a[206:207], v8 offset:57600
    v_mfma_f32_16x16x32_bf16 v[116:119], a[236:239], a[36:39], v[116:119]
    s_waitcnt lgkmcnt(4)
    s_waitcnt vmcnt(32)
    buffer_load_dwordx4 v59, s[4:7], s29 offen offset:1024 lds
    s_barrier
    v_mfma_f32_16x16x32_bf16 v[120:123], a[192:195], a[24:27], v[120:123]
    ds_read_b64_tr_b16 a[208:209], v9 offset:0
    v_mfma_f32_16x16x32_bf16 v[120:123], a[196:199], a[36:39], v[120:123]
    ds_read_b64_tr_b16 a[210:211], v9 offset:8192
    v_mfma_f32_16x16x32_bf16 v[184:187], a[196:199], a[40:43], v[184:187]
    v_mfma_f32_16x16x32_bf16 v[184:187], a[192:195], a[28:31], v[184:187]
    s_add_u32 m0, s28, 32768
    ds_read_b64_tr_b16 a[212:213], v9 offset:256
    v_mfma_f32_16x16x32_bf16 v[248:251], a[192:195], a[32:35], v[248:251]
    s_xor_b32 s29, s97, 0
    s_waitcnt vmcnt(21)
    ds_read_b64_tr_b16 a[214:215], v9 offset:8448
    v_mfma_f32_16x16x32_bf16 v[248:251], a[196:199], a[44:47], v[248:251]
    s_waitcnt lgkmcnt(4)
    buffer_load_dwordx4 v53, s[8:11], s29 offen lds
    ds_read_b128 a[96:99], v60 offset:24576
    v_mfma_f32_16x16x32_bf16 v[252:255], a[200:203], a[32:35], v[252:255]
    ds_read_b64_tr_b16 a[216:217], v10 offset:0
    ds_read_b128 a[100:103], v60 offset:26624
    v_mfma_f32_16x16x32_bf16 v[252:255], a[204:207], a[44:47], v[252:255]
    ds_read_b64_tr_b16 a[218:219], v10 offset:8192
    ds_read_b128 a[104:107], v60 offset:28672
    v_mfma_f32_16x16x32_bf16 v[188:191], a[204:207], a[40:43], v[188:191]
    buffer_load_dwordx4 v54, s[8:11], s29 offen offset:1024 lds
    ds_read_b128 a[108:111], v61 offset:24576
    v_mfma_f32_16x16x32_bf16 v[188:191], a[200:203], a[28:31], v[188:191]
    ds_read_b64_tr_b16 a[220:221], v10 offset:256
    ds_read_b128 a[112:115], v61 offset:26624
    v_mfma_f32_16x16x32_bf16 v[124:127], a[200:203], a[24:27], v[124:127]
    ds_read_b64_tr_b16 a[222:223], v10 offset:8448
    ds_read_b128 a[116:119], v61 offset:28672
    v_mfma_f32_16x16x32_bf16 v[124:127], a[204:207], a[36:39], v[124:127]
    s_waitcnt lgkmcnt(10)
    buffer_load_dwordx4 v55, s[8:11], s29 offen offset:2048 lds
    v_mfma_f32_16x16x32_bf16 v[64:67], a[208:211], a[48:51], v[64:67]
    ds_read_b64_tr_b16 a[224:225], v11 offset:0
    v_mfma_f32_16x16x32_bf16 v[64:67], a[212:215], a[60:63], v[64:67]
    ds_read_b64_tr_b16 a[226:227], v11 offset:8192
    v_mfma_f32_16x16x32_bf16 v[128:131], a[212:215], a[64:67], v[128:131]
    buffer_load_dwordx4 v56, s[8:11], s29 offen offset:3072 lds
    v_mfma_f32_16x16x32_bf16 v[128:131], a[208:211], a[52:55], v[128:131]
    ds_read_b64_tr_b16 a[228:229], v11 offset:256
    v_mfma_f32_16x16x32_bf16 v[192:195], a[208:211], a[56:59], v[192:195]
    ds_read_b64_tr_b16 a[230:231], v11 offset:8448
    v_mfma_f32_16x16x32_bf16 v[192:195], a[212:215], a[68:71], v[192:195]
    s_waitcnt lgkmcnt(5)
    v_mfma_f32_16x16x32_bf16 v[196:199], a[216:219], a[56:59], v[196:199]
    ds_read_b64_tr_b16 a[232:233], v12 offset:0
    v_mfma_f32_16x16x32_bf16 v[196:199], a[220:223], a[68:71], v[196:199]
    ds_read_b64_tr_b16 a[234:235], v12 offset:8192
    v_mfma_f32_16x16x32_bf16 v[132:135], a[220:223], a[64:67], v[132:135]
    v_mfma_f32_16x16x32_bf16 v[132:135], a[216:219], a[52:55], v[132:135]
    ds_read_b64_tr_b16 a[236:237], v12 offset:256
    v_mfma_f32_16x16x32_bf16 v[68:71], a[216:219], a[48:51], v[68:71]
    ds_read_b64_tr_b16 a[238:239], v12 offset:8448
    v_mfma_f32_16x16x32_bf16 v[68:71], a[220:223], a[60:63], v[68:71]
    s_waitcnt lgkmcnt(4)
    v_mfma_f32_16x16x32_bf16 v[72:75], a[224:227], a[48:51], v[72:75]
    ds_read_b64_tr_b16 a[192:193], v13 offset:0
    v_mfma_f32_16x16x32_bf16 v[72:75], a[228:231], a[60:63], v[72:75]
    ds_read_b64_tr_b16 a[194:195], v13 offset:8192
    v_mfma_f32_16x16x32_bf16 v[136:139], a[228:231], a[64:67], v[136:139]
    v_mfma_f32_16x16x32_bf16 v[136:139], a[224:227], a[52:55], v[136:139]
    ds_read_b64_tr_b16 a[196:197], v13 offset:256
    v_mfma_f32_16x16x32_bf16 v[200:203], a[224:227], a[56:59], v[200:203]
    ds_read_b64_tr_b16 a[198:199], v13 offset:8448
    v_mfma_f32_16x16x32_bf16 v[200:203], a[228:231], a[68:71], v[200:203]
    s_waitcnt lgkmcnt(4)
    v_mfma_f32_16x16x32_bf16 v[204:207], a[232:235], a[56:59], v[204:207]
    ds_read_b64_tr_b16 a[200:201], v14 offset:0
    v_mfma_f32_16x16x32_bf16 v[204:207], a[236:239], a[68:71], v[204:207]
    s_lshr_b32 s62, s2, 3
    ds_read_b64_tr_b16 a[202:203], v14 offset:8192
    v_mfma_f32_16x16x32_bf16 v[140:143], a[236:239], a[64:67], v[140:143]
    s_lshl_b32 s62, s62, 2
    v_mfma_f32_16x16x32_bf16 v[140:143], a[232:235], a[52:55], v[140:143]
    s_add_u32 s62, s62, s58
    ds_read_b64_tr_b16 a[204:205], v14 offset:256
    v_mfma_f32_16x16x32_bf16 v[76:79], a[232:235], a[48:51], v[76:79]
    s_lshl_b32 s62, s62, 7
    ds_read_b64_tr_b16 a[206:207], v14 offset:8448
    v_mfma_f32_16x16x32_bf16 v[76:79], a[236:239], a[60:63], v[76:79]
    s_waitcnt lgkmcnt(4)
    s_getpc_b64 s[4:5]
L_pv0:
    s_mov_b32 s6, L_code_end-L_pv0
    v_mfma_f32_16x16x32_bf16 v[80:83], a[192:195], a[48:51], v[80:83]
    ds_read_b64_tr_b16 a[208:209], v15 offset:0
    v_mbcnt_lo_u32_b32 v0, -1, 0
    v_mfma_f32_16x16x32_bf16 v[80:83], a[196:199], a[60:63], v[80:83]
    ds_read_b64_tr_b16 a[210:211], v15 offset:8192
    v_mbcnt_hi_u32_b32 v0, -1, v0
    v_mfma_f32_16x16x32_bf16 v[144:147], a[196:199], a[64:67], v[144:147]
    v_and_b32 v0, 3, v0
    v_lshlrev_b32 v0, 14, v0
    v_mfma_f32_16x16x32_bf16 v[144:147], a[192:195], a[52:55], v[144:147]
    ds_read_b64_tr_b16 a[212:213], v15 offset:256
    buffer_load_dword a255, v0, s[4:7], s62 offen
    v_mfma_f32_16x16x32_bf16 v[208:211], a[192:195], a[56:59], v[208:211]
    ds_read_b64_tr_b16 a[214:215], v15 offset:8448
    v_mfma_f32_16x16x32_bf16 v[208:211], a[196:199], a[68:71], v[208:211]
    s_waitcnt lgkmcnt(4)
    v_mfma_f32_16x16x32_bf16 v[212:215], a[200:203], a[56:59], v[212:215]
    ds_read_b64_tr_b16 a[216:217], v16 offset:0
    v_mfma_f32_16x16x32_bf16 v[212:215], a[204:207], a[68:71], v[212:215]
    ds_read_b64_tr_b16 a[218:219], v16 offset:8192
    v_mfma_f32_16x16x32_bf16 v[148:151], a[204:207], a[64:67], v[148:151]
    v_mfma_f32_16x16x32_bf16 v[148:151], a[200:203], a[52:55], v[148:151]
    ds_read_b64_tr_b16 a[220:221], v16 offset:256
    v_mfma_f32_16x16x32_bf16 v[84:87], a[200:203], a[48:51], v[84:87]
    ds_read_b64_tr_b16 a[222:223], v16 offset:8448
    v_mfma_f32_16x16x32_bf16 v[84:87], a[204:207], a[60:63], v[84:87]
    s_waitcnt lgkmcnt(4)
    s_waitcnt vmcnt(22)
    s_barrier
    v_mfma_f32_16x16x32_bf16 v[88:91], a[208:211], a[48:51], v[88:91]
    s_add_u32 m0, s28, 49152
    ds_read_b64_tr_b16 a[224:225], v1 offset:0
    v_mfma_f32_16x16x32_bf16 v[88:91], a[212:215], a[60:63], v[88:91]
    s_xor_b32 s29, s96, 128
    ds_read_b64_tr_b16 a[226:227], v1 offset:8192
    v_mfma_f32_16x16x32_bf16 v[152:155], a[212:215], a[64:67], v[152:155]
    buffer_load_dwordx4 v53, s[8:11], s29 offen lds
    v_mfma_f32_16x16x32_bf16 v[152:155], a[208:211], a[52:55], v[152:155]
    ds_read_b64_tr_b16 a[228:229], v1 offset:256
    v_mfma_f32_16x16x32_bf16 v[216:219], a[208:211], a[56:59], v[216:219]
    s_waitcnt vmcnt(16)
    ds_read_b64_tr_b16 a[230:231], v1 offset:8448
    ds_read_b128 a[120:123], v60 offset:0
    v_mfma_f32_16x16x32_bf16 v[216:219], a[212:215], a[68:71], v[216:219]
    s_waitcnt lgkmcnt(5)
    buffer_load_dwordx4 v54, s[8:11], s29 offen offset:1024 lds
    ds_read_b128 a[124:127], v60 offset:2048
    v_mfma_f32_16x16x32_bf16 v[220:223], a[216:219], a[56:59], v[220:223]
    ds_read_b64_tr_b16 a[232:233], v2 offset:0
    ds_read_b128 a[128:131], v60 offset:4096
    v_mfma_f32_16x16x32_bf16 v[220:223], a[220:223], a[68:71], v[220:223]
    ds_read_b64_tr_b16 a[234:235], v2 offset:8192
    ds_read_b128 a[132:135], v61 offset:0
    v_mfma_f32_16x16x32_bf16 v[156:159], a[220:223], a[64:67], v[156:159]
    buffer_load_dwordx4 v55, s[8:11], s29 offen offset:2048 lds
    ds_read_b128 a[136:139], v61 offset:2048
    v_mfma_f32_16x16x32_bf16 v[156:159], a[216:219], a[52:55], v[156:159]
    ds_read_b64_tr_b16 a[236:237], v2 offset:256
    ds_read_b128 a[140:143], v61 offset:4096
    v_mfma_f32_16x16x32_bf16 v[92:95], a[216:219], a[48:51], v[92:95]
    ds_read_b64_tr_b16 a[238:239], v2 offset:8448
    v_mfma_f32_16x16x32_bf16 v[92:95], a[220:223], a[60:63], v[92:95]
    s_waitcnt lgkmcnt(10)
    buffer_load_dwordx4 v56, s[8:11], s29 offen offset:3072 lds
    v_mfma_f32_16x16x32_bf16 v[96:99], a[224:227], a[48:51], v[96:99]
    ds_read_b64_tr_b16 a[192:193], v3 offset:0
    v_mfma_f32_16x16x32_bf16 v[96:99], a[228:231], a[60:63], v[96:99]
    ds_read_b64_tr_b16 a[194:195], v3 offset:8192
    v_mfma_f32_16x16x32_bf16 v[160:163], a[228:231], a[64:67], v[160:163]
    v_mfma_f32_16x16x32_bf16 v[160:163], a[224:227], a[52:55], v[160:163]
    ds_read_b64_tr_b16 a[196:197], v3 offset:256
    v_mfma_f32_16x16x32_bf16 v[224:227], a[224:227], a[56:59], v[224:227]
    ds_read_b64_tr_b16 a[198:199], v3 offset:8448
    v_mfma_f32_16x16x32_bf16 v[224:227], a[228:231], a[68:71], v[224:227]
    s_waitcnt lgkmcnt(4)
    v_mfma_f32_16x16x32_bf16 v[228:231], a[232:235], a[56:59], v[228:231]
    ds_read_b64_tr_b16 a[200:201], v4 offset:0
    v_mfma_f32_16x16x32_bf16 v[228:231], a[236:239], a[68:71], v[228:231]
    ds_read_b64_tr_b16 a[202:203], v4 offset:8192
    v_mfma_f32_16x16x32_bf16 v[164:167], a[236:239], a[64:67], v[164:167]
    v_mfma_f32_16x16x32_bf16 v[164:167], a[232:235], a[52:55], v[164:167]
    ds_read_b64_tr_b16 a[204:205], v4 offset:256
    v_mfma_f32_16x16x32_bf16 v[100:103], a[232:235], a[48:51], v[100:103]
    ds_read_b64_tr_b16 a[206:207], v4 offset:8448
    v_mfma_f32_16x16x32_bf16 v[100:103], a[236:239], a[60:63], v[100:103]
    s_waitcnt lgkmcnt(4)
    v_mfma_f32_16x16x32_bf16 v[104:107], a[192:195], a[48:51], v[104:107]
    ds_read_b64_tr_b16 a[208:209], v5 offset:0
    v_mfma_f32_16x16x32_bf16 v[104:107], a[196:199], a[60:63], v[104:107]
    ds_read_b64_tr_b16 a[210:211], v5 offset:8192
    v_mfma_f32_16x16x32_bf16 v[168:171], a[196:199], a[64:67], v[168:171]
    v_mfma_f32_16x16x32_bf16 v[168:171], a[192:195], a[52:55], v[168:171]
    ds_read_b64_tr_b16 a[212:213], v5 offset:256
    v_mfma_f32_16x16x32_bf16 v[232:235], a[192:195], a[56:59], v[232:235]
    ds_read_b64_tr_b16 a[214:215], v5 offset:8448
    v_mfma_f32_16x16x32_bf16 v[232:235], a[196:199], a[68:71], v[232:235]
    s_waitcnt lgkmcnt(4)
    v_mfma_f32_16x16x32_bf16 v[236:239], a[200:203], a[56:59], v[236:239]
    ds_read_b64_tr_b16 a[216:217], v6 offset:0
    v_mfma_f32_16x16x32_bf16 v[236:239], a[204:207], a[68:71], v[236:239]
    ds_read_b64_tr_b16 a[218:219], v6 offset:8192
    v_mfma_f32_16x16x32_bf16 v[172:175], a[204:207], a[64:67], v[172:175]
    v_mfma_f32_16x16x32_bf16 v[172:175], a[200:203], a[52:55], v[172:175]
    s_add_u32 m0, s28, 114688
    ds_read_b64_tr_b16 a[220:221], v6 offset:256
    v_mfma_f32_16x16x32_bf16 v[108:111], a[200:203], a[48:51], v[108:111]
    s_xor_b32 s29, s61, 0
    ds_read_b64_tr_b16 a[222:223], v6 offset:8448
    v_mfma_f32_16x16x32_bf16 v[108:111], a[204:207], a[60:63], v[108:111]
    s_waitcnt lgkmcnt(4)
    buffer_load_dwordx4 v49, s[12:15], s29 offen nt lds
    v_mfma_f32_16x16x32_bf16 v[112:115], a[208:211], a[48:51], v[112:115]
    ds_read_b64_tr_b16 a[224:225], v7 offset:0
    v_mfma_f32_16x16x32_bf16 v[112:115], a[212:215], a[60:63], v[112:115]
    ds_read_b64_tr_b16 a[226:227], v7 offset:8192
    v_mfma_f32_16x16x32_bf16 v[176:179], a[212:215], a[64:67], v[176:179]
    buffer_load_dwordx4 v50, s[12:15], s29 offen offset:1024 nt lds
    v_mfma_f32_16x16x32_bf16 v[176:179], a[208:211], a[52:55], v[176:179]
    ds_read_b64_tr_b16 a[228:229], v7 offset:256
    v_mfma_f32_16x16x32_bf16 v[240:243], a[208:211], a[56:59], v[240:243]
    ds_read_b64_tr_b16 a[230:231], v7 offset:8448
    v_mfma_f32_16x16x32_bf16 v[240:243], a[212:215], a[68:71], v[240:243]
    s_waitcnt lgkmcnt(4)
    buffer_load_dwordx4 v51, s[12:15], s29 offen offset:2048 nt lds
    v_mfma_f32_16x16x32_bf16 v[244:247], a[216:219], a[56:59], v[244:247]
    ds_read_b64_tr_b16 a[232:233], v8 offset:0
    v_mfma_f32_16x16x32_bf16 v[244:247], a[220:223], a[68:71], v[244:247]
    ds_read_b64_tr_b16 a[234:235], v8 offset:8192
    v_mfma_f32_16x16x32_bf16 v[180:183], a[220:223], a[64:67], v[180:183]
    buffer_load_dwordx4 v52, s[12:15], s29 offen offset:3072 nt lds
    v_mfma_f32_16x16x32_bf16 v[180:183], a[216:219], a[52:55], v[180:183]
    ds_read_b64_tr_b16 a[236:237], v8 offset:256
    v_mfma_f32_16x16x32_bf16 v[116:119], a[216:219], a[48:51], v[116:119]
    ds_read_b64_tr_b16 a[238:239], v8 offset:8448
    v_mfma_f32_16x16x32_bf16 v[116:119], a[220:223], a[60:63], v[116:119]
    s_waitcnt lgkmcnt(4)
    s_waitcnt vmcnt(19)
    s_barrier
    v_mfma_f32_16x16x32_bf16 v[120:123], a[224:227], a[48:51], v[120:123]
    s_add_u32 m0, s28, 65536
    ds_read_b64_tr_b16 a[192:193], v37 offset:16384
    v_mfma_f32_16x16x32_bf16 v[120:123], a[228:231], a[60:63], v[120:123]
    s_xor_b32 s29, s97, 128
    ds_read_b64_tr_b16 a[194:195], v37 offset:18432
    v_mfma_f32_16x16x32_bf16 v[184:187], a[228:231], a[64:67], v[184:187]
    buffer_load_dwordx4 v53, s[8:11], s29 offen lds
    v_mfma_f32_16x16x32_bf16 v[184:187], a[224:227], a[52:55], v[184:187]
    ds_read_b64_tr_b16 a[196:197], v37 offset:20480
    v_mfma_f32_16x16x32_bf16 v[248:251], a[224:227], a[56:59], v[248:251]
    s_waitcnt vmcnt(14)
    ds_read_b64_tr_b16 a[198:199], v37 offset:22528
    ds_read_b128 a[144:147], v60 offset:49152
    v_mfma_f32_16x16x32_bf16 v[248:251], a[228:231], a[68:71], v[248:251]
    s_waitcnt lgkmcnt(5)
    buffer_load_dwordx4 v54, s[8:11], s29 offen offset:1024 lds
    ds_read_b128 a[148:151], v60 offset:51200
    v_mfma_f32_16x16x32_bf16 v[252:255], a[232:235], a[56:59], v[252:255]
    ds_read_b64_tr_b16 a[200:201], v37 offset:24576
    ds_read_b128 a[152:155], v60 offset:53248
    v_mfma_f32_16x16x32_bf16 v[252:255], a[236:239], a[68:71], v[252:255]
    ds_read_b64_tr_b16 a[202:203], v37 offset:26624
    ds_read_b128 a[156:159], v61 offset:49152
    v_mfma_f32_16x16x32_bf16 v[188:191], a[236:239], a[64:67], v[188:191]
    buffer_load_dwordx4 v55, s[8:11], s29 offen offset:2048 lds
    ds_read_b128 a[160:163], v61 offset:51200
    v_mfma_f32_16x16x32_bf16 v[188:191], a[232:235], a[52:55], v[188:191]
    ds_read_b64_tr_b16 a[204:205], v37 offset:28672
    ds_read_b128 a[164:167], v61 offset:53248
    v_mfma_f32_16x16x32_bf16 v[124:127], a[232:235], a[48:51], v[124:127]
    ds_read_b64_tr_b16 a[206:207], v37 offset:30720
    v_mfma_f32_16x16x32_bf16 v[124:127], a[236:239], a[60:63], v[124:127]
    s_waitcnt lgkmcnt(10)
    buffer_load_dwordx4 v56, s[8:11], s29 offen offset:3072 lds
    v_mfma_f32_16x16x32_bf16 v[64:67], a[192:195], a[72:75], v[64:67]
    ds_read_b64_tr_b16 a[208:209], v38 offset:16384
    v_mfma_f32_16x16x32_bf16 v[64:67], a[196:199], a[84:87], v[64:67]
    ds_read_b64_tr_b16 a[210:211], v38 offset:18432
    v_mfma_f32_16x16x32_bf16 v[128:131], a[196:199], a[88:91], v[128:131]
    v_mfma_f32_16x16x32_bf16 v[128:131], a[192:195], a[76:79], v[128:131]
    ds_read_b64_tr_b16 a[212:213], v38 offset:20480
    v_mfma_f32_16x16x32_bf16 v[192:195], a[192:195], a[80:83], v[192:195]
    ds_read_b64_tr_b16 a[214:215], v38 offset:22528
    v_mfma_f32_16x16x32_bf16 v[192:195], a[196:199], a[92:95], v[192:195]
    s_waitcnt lgkmcnt(4)
    v_mfma_f32_16x16x32_bf16 v[192:195], a[200:203], a[104:107], v[192:195]
    ds_read_b64_tr_b16 a[216:217], v38 offset:24576
    v_mfma_f32_16x16x32_bf16 v[192:195], a[204:207], a[116:119], v[192:195]
    ds_read_b64_tr_b16 a[218:219], v38 offset:26624
    v_mfma_f32_16x16x32_bf16 v[128:131], a[204:207], a[112:115], v[128:131]
    v_mfma_f32_16x16x32_bf16 v[128:131], a[200:203], a[100:103], v[128:131]
    ds_read_b64_tr_b16 a[220:221], v38 offset:28672
    v_mfma_f32_16x16x32_bf16 v[64:67], a[200:203], a[96:99], v[64:67]
    ds_read_b64_tr_b16 a[222:223], v38 offset:30720
    v_mfma_f32_16x16x32_bf16 v[64:67], a[204:207], a[108:111], v[64:67]
    s_waitcnt lgkmcnt(4)
    v_mfma_f32_16x16x32_bf16 v[68:71], a[208:211], a[72:75], v[68:71]
    ds_read_b64_tr_b16 a[224:225], v39 offset:16384
    v_mfma_f32_16x16x32_bf16 v[68:71], a[212:215], a[84:87], v[68:71]
    ds_read_b64_tr_b16 a[226:227], v39 offset:18432
    v_mfma_f32_16x16x32_bf16 v[132:135], a[212:215], a[88:91], v[132:135]
    v_mfma_f32_16x16x32_bf16 v[132:135], a[208:211], a[76:79], v[132:135]
    ds_read_b64_tr_b16 a[228:229], v39 offset:20480
    v_mfma_f32_16x16x32_bf16 v[196:199], a[208:211], a[80:83], v[196:199]
    ds_read_b64_tr_b16 a[230:231], v39 offset:22528
    v_mfma_f32_16x16x32_bf16 v[196:199], a[212:215], a[92:95], v[196:199]
    s_waitcnt lgkmcnt(4)
    v_mfma_f32_16x16x32_bf16 v[196:199], a[216:219], a[104:107], v[196:199]
    ds_read_b64_tr_b16 a[232:233], v39 offset:24576
    v_mfma_f32_16x16x32_bf16 v[196:199], a[220:223], a[116:119], v[196:199]
    ds_read_b64_tr_b16 a[234:235], v39 offset:26624
    v_mfma_f32_16x16x32_bf16 v[132:135], a[220:223], a[112:115], v[132:135]
    v_mfma_f32_16x16x32_bf16 v[132:135], a[216:219], a[100:103], v[132:135]
    ds_read_b64_tr_b16 a[236:237], v39 offset:28672
    v_mfma_f32_16x16x32_bf16 v[68:71], a[216:219], a[96:99], v[68:71]
    ds_read_b64_tr_b16 a[238:239], v39 offset:30720
    v_mfma_f32_16x16x32_bf16 v[68:71], a[220:223], a[108:111], v[68:71]
    s_waitcnt lgkmcnt(4)
    v_mfma_f32_16x16x32_bf16 v[72:75], a[224:227], a[72:75], v[72:75]
    s_add_u32 m0, s28, 81920
    ds_read_b64_tr_b16 a[192:193], v40 offset:16384
    v_mfma_f32_16x16x32_bf16 v[72:75], a[228:231], a[84:87], v[72:75]
    s_xor_b32 s29, s61, 1024
    ds_read_b64_tr_b16 a[194:195], v40 offset:18432
    v_mfma_f32_16x16x32_bf16 v[136:139], a[228:231], a[88:91], v[136:139]
    buffer_load_dwordx4 v49, s[12:15], s29 offen nt lds
    v_mfma_f32_16x16x32_bf16 v[136:139], a[224:227], a[76:79], v[136:139]
    ds_read_b64_tr_b16 a[196:197], v40 offset:20480
    v_mfma_f32_16x16x32_bf16 v[200:203], a[224:227], a[80:83], v[200:203]
    ds_read_b64_tr_b16 a[198:199], v40 offset:22528
    v_mfma_f32_16x16x32_bf16 v[200:203], a[228:231], a[92:95], v[200:203]
    s_waitcnt lgkmcnt(4)
    buffer_load_dwordx4 v50, s[12:15], s29 offen offset:1024 nt lds
    v_mfma_f32_16x16x32_bf16 v[200:203], a[232:235], a[104:107], v[200:203]
    ds_read_b64_tr_b16 a[200:201], v40 offset:24576
    v_mfma_f32_16x16x32_bf16 v[200:203], a[236:239], a[116:119], v[200:203]
    ds_read_b64_tr_b16 a[202:203], v40 offset:26624
    v_mfma_f32_16x16x32_bf16 v[136:139], a[236:239], a[112:115], v[136:139]
    buffer_load_dwordx4 v51, s[12:15], s29 offen offset:2048 nt lds
    v_mfma_f32_16x16x32_bf16 v[136:139], a[232:235], a[100:103], v[136:139]
    ds_read_b64_tr_b16 a[204:205], v40 offset:28672
    v_mfma_f32_16x16x32_bf16 v[72:75], a[232:235], a[96:99], v[72:75]
    ds_read_b64_tr_b16 a[206:207], v40 offset:30720
    v_mfma_f32_16x16x32_bf16 v[72:75], a[236:239], a[108:111], v[72:75]
    s_waitcnt lgkmcnt(4)
    s_waitcnt vmcnt(16)
    buffer_load_dwordx4 v52, s[12:15], s29 offen offset:3072 nt lds
    s_barrier
    v_mfma_f32_16x16x32_bf16 v[76:79], a[192:195], a[72:75], v[76:79]
    ds_read_b64_tr_b16 a[208:209], v37 offset:32768
    v_mfma_f32_16x16x32_bf16 v[76:79], a[196:199], a[84:87], v[76:79]
    ds_read_b64_tr_b16 a[210:211], v37 offset:34816
    v_mfma_f32_16x16x32_bf16 v[140:143], a[196:199], a[88:91], v[140:143]
    v_mfma_f32_16x16x32_bf16 v[140:143], a[192:195], a[76:79], v[140:143]
    s_add_u32 m0, s28, 98304
    ds_read_b64_tr_b16 a[212:213], v37 offset:36864
    v_mfma_f32_16x16x32_bf16 v[204:207], a[192:195], a[80:83], v[204:207]
    s_xor_b32 s29, s96, 256
    ds_read_b64_tr_b16 a[214:215], v37 offset:38912
    v_mfma_f32_16x16x32_bf16 v[204:207], a[196:199], a[92:95], v[204:207]
    s_waitcnt lgkmcnt(4)
    buffer_load_dwordx4 v53, s[8:11], s29 offen lds
    v_mfma_f32_16x16x32_bf16 v[204:207], a[200:203], a[104:107], v[204:207]
    ds_read_b64_tr_b16 a[216:217], v37 offset:40960
    v_mfma_f32_16x16x32_bf16 v[204:207], a[204:207], a[116:119], v[204:207]
    ds_read_b64_tr_b16 a[218:219], v37 offset:43008
    v_mfma_f32_16x16x32_bf16 v[140:143], a[204:207], a[112:115], v[140:143]
    buffer_load_dwordx4 v54, s[8:11], s29 offen offset:1024 lds
    v_mfma_f32_16x16x32_bf16 v[140:143], a[200:203], a[100:103], v[140:143]
    ds_read_b64_tr_b16 a[220:221], v37 offset:45056
    v_mfma_f32_16x16x32_bf16 v[76:79], a[200:203], a[96:99], v[76:79]
    ds_read_b64_tr_b16 a[222:223], v37 offset:47104
    v_mfma_f32_16x16x32_bf16 v[76:79], a[204:207], a[108:111], v[76:79]
    s_waitcnt lgkmcnt(4)
    buffer_load_dwordx4 v55, s[8:11], s29 offen offset:2048 lds
    v_mfma_f32_16x16x32_bf16 v[64:67], a[208:211], a[120:123], v[64:67]
    ds_read_b64_tr_b16 a[224:225], v38 offset:32768
    v_mfma_f32_16x16x32_bf16 v[64:67], a[212:215], a[132:135], v[64:67]
    ds_read_b64_tr_b16 a[226:227], v38 offset:34816
    v_mfma_f32_16x16x32_bf16 v[128:131], a[212:215], a[136:139], v[128:131]
    buffer_load_dwordx4 v56, s[8:11], s29 offen offset:3072 lds
    v_mfma_f32_16x16x32_bf16 v[128:131], a[208:211], a[124:127], v[128:131]
    ds_read_b64_tr_b16 a[228:229], v38 offset:36864
    v_mfma_f32_16x16x32_bf16 v[192:195], a[208:211], a[128:131], v[192:195]
    ds_read_b64_tr_b16 a[230:231], v38 offset:38912
    v_mfma_f32_16x16x32_bf16 v[192:195], a[212:215], a[140:143], v[192:195]
    s_waitcnt lgkmcnt(4)
    v_mfma_f32_16x16x32_bf16 v[192:195], a[216:219], a[152:155], v[192:195]
    ds_read_b64_tr_b16 a[232:233], v38 offset:40960
    v_mfma_f32_16x16x32_bf16 v[192:195], a[220:223], a[164:167], v[192:195]
    ds_read_b64_tr_b16 a[234:235], v38 offset:43008
    v_mfma_f32_16x16x32_bf16 v[128:131], a[220:223], a[160:163], v[128:131]
    v_mfma_f32_16x16x32_bf16 v[128:131], a[216:219], a[148:151], v[128:131]
    ds_read_b64_tr_b16 a[236:237], v38 offset:45056
    v_mfma_f32_16x16x32_bf16 v[64:67], a[216:219], a[144:147], v[64:67]
    ds_read_b64_tr_b16 a[238:239], v38 offset:47104
    v_mfma_f32_16x16x32_bf16 v[64:67], a[220:223], a[156:159], v[64:67]
    s_waitcnt lgkmcnt(4)
    v_mfma_f32_16x16x32_bf16 v[68:71], a[224:227], a[120:123], v[68:71]
    ds_read_b64_tr_b16 a[192:193], v39 offset:32768
    v_mfma_f32_16x16x32_bf16 v[68:71], a[228:231], a[132:135], v[68:71]
    ds_read_b64_tr_b16 a[194:195], v39 offset:34816
    v_mfma_f32_16x16x32_bf16 v[132:135], a[228:231], a[136:139], v[132:135]
    v_mfma_f32_16x16x32_bf16 v[132:135], a[224:227], a[124:127], v[132:135]
    ds_read_b64_tr_b16 a[196:197], v39 offset:36864
    v_mfma_f32_16x16x32_bf16 v[196:199], a[224:227], a[128:131], v[196:199]
    ds_read_b64_tr_b16 a[198:199], v39 offset:38912
    v_mfma_f32_16x16x32_bf16 v[196:199], a[228:231], a[140:143], v[196:199]
    s_waitcnt lgkmcnt(4)
    v_mfma_f32_16x16x32_bf16 v[196:199], a[232:235], a[152:155], v[196:199]
    ds_read_b64_tr_b16 a[200:201], v39 offset:40960
    v_mfma_f32_16x16x32_bf16 v[196:199], a[236:239], a[164:167], v[196:199]
    ds_read_b64_tr_b16 a[202:203], v39 offset:43008
    v_mfma_f32_16x16x32_bf16 v[132:135], a[236:239], a[160:163], v[132:135]
    v_mfma_f32_16x16x32_bf16 v[132:135], a[232:235], a[148:151], v[132:135]
    ds_read_b64_tr_b16 a[204:205], v39 offset:45056
    v_mfma_f32_16x16x32_bf16 v[68:71], a[232:235], a[144:147], v[68:71]
    ds_read_b64_tr_b16 a[206:207], v39 offset:47104
    v_mfma_f32_16x16x32_bf16 v[68:71], a[236:239], a[156:159], v[68:71]
    s_waitcnt lgkmcnt(4)
    v_mfma_f32_16x16x32_bf16 v[72:75], a[192:195], a[120:123], v[72:75]
    ds_read_b64_tr_b16 a[208:209], v40 offset:32768
    v_mfma_f32_16x16x32_bf16 v[72:75], a[196:199], a[132:135], v[72:75]
    ds_read_b64_tr_b16 a[210:211], v40 offset:34816
    v_mfma_f32_16x16x32_bf16 v[136:139], a[196:199], a[136:139], v[136:139]
    v_mfma_f32_16x16x32_bf16 v[136:139], a[192:195], a[124:127], v[136:139]
    s_add_u32 m0, s28, 0
    ds_read_b64_tr_b16 a[212:213], v40 offset:36864
    v_mul_f32 v64, s34, v64
    v_mfma_f32_16x16x32_bf16 v[200:203], a[192:195], a[128:131], v[200:203]
    s_xor_b32 s29, s61, 0
    ds_read_b64_tr_b16 a[214:215], v40 offset:38912
    v_mul_f32 v65, s34, v65
    v_mfma_f32_16x16x32_bf16 v[200:203], a[196:199], a[140:143], v[200:203]
    s_waitcnt lgkmcnt(4)
    buffer_load_dwordx4 v49, s[16:19], s29 offen nt lds
    v_mul_f32 v66, s34, v66
    v_mfma_f32_16x16x32_bf16 v[200:203], a[200:203], a[152:155], v[200:203]
    ds_read_b64_tr_b16 a[216:217], v40 offset:40960
    v_mul_f32 v67, s34, v67
    v_mfma_f32_16x16x32_bf16 v[200:203], a[204:207], a[164:167], v[200:203]
    ds_read_b64_tr_b16 a[218:219], v40 offset:43008
    v_mul_f32 v68, s34, v68
    v_mfma_f32_16x16x32_bf16 v[136:139], a[204:207], a[160:163], v[136:139]
    buffer_load_dwordx4 v50, s[16:19], s29 offen offset:1024 nt lds
    v_mul_f32 v69, s34, v69
    v_mfma_f32_16x16x32_bf16 v[136:139], a[200:203], a[148:151], v[136:139]
    ds_read_b64_tr_b16 a[220:221], v40 offset:45056
    v_mul_f32 v70, s34, v70
    v_mfma_f32_16x16x32_bf16 v[72:75], a[200:203], a[144:147], v[72:75]
    ds_read_b64_tr_b16 a[222:223], v40 offset:47104
    v_mul_f32 v71, s34, v71
    v_mfma_f32_16x16x32_bf16 v[72:75], a[204:207], a[156:159], v[72:75]
    s_waitcnt lgkmcnt(4)
    s_waitcnt vmcnt(18)
    buffer_load_dwordx4 v51, s[16:19], s29 offen offset:2048 nt lds
    s_barrier
    v_mfma_f32_16x16x32_bf16 v[76:79], a[208:211], a[120:123], v[76:79]
    ds_read_b64_tr_b16 a[224:225], v37 offset:49152
    v_cvt_pk_bf16_f32 v64, v64, v65
    v_mfma_f32_16x16x32_bf16 v[76:79], a[212:215], a[132:135], v[76:79]
    ds_read_b64_tr_b16 a[226:227], v37 offset:51200
    v_cvt_pk_bf16_f32 v65, v66, v67
    v_mfma_f32_16x16x32_bf16 v[140:143], a[212:215], a[136:139], v[140:143]
    buffer_load_dwordx4 v52, s[16:19], s29 offen offset:3072 nt lds
    v_cvt_pk_bf16_f32 v66, v68, v69
    v_mfma_f32_16x16x32_bf16 v[140:143], a[208:211], a[124:127], v[140:143]
    ds_read_b64_tr_b16 a[228:229], v37 offset:53248
    v_cvt_pk_bf16_f32 v67, v70, v71
    v_mfma_f32_16x16x32_bf16 v[204:207], a[208:211], a[128:131], v[204:207]
    ds_read_b64_tr_b16 a[230:231], v37 offset:55296
    v_mul_f32 v128, s34, v128
    v_mfma_f32_16x16x32_bf16 v[204:207], a[212:215], a[140:143], v[204:207]
    s_waitcnt lgkmcnt(4)
    v_permlane16_swap_b32 v64, v66
    v_mfma_f32_16x16x32_bf16 v[204:207], a[216:219], a[152:155], v[204:207]
    s_add_u32 m0, s28, 131072
    ds_read_b64_tr_b16 a[232:233], v37 offset:57344
    v_mul_f32 v129, s34, v129
    v_mfma_f32_16x16x32_bf16 v[204:207], a[220:223], a[164:167], v[204:207]
    s_xor_b32 s29, s97, 256
    ds_read_b64_tr_b16 a[234:235], v37 offset:59392
    v_mul_f32 v130, s34, v130
    v_mfma_f32_16x16x32_bf16 v[140:143], a[220:223], a[160:163], v[140:143]
    buffer_load_dwordx4 v53, s[8:11], s29 offen lds
    v_mul_f32 v131, s34, v131
    v_mfma_f32_16x16x32_bf16 v[140:143], a[216:219], a[148:151], v[140:143]
    ds_read_b64_tr_b16 a[236:237], v37 offset:61440
    v_mul_f32 v132, s34, v132
    v_mfma_f32_16x16x32_bf16 v[76:79], a[216:219], a[144:147], v[76:79]
    ds_read_b64_tr_b16 a[238:239], v37 offset:63488
    v_mul_f32 v133, s34, v133
    v_mfma_f32_16x16x32_bf16 v[76:79], a[220:223], a[156:159], v[76:79]
    s_waitcnt lgkmcnt(4)
    buffer_load_dwordx4 v54, s[8:11], s29 offen offset:1024 lds
    v_mul_f32 v134, s34, v134
    v_mfma_f32_16x16x32_bf16 v[80:83], a[224:227], a[72:75], v[80:83]
    ds_read_b64_tr_b16 a[192:193], v38 offset:49152
    v_mul_f32 v135, s34, v135
    v_mfma_f32_16x16x32_bf16 v[80:83], a[228:231], a[84:87], v[80:83]
    ds_read_b64_tr_b16 a[194:195], v38 offset:51200
    v_cvt_pk_bf16_f32 v128, v128, v129
    v_mfma_f32_16x16x32_bf16 v[144:147], a[228:231], a[88:91], v[144:147]
    buffer_load_dwordx4 v55, s[8:11], s29 offen offset:2048 lds
    v_cvt_pk_bf16_f32 v129, v130, v131
    v_mfma_f32_16x16x32_bf16 v[144:147], a[224:227], a[76:79], v[144:147]
    ds_read_b64_tr_b16 a[196:197], v38 offset:53248
    v_cvt_pk_bf16_f32 v130, v132, v133
    v_mfma_f32_16x16x32_bf16 v[208:211], a[224:227], a[80:83], v[208:211]
    ds_read_b64_tr_b16 a[198:199], v38 offset:55296
    v_cvt_pk_bf16_f32 v131, v134, v135
    v_mfma_f32_16x16x32_bf16 v[208:211], a[228:231], a[92:95], v[208:211]
    s_waitcnt lgkmcnt(4)
    buffer_load_dwordx4 v56, s[8:11], s29 offen offset:3072 lds
    v_mul_f32 v192, s34, v192
    v_mfma_f32_16x16x32_bf16 v[208:211], a[232:235], a[104:107], v[208:211]
    ds_read_b64_tr_b16 a[200:201], v38 offset:57344
    v_mul_f32 v193, s34, v193
    v_mfma_f32_16x16x32_bf16 v[208:211], a[236:239], a[116:119], v[208:211]
    ds_read_b64_tr_b16 a[202:203], v38 offset:59392
    v_mul_f32 v194, s34, v194
    v_mfma_f32_16x16x32_bf16 v[144:147], a[236:239], a[112:115], v[144:147]
    v_permlane16_swap_b32 v65, v67
    v_mfma_f32_16x16x32_bf16 v[144:147], a[232:235], a[100:103], v[144:147]
    ds_read_b64_tr_b16 a[204:205], v38 offset:61440
    v_mul_f32 v195, s34, v195
    v_mfma_f32_16x16x32_bf16 v[80:83], a[232:235], a[96:99], v[80:83]
    ds_read_b64_tr_b16 a[206:207], v38 offset:63488
    v_mul_f32 v196, s34, v196
    v_mfma_f32_16x16x32_bf16 v[80:83], a[236:239], a[108:111], v[80:83]
    s_waitcnt lgkmcnt(4)
    v_permlane16_swap_b32 v128, v130
    v_mfma_f32_16x16x32_bf16 v[84:87], a[192:195], a[72:75], v[84:87]
    ds_read_b64_tr_b16 a[208:209], v39 offset:49152
    v_mul_f32 v197, s34, v197
    v_mfma_f32_16x16x32_bf16 v[84:87], a[196:199], a[84:87], v[84:87]
    ds_read_b64_tr_b16 a[210:211], v39 offset:51200
    v_mul_f32 v198, s34, v198
    v_mfma_f32_16x16x32_bf16 v[148:151], a[196:199], a[88:91], v[148:151]
    v_permlane16_swap_b32 v129, v131
    v_mfma_f32_16x16x32_bf16 v[148:151], a[192:195], a[76:79], v[148:151]
    ds_read_b64_tr_b16 a[212:213], v39 offset:53248
    v_mul_f32 v199, s34, v199
    v_mfma_f32_16x16x32_bf16 v[212:215], a[192:195], a[80:83], v[212:215]
    ds_read_b64_tr_b16 a[214:215], v39 offset:55296
    v_cvt_pk_bf16_f32 v192, v192, v193
    v_mfma_f32_16x16x32_bf16 v[212:215], a[196:199], a[92:95], v[212:215]
    s_waitcnt lgkmcnt(4)
    v_mfma_f32_16x16x32_bf16 v[212:215], a[200:203], a[104:107], v[212:215]
    ds_read_b64_tr_b16 a[216:217], v39 offset:57344
    v_cvt_pk_bf16_f32 v193, v194, v195
    v_mfma_f32_16x16x32_bf16 v[212:215], a[204:207], a[116:119], v[212:215]
    ds_read_b64_tr_b16 a[218:219], v39 offset:59392
    v_cvt_pk_bf16_f32 v194, v196, v197
    v_mfma_f32_16x16x32_bf16 v[148:151], a[204:207], a[112:115], v[148:151]
    v_mfma_f32_16x16x32_bf16 v[148:151], a[200:203], a[100:103], v[148:151]
    ds_read_b64_tr_b16 a[220:221], v39 offset:61440
    v_cvt_pk_bf16_f32 v195, v198, v199
    v_mfma_f32_16x16x32_bf16 v[84:87], a[200:203], a[96:99], v[84:87]
    ds_read_b64_tr_b16 a[222:223], v39 offset:63488
    v_mul_f32 v72, s34, v72
    v_mfma_f32_16x16x32_bf16 v[84:87], a[204:207], a[108:111], v[84:87]
    s_waitcnt lgkmcnt(4)
    v_permlane16_swap_b32 v192, v194
    v_mfma_f32_16x16x32_bf16 v[88:91], a[208:211], a[72:75], v[88:91]
    ds_read_b64_tr_b16 a[224:225], v40 offset:49152
    v_mul_f32 v73, s34, v73
    v_mfma_f32_16x16x32_bf16 v[88:91], a[212:215], a[84:87], v[88:91]
    ds_read_b64_tr_b16 a[226:227], v40 offset:51200
    v_mul_f32 v74, s34, v74
    v_mfma_f32_16x16x32_bf16 v[152:155], a[212:215], a[88:91], v[152:155]
    v_permlane16_swap_b32 v193, v195
    v_mfma_f32_16x16x32_bf16 v[152:155], a[208:211], a[76:79], v[152:155]
    ds_read_b64_tr_b16 a[228:229], v40 offset:53248
    v_mul_f32 v75, s34, v75
    v_mfma_f32_16x16x32_bf16 v[216:219], a[208:211], a[80:83], v[216:219]
    ds_read_b64_tr_b16 a[230:231], v40 offset:55296
    v_mul_f32 v76, s34, v76
    v_mfma_f32_16x16x32_bf16 v[216:219], a[212:215], a[92:95], v[216:219]
    s_waitcnt lgkmcnt(4)
    v_mfma_f32_16x16x32_bf16 v[216:219], a[216:219], a[104:107], v[216:219]
    s_add_u32 m0, s28, 147456
    ds_read_b64_tr_b16 a[232:233], v40 offset:57344
    v_mul_f32 v77, s34, v77
    v_mfma_f32_16x16x32_bf16 v[216:219], a[220:223], a[116:119], v[216:219]
    s_xor_b32 s29, s61, 2048
    ds_read_b64_tr_b16 a[234:235], v40 offset:59392
    v_mul_f32 v78, s34, v78
    v_mfma_f32_16x16x32_bf16 v[152:155], a[220:223], a[112:115], v[152:155]
    buffer_load_dwordx4 v49, s[12:15], s29 offen nt lds
    v_mul_f32 v79, s34, v79
    v_mfma_f32_16x16x32_bf16 v[152:155], a[216:219], a[100:103], v[152:155]
    ds_read_b64_tr_b16 a[236:237], v40 offset:61440
    v_cvt_pk_bf16_f32 v72, v72, v73
    v_mfma_f32_16x16x32_bf16 v[88:91], a[216:219], a[96:99], v[88:91]
    ds_read_b64_tr_b16 a[238:239], v40 offset:63488
    v_cvt_pk_bf16_f32 v73, v74, v75
    v_mfma_f32_16x16x32_bf16 v[88:91], a[220:223], a[108:111], v[88:91]
    s_waitcnt lgkmcnt(4)
    s_waitcnt vmcnt(17)
    buffer_load_dwordx4 v50, s[12:15], s29 offen offset:1024 nt lds
    s_barrier
    v_mfma_f32_16x16x32_bf16 v[92:95], a[224:227], a[72:75], v[92:95]
    ds_read_b64_tr_b16 a[192:193], v41 offset:0
    v_cvt_pk_bf16_f32 v74, v76, v77
    v_mfma_f32_16x16x32_bf16 v[92:95], a[228:231], a[84:87], v[92:95]
    ds_read_b64_tr_b16 a[194:195], v41 offset:2048
    v_cvt_pk_bf16_f32 v75, v78, v79
    v_mfma_f32_16x16x32_bf16 v[156:159], a[228:231], a[88:91], v[156:159]
    buffer_load_dwordx4 v51, s[12:15], s29 offen offset:2048 nt lds
    v_mul_f32 v136, s34, v136
    v_mfma_f32_16x16x32_bf16 v[156:159], a[224:227], a[76:79], v[156:159]
    ds_read_b64_tr_b16 a[196:197], v41 offset:4096
    v_mul_f32 v137, s34, v137
    v_mfma_f32_16x16x32_bf16 v[220:223], a[224:227], a[80:83], v[220:223]
    ds_read_b64_tr_b16 a[198:199], v41 offset:6144
    v_mul_f32 v138, s34, v138
    v_mfma_f32_16x16x32_bf16 v[220:223], a[228:231], a[92:95], v[220:223]
    s_waitcnt lgkmcnt(4)
    buffer_load_dwordx4 v52, s[12:15], s29 offen offset:3072 nt lds
    v_mul_f32 v139, s34, v139
    v_mfma_f32_16x16x32_bf16 v[220:223], a[232:235], a[104:107], v[220:223]
    ds_read_b64_tr_b16 a[200:201], v41 offset:8192
    v_mul_f32 v140, s34, v140
    v_mfma_f32_16x16x32_bf16 v[220:223], a[236:239], a[116:119], v[220:223]
    ds_read_b64_tr_b16 a[202:203], v41 offset:10240
    v_mul_f32 v141, s34, v141
    v_mfma_f32_16x16x32_bf16 v[156:159], a[236:239], a[112:115], v[156:159]
    v_permlane16_swap_b32 v72, v74
    v_mfma_f32_16x16x32_bf16 v[156:159], a[232:235], a[100:103], v[156:159]
    s_add_u32 m0, s28, 16384
    ds_read_b64_tr_b16 a[204:205], v41 offset:12288
    v_mul_f32 v142, s34, v142
    v_mfma_f32_16x16x32_bf16 v[92:95], a[232:235], a[96:99], v[92:95]
    s_xor_b32 s29, s96, 384
    ds_read_b64_tr_b16 a[206:207], v41 offset:14336
    v_mul_f32 v143, s34, v143
    v_mfma_f32_16x16x32_bf16 v[92:95], a[236:239], a[108:111], v[92:95]
    s_waitcnt lgkmcnt(4)
    buffer_load_dwordx4 v53, s[8:11], s29 offen lds
    v_cvt_pk_bf16_f32 v136, v136, v137
    v_mfma_f32_16x16x32_bf16 v[80:83], a[192:195], a[120:123], v[80:83]
    ds_read_b64_tr_b16 a[208:209], v42 offset:0
    v_cvt_pk_bf16_f32 v137, v138, v139
    v_mfma_f32_16x16x32_bf16 v[80:83], a[196:199], a[132:135], v[80:83]
    ds_read_b64_tr_b16 a[210:211], v42 offset:2048
    v_cvt_pk_bf16_f32 v138, v140, v141
    v_mfma_f32_16x16x32_bf16 v[144:147], a[196:199], a[136:139], v[144:147]
    buffer_load_dwordx4 v54, s[8:11], s29 offen offset:1024 lds
    v_cvt_pk_bf16_f32 v139, v142, v143
    v_mfma_f32_16x16x32_bf16 v[144:147], a[192:195], a[124:127], v[144:147]
    ds_read_b64_tr_b16 a[212:213], v42 offset:4096
    v_mul_f32 v200, s34, v200
    v_mfma_f32_16x16x32_bf16 v[208:211], a[192:195], a[128:131], v[208:211]
    ds_read_b64_tr_b16 a[214:215], v42 offset:6144
    v_mul_f32 v201, s34, v201
    v_mfma_f32_16x16x32_bf16 v[208:211], a[196:199], a[140:143], v[208:211]
    s_waitcnt lgkmcnt(4)
    buffer_load_dwordx4 v55, s[8:11], s29 offen offset:2048 lds
    v_mul_f32 v202, s34, v202
    v_mfma_f32_16x16x32_bf16 v[208:211], a[200:203], a[152:155], v[208:211]
    ds_read_b64_tr_b16 a[216:217], v42 offset:8192
    v_mul_f32 v203, s34, v203
    v_mfma_f32_16x16x32_bf16 v[208:211], a[204:207], a[164:167], v[208:211]
    ds_read_b64_tr_b16 a[218:219], v42 offset:10240
    v_mul_f32 v204, s34, v204
    v_mfma_f32_16x16x32_bf16 v[144:147], a[204:207], a[160:163], v[144:147]
    buffer_load_dwordx4 v56, s[8:11], s29 offen offset:3072 lds
    v_mul_f32 v205, s34, v205
    v_mfma_f32_16x16x32_bf16 v[144:147], a[200:203], a[148:151], v[144:147]
    ds_read_b64_tr_b16 a[220:221], v42 offset:12288
    v_mul_f32 v206, s34, v206
    v_mfma_f32_16x16x32_bf16 v[80:83], a[200:203], a[144:147], v[80:83]
    ds_read_b64_tr_b16 a[222:223], v42 offset:14336
    v_mul_f32 v207, s34, v207
    v_mfma_f32_16x16x32_bf16 v[80:83], a[204:207], a[156:159], v[80:83]
    s_waitcnt lgkmcnt(4)
    v_permlane16_swap_b32 v73, v75
    v_mfma_f32_16x16x32_bf16 v[84:87], a[208:211], a[120:123], v[84:87]
    ds_read_b64_tr_b16 a[224:225], v43 offset:0
    v_cvt_pk_bf16_f32 v200, v200, v201
    v_mfma_f32_16x16x32_bf16 v[84:87], a[212:215], a[132:135], v[84:87]
    ds_read_b64_tr_b16 a[226:227], v43 offset:2048
    v_cvt_pk_bf16_f32 v201, v202, v203
    v_mfma_f32_16x16x32_bf16 v[148:151], a[212:215], a[136:139], v[148:151]
    v_permlane16_swap_b32 v136, v138
    v_mfma_f32_16x16x32_bf16 v[148:151], a[208:211], a[124:127], v[148:151]
    ds_read_b64_tr_b16 a[228:229], v43 offset:4096
    v_cvt_pk_bf16_f32 v202, v204, v205
    v_mfma_f32_16x16x32_bf16 v[212:215], a[208:211], a[128:131], v[212:215]
    ds_read_b64_tr_b16 a[230:231], v43 offset:6144
    v_cvt_pk_bf16_f32 v203, v206, v207
    v_mfma_f32_16x16x32_bf16 v[212:215], a[212:215], a[140:143], v[212:215]
    s_waitcnt lgkmcnt(4)
    v_permlane16_swap_b32 v137, v139
    v_mfma_f32_16x16x32_bf16 v[212:215], a[216:219], a[152:155], v[212:215]
    ds_read_b64_tr_b16 a[232:233], v43 offset:8192
    v_mfma_f32_16x16x32_bf16 v[212:215], a[220:223], a[164:167], v[212:215]
    ds_read_b64_tr_b16 a[234:235], v43 offset:10240
    v_mfma_f32_16x16x32_bf16 v[148:151], a[220:223], a[160:163], v[148:151]
    v_permlane16_swap_b32 v200, v202
    v_mfma_f32_16x16x32_bf16 v[148:151], a[216:219], a[148:151], v[148:151]
    ds_read_b64_tr_b16 a[236:237], v43 offset:12288
    v_mfma_f32_16x16x32_bf16 v[84:87], a[216:219], a[144:147], v[84:87]
    ds_read_b64_tr_b16 a[238:239], v43 offset:14336
    v_mfma_f32_16x16x32_bf16 v[84:87], a[220:223], a[156:159], v[84:87]
    s_waitcnt lgkmcnt(4)
    v_permlane16_swap_b32 v201, v203
    v_mfma_f32_16x16x32_bf16 v[88:91], a[224:227], a[120:123], v[88:91]
    ds_read_b64_tr_b16 a[192:193], v44 offset:0
    v_mfma_f32_16x16x32_bf16 v[88:91], a[228:231], a[132:135], v[88:91]
    ds_read_b64_tr_b16 a[194:195], v44 offset:2048
    v_mfma_f32_16x16x32_bf16 v[152:155], a[228:231], a[136:139], v[152:155]
    v_mfma_f32_16x16x32_bf16 v[152:155], a[224:227], a[124:127], v[152:155]
    ds_read_b64_tr_b16 a[196:197], v44 offset:4096
    v_mul_f32 v80, s34, v80
    v_mfma_f32_16x16x32_bf16 v[216:219], a[224:227], a[128:131], v[216:219]
    ds_read_b64_tr_b16 a[198:199], v44 offset:6144
    v_mul_f32 v81, s34, v81
    v_mfma_f32_16x16x32_bf16 v[216:219], a[228:231], a[140:143], v[216:219]
    s_waitcnt lgkmcnt(4)
    v_mfma_f32_16x16x32_bf16 v[216:219], a[232:235], a[152:155], v[216:219]
    ds_read_b64_tr_b16 a[200:201], v44 offset:8192
    v_mul_f32 v82, s34, v82
    v_mfma_f32_16x16x32_bf16 v[216:219], a[236:239], a[164:167], v[216:219]
    ds_read_b64_tr_b16 a[202:203], v44 offset:10240
    v_mul_f32 v83, s34, v83
    v_mfma_f32_16x16x32_bf16 v[152:155], a[236:239], a[160:163], v[152:155]
    v_mfma_f32_16x16x32_bf16 v[152:155], a[232:235], a[148:151], v[152:155]
    s_add_u32 m0, s28, 32768
    ds_read_b64_tr_b16 a[204:205], v44 offset:12288
    v_mul_f32 v84, s34, v84
    v_mfma_f32_16x16x32_bf16 v[88:91], a[232:235], a[144:147], v[88:91]
    s_xor_b32 s29, s61, 1024
    ds_read_b64_tr_b16 a[206:207], v44 offset:14336
    v_mul_f32 v85, s34, v85
    v_mfma_f32_16x16x32_bf16 v[88:91], a[236:239], a[156:159], v[88:91]
    s_waitcnt lgkmcnt(4)
    s_waitcnt vmcnt(16)
    buffer_load_dwordx4 v49, s[16:19], s29 offen nt lds
    s_barrier
    v_mfma_f32_16x16x32_bf16 v[92:95], a[192:195], a[120:123], v[92:95]
    ds_read_b64_tr_b16 a[208:209], v41 offset:32768
    v_mul_f32 v86, s34, v86
    v_mfma_f32_16x16x32_bf16 v[92:95], a[196:199], a[132:135], v[92:95]
    ds_read_b64_tr_b16 a[210:211], v41 offset:34816
    v_mul_f32 v87, s34, v87
    v_mfma_f32_16x16x32_bf16 v[156:159], a[196:199], a[136:139], v[156:159]
    buffer_load_dwordx4 v50, s[16:19], s29 offen offset:1024 nt lds
    v_cvt_pk_bf16_f32 v80, v80, v81
    v_mfma_f32_16x16x32_bf16 v[156:159], a[192:195], a[124:127], v[156:159]
    ds_read_b64_tr_b16 a[212:213], v41 offset:36864
    v_cvt_pk_bf16_f32 v81, v82, v83
    v_mfma_f32_16x16x32_bf16 v[220:223], a[192:195], a[128:131], v[220:223]
    ds_read_b64_tr_b16 a[214:215], v41 offset:38912
    v_cvt_pk_bf16_f32 v82, v84, v85
    v_mfma_f32_16x16x32_bf16 v[220:223], a[196:199], a[140:143], v[220:223]
    s_waitcnt lgkmcnt(4)
    buffer_load_dwordx4 v51, s[16:19], s29 offen offset:2048 nt lds
    v_cvt_pk_bf16_f32 v83, v86, v87
    v_mfma_f32_16x16x32_bf16 v[220:223], a[200:203], a[152:155], v[220:223]
    ds_read_b64_tr_b16 a[216:217], v41 offset:40960
    v_mul_f32 v144, s34, v144
    v_mfma_f32_16x16x32_bf16 v[220:223], a[204:207], a[164:167], v[220:223]
    ds_read_b64_tr_b16 a[218:219], v41 offset:43008
    v_mul_f32 v145, s34, v145
    v_mfma_f32_16x16x32_bf16 v[156:159], a[204:207], a[160:163], v[156:159]
    buffer_load_dwordx4 v52, s[16:19], s29 offen offset:3072 nt lds
    v_mul_f32 v146, s34, v146
    v_mfma_f32_16x16x32_bf16 v[156:159], a[200:203], a[148:151], v[156:159]
    ds_read_b64_tr_b16 a[220:221], v41 offset:45056
    v_mul_f32 v147, s34, v147
    v_mfma_f32_16x16x32_bf16 v[92:95], a[200:203], a[144:147], v[92:95]
    ds_read_b64_tr_b16 a[222:223], v41 offset:47104
    v_mul_f32 v148, s34, v148
    v_mfma_f32_16x16x32_bf16 v[92:95], a[204:207], a[156:159], v[92:95]
    s_waitcnt lgkmcnt(4)
    v_permlane16_swap_b32 v80, v82
    v_mfma_f32_16x16x32_bf16 v[96:99], a[208:211], a[72:75], v[96:99]
    s_add_u32 m0, s28, 49152
    ds_read_b64_tr_b16 a[224:225], v42 offset:32768
    v_mul_f32 v149, s34, v149
    v_mfma_f32_16x16x32_bf16 v[96:99], a[212:215], a[84:87], v[96:99]
    s_xor_b32 s29, s97, 384
    ds_read_b64_tr_b16 a[226:227], v42 offset:34816
    v_mul_f32 v150, s34, v150
    v_mfma_f32_16x16x32_bf16 v[160:163], a[212:215], a[88:91], v[160:163]
    buffer_load_dwordx4 v53, s[8:11], s29 offen lds
    v_mul_f32 v151, s34, v151
    v_mfma_f32_16x16x32_bf16 v[160:163], a[208:211], a[76:79], v[160:163]
    ds_read_b64_tr_b16 a[228:229], v42 offset:36864
    v_cvt_pk_bf16_f32 v144, v144, v145
    v_mfma_f32_16x16x32_bf16 v[224:227], a[208:211], a[80:83], v[224:227]
    ds_read_b64_tr_b16 a[230:231], v42 offset:38912
    v_cvt_pk_bf16_f32 v145, v146, v147
    v_mfma_f32_16x16x32_bf16 v[224:227], a[212:215], a[92:95], v[224:227]
    s_waitcnt lgkmcnt(4)
    buffer_load_dwordx4 v54, s[8:11], s29 offen offset:1024 lds
    v_cvt_pk_bf16_f32 v146, v148, v149
    v_mfma_f32_16x16x32_bf16 v[224:227], a[216:219], a[104:107], v[224:227]
    ds_read_b64_tr_b16 a[232:233], v42 offset:40960
    v_cvt_pk_bf16_f32 v147, v150, v151
    v_mfma_f32_16x16x32_bf16 v[224:227], a[220:223], a[116:119], v[224:227]
    ds_read_b64_tr_b16 a[234:235], v42 offset:43008
    v_mul_f32 v208, s34, v208
    v_mfma_f32_16x16x32_bf16 v[160:163], a[220:223], a[112:115], v[160:163]
    buffer_load_dwordx4 v55, s[8:11], s29 offen offset:2048 lds
    v_mul_f32 v209, s34, v209
    v_mfma_f32_16x16x32_bf16 v[160:163], a[216:219], a[100:103], v[160:163]
    ds_read_b64_tr_b16 a[236:237], v42 offset:45056
    v_mul_f32 v210, s34, v210
    v_mfma_f32_16x16x32_bf16 v[96:99], a[216:219], a[96:99], v[96:99]
    ds_read_b64_tr_b16 a[238:239], v42 offset:47104
    v_mul_f32 v211, s34, v211
    v_mfma_f32_16x16x32_bf16 v[96:99], a[220:223], a[108:111], v[96:99]
    s_waitcnt lgkmcnt(4)
    buffer_load_dwordx4 v56, s[8:11], s29 offen offset:3072 lds
    v_mul_f32 v212, s34, v212
    v_mfma_f32_16x16x32_bf16 v[100:103], a[224:227], a[72:75], v[100:103]
    ds_read_b64_tr_b16 a[192:193], v43 offset:32768
    v_xor_b32 v53, 0, v57
    v_mfma_f32_16x16x32_bf16 v[100:103], a[228:231], a[84:87], v[100:103]
    ds_read_b64_tr_b16 a[194:195], v43 offset:34816
    v_add_u32 v53, v63, v53
    v_mul_f32 v213, s34, v213
    v_mfma_f32_16x16x32_bf16 v[164:167], a[228:231], a[88:91], v[164:167]
    v_xor_b32 v54, 64, v57
    v_add_u32 v54, v63, v54
    v_mfma_f32_16x16x32_bf16 v[164:167], a[224:227], a[76:79], v[164:167]
    ds_read_b64_tr_b16 a[196:197], v43 offset:36864
    v_add_u32 v54, 768, v54
    v_mul_f32 v214, s34, v214
    v_mfma_f32_16x16x32_bf16 v[228:231], a[224:227], a[80:83], v[228:231]
    ds_read_b64_tr_b16 a[198:199], v43 offset:38912
    v_xor_b32 v55, 128, v57
    v_mfma_f32_16x16x32_bf16 v[228:231], a[228:231], a[92:95], v[228:231]
    s_waitcnt lgkmcnt(4)
    v_add_u32 v55, v63, v55
    v_add_u32 v55, 1536, v55
    v_mul_f32 v215, s34, v215
    v_mfma_f32_16x16x32_bf16 v[228:231], a[232:235], a[104:107], v[228:231]
    ds_read_b64_tr_b16 a[200:201], v43 offset:40960
    v_xor_b32 v56, 192, v57
    v_mfma_f32_16x16x32_bf16 v[228:231], a[236:239], a[116:119], v[228:231]
    ds_read_b64_tr_b16 a[202:203], v43 offset:43008
    v_add_u32 v56, v63, v56
    v_cvt_pk_bf16_f32 v208, v208, v209
    v_mfma_f32_16x16x32_bf16 v[164:167], a[236:239], a[112:115], v[164:167]
    v_add_u32 v56, 2304, v56
    v_cvt_pk_bf16_f32 v209, v210, v211
    v_mfma_f32_16x16x32_bf16 v[164:167], a[232:235], a[100:103], v[164:167]
    ds_read_b64_tr_b16 a[204:205], v43 offset:45056
    v_cvt_pk_bf16_f32 v210, v212, v213
    v_mfma_f32_16x16x32_bf16 v[100:103], a[232:235], a[96:99], v[100:103]
    ds_read_b64_tr_b16 a[206:207], v43 offset:47104
    v_cvt_pk_bf16_f32 v211, v214, v215
    v_mfma_f32_16x16x32_bf16 v[100:103], a[236:239], a[108:111], v[100:103]
    s_waitcnt lgkmcnt(4)
    v_permlane16_swap_b32 v81, v83
    v_mfma_f32_16x16x32_bf16 v[104:107], a[192:195], a[72:75], v[104:107]
    ds_read_b64_tr_b16 a[208:209], v44 offset:32768
    v_mul_f32 v88, s34, v88
    v_mfma_f32_16x16x32_bf16 v[104:107], a[196:199], a[84:87], v[104:107]
    ds_read_b64_tr_b16 a[210:211], v44 offset:34816
    v_mul_f32 v89, s34, v89
    v_mfma_f32_16x16x32_bf16 v[168:171], a[196:199], a[88:91], v[168:171]
    v_permlane16_swap_b32 v144, v146
    v_mfma_f32_16x16x32_bf16 v[168:171], a[192:195], a[76:79], v[168:171]
    ds_read_b64_tr_b16 a[212:213], v44 offset:36864
    v_mul_f32 v90, s34, v90
    v_mfma_f32_16x16x32_bf16 v[232:235], a[192:195], a[80:83], v[232:235]
    ds_read_b64_tr_b16 a[214:215], v44 offset:38912
    v_mul_f32 v91, s34, v91
    v_mfma_f32_16x16x32_bf16 v[232:235], a[196:199], a[92:95], v[232:235]
    s_waitcnt lgkmcnt(4)
    v_permlane16_swap_b32 v145, v147
    v_mfma_f32_16x16x32_bf16 v[232:235], a[200:203], a[104:107], v[232:235]
    ds_read_b64_tr_b16 a[216:217], v44 offset:40960
    v_mul_f32 v92, s34, v92
    v_mfma_f32_16x16x32_bf16 v[232:235], a[204:207], a[116:119], v[232:235]
    ds_read_b64_tr_b16 a[218:219], v44 offset:43008
    v_mul_f32 v93, s34, v93
    v_mfma_f32_16x16x32_bf16 v[168:171], a[204:207], a[112:115], v[168:171]
    v_permlane16_swap_b32 v208, v210
    v_mfma_f32_16x16x32_bf16 v[168:171], a[200:203], a[100:103], v[168:171]
    ds_read_b64_tr_b16 a[220:221], v44 offset:45056
    v_mul_f32 v94, s34, v94
    v_mfma_f32_16x16x32_bf16 v[104:107], a[200:203], a[96:99], v[104:107]
    ds_read_b64_tr_b16 a[222:223], v44 offset:47104
    v_mul_f32 v95, s34, v95
    v_mfma_f32_16x16x32_bf16 v[104:107], a[204:207], a[108:111], v[104:107]
    s_waitcnt lgkmcnt(4)
    s_waitcnt vmcnt(16)
    s_barrier
    v_mfma_f32_16x16x32_bf16 v[108:111], a[208:211], a[72:75], v[108:111]
    s_add_u32 m0, s28, 65536
    ds_read_b64_tr_b16 a[224:225], v45 offset:0
    v_cvt_pk_bf16_f32 v88, v88, v89
    v_mfma_f32_16x16x32_bf16 v[108:111], a[212:215], a[84:87], v[108:111]
    s_xor_b32 s29, s61, 3072
    ds_read_b64_tr_b16 a[226:227], v45 offset:2048
    v_cvt_pk_bf16_f32 v89, v90, v91
    v_mfma_f32_16x16x32_bf16 v[172:175], a[212:215], a[88:91], v[172:175]
    buffer_load_dwordx4 v49, s[12:15], s29 offen nt lds
    v_cvt_pk_bf16_f32 v90, v92, v93
    v_mfma_f32_16x16x32_bf16 v[172:175], a[208:211], a[76:79], v[172:175]
    ds_read_b64_tr_b16 a[228:229], v45 offset:4096
    v_cvt_pk_bf16_f32 v91, v94, v95
    v_mfma_f32_16x16x32_bf16 v[236:239], a[208:211], a[80:83], v[236:239]
    ds_read_b64_tr_b16 a[230:231], v45 offset:6144
    v_mul_f32 v152, s34, v152
    v_mfma_f32_16x16x32_bf16 v[236:239], a[212:215], a[92:95], v[236:239]
    s_waitcnt lgkmcnt(4)
    buffer_load_dwordx4 v50, s[12:15], s29 offen offset:1024 nt lds
    v_mul_f32 v153, s34, v153
    v_mfma_f32_16x16x32_bf16 v[236:239], a[216:219], a[104:107], v[236:239]
    ds_read_b64_tr_b16 a[232:233], v45 offset:8192
    v_mul_f32 v154, s34, v154
    v_mfma_f32_16x16x32_bf16 v[236:239], a[220:223], a[116:119], v[236:239]
    ds_read_b64_tr_b16 a[234:235], v45 offset:10240
    v_mul_f32 v155, s34, v155
    v_mfma_f32_16x16x32_bf16 v[172:175], a[220:223], a[112:115], v[172:175]
    buffer_load_dwordx4 v51, s[12:15], s29 offen offset:2048 nt lds
    v_mul_f32 v156, s34, v156
    v_mfma_f32_16x16x32_bf16 v[172:175], a[216:219], a[100:103], v[172:175]
    ds_read_b64_tr_b16 a[236:237], v45 offset:12288
    v_mul_f32 v157, s34, v157
    v_mfma_f32_16x16x32_bf16 v[108:111], a[216:219], a[96:99], v[108:111]
    ds_read_b64_tr_b16 a[238:239], v45 offset:14336
    v_mul_f32 v158, s34, v158
    v_mfma_f32_16x16x32_bf16 v[108:111], a[220:223], a[108:111], v[108:111]
    s_waitcnt lgkmcnt(4)
    buffer_load_dwordx4 v52, s[12:15], s29 offen offset:3072 nt lds
    v_mul_f32 v159, s34, v159
    v_mfma_f32_16x16x32_bf16 v[96:99], a[224:227], a[120:123], v[96:99]
    ds_read_b64_tr_b16 a[192:193], v46 offset:0
    v_cvt_pk_bf16_f32 v152, v152, v153
    v_mfma_f32_16x16x32_bf16 v[96:99], a[228:231], a[132:135], v[96:99]
    ds_read_b64_tr_b16 a[194:195], v46 offset:2048
    v_cvt_pk_bf16_f32 v153, v154, v155
    v_mfma_f32_16x16x32_bf16 v[160:163], a[228:231], a[136:139], v[160:163]
    v_permlane16_swap_b32 v209, v211
    v_mfma_f32_16x16x32_bf16 v[160:163], a[224:227], a[124:127], v[160:163]
    ds_read_b64_tr_b16 a[196:197], v46 offset:4096
    v_cvt_pk_bf16_f32 v154, v156, v157
    v_mfma_f32_16x16x32_bf16 v[224:227], a[224:227], a[128:131], v[224:227]
    ds_read_b64_tr_b16 a[198:199], v46 offset:6144
    v_cvt_pk_bf16_f32 v155, v158, v159
    v_mfma_f32_16x16x32_bf16 v[224:227], a[228:231], a[140:143], v[224:227]
    s_waitcnt lgkmcnt(4)
    v_permlane16_swap_b32 v88, v90
    v_mfma_f32_16x16x32_bf16 v[224:227], a[232:235], a[152:155], v[224:227]
    ds_read_b64_tr_b16 a[200:201], v46 offset:8192
    v_mul_f32 v216, s34, v216
    v_mfma_f32_16x16x32_bf16 v[224:227], a[236:239], a[164:167], v[224:227]
    ds_read_b64_tr_b16 a[202:203], v46 offset:10240
    v_mul_f32 v217, s34, v217
    v_mfma_f32_16x16x32_bf16 v[160:163], a[236:239], a[160:163], v[160:163]
    v_permlane16_swap_b32 v89, v91
    v_mfma_f32_16x16x32_bf16 v[160:163], a[232:235], a[148:151], v[160:163]
    ds_read_b64_tr_b16 a[204:205], v46 offset:12288
    v_mul_f32 v218, s34, v218
    v_mfma_f32_16x16x32_bf16 v[96:99], a[232:235], a[144:147], v[96:99]
    ds_read_b64_tr_b16 a[206:207], v46 offset:14336
    v_mul_f32 v219, s34, v219
    v_mfma_f32_16x16x32_bf16 v[96:99], a[236:239], a[156:159], v[96:99]
    s_waitcnt lgkmcnt(4)
    v_permlane16_swap_b32 v152, v154
    v_mfma_f32_16x16x32_bf16 v[100:103], a[192:195], a[120:123], v[100:103]
    ds_read_b64_tr_b16 a[208:209], v47 offset:0
    v_mul_f32 v220, s34, v220
    v_mfma_f32_16x16x32_bf16 v[100:103], a[196:199], a[132:135], v[100:103]
    ds_read_b64_tr_b16 a[210:211], v47 offset:2048
    v_mul_f32 v221, s34, v221
    v_mfma_f32_16x16x32_bf16 v[164:167], a[196:199], a[136:139], v[164:167]
    v_permlane16_swap_b32 v153, v155
    v_mfma_f32_16x16x32_bf16 v[164:167], a[192:195], a[124:127], v[164:167]
    ds_read_b64_tr_b16 a[212:213], v47 offset:4096
    v_mul_f32 v222, s34, v222
    v_mfma_f32_16x16x32_bf16 v[228:231], a[192:195], a[128:131], v[228:231]
    ds_read_b64_tr_b16 a[214:215], v47 offset:6144
    v_mul_f32 v223, s34, v223
    v_mfma_f32_16x16x32_bf16 v[228:231], a[196:199], a[140:143], v[228:231]
    s_waitcnt lgkmcnt(4)
    v_mfma_f32_16x16x32_bf16 v[228:231], a[200:203], a[152:155], v[228:231]
    ds_read_b64_tr_b16 a[216:217], v47 offset:8192
    v_cvt_pk_bf16_f32 v216, v216, v217
    v_mfma_f32_16x16x32_bf16 v[228:231], a[204:207], a[164:167], v[228:231]
    ds_read_b64_tr_b16 a[218:219], v47 offset:10240
    v_cvt_pk_bf16_f32 v217, v218, v219
    v_mfma_f32_16x16x32_bf16 v[164:167], a[204:207], a[160:163], v[164:167]
    v_mfma_f32_16x16x32_bf16 v[164:167], a[200:203], a[148:151], v[164:167]
    ds_read_b64_tr_b16 a[220:221], v47 offset:12288
    v_cvt_pk_bf16_f32 v218, v220, v221
    v_mfma_f32_16x16x32_bf16 v[100:103], a[200:203], a[144:147], v[100:103]
    ds_read_b64_tr_b16 a[222:223], v47 offset:14336
    v_cvt_pk_bf16_f32 v219, v222, v223
    v_mfma_f32_16x16x32_bf16 v[100:103], a[204:207], a[156:159], v[100:103]
    s_waitcnt lgkmcnt(4)
    v_permlane16_swap_b32 v216, v218
    v_mfma_f32_16x16x32_bf16 v[104:107], a[208:211], a[120:123], v[104:107]
    ds_read_b64_tr_b16 a[224:225], v48 offset:0
    v_mfma_f32_16x16x32_bf16 v[104:107], a[212:215], a[132:135], v[104:107]
    ds_read_b64_tr_b16 a[226:227], v48 offset:2048
    v_mfma_f32_16x16x32_bf16 v[168:171], a[212:215], a[136:139], v[168:171]
    v_permlane16_swap_b32 v217, v219
    v_mfma_f32_16x16x32_bf16 v[168:171], a[208:211], a[124:127], v[168:171]
    ds_read_b64_tr_b16 a[228:229], v48 offset:4096
    v_mul_f32 v96, s34, v96
    v_mfma_f32_16x16x32_bf16 v[232:235], a[208:211], a[128:131], v[232:235]
    ds_read_b64_tr_b16 a[230:231], v48 offset:6144
    v_mul_f32 v97, s34, v97
    v_mfma_f32_16x16x32_bf16 v[232:235], a[212:215], a[140:143], v[232:235]
    s_waitcnt lgkmcnt(4)
    v_mfma_f32_16x16x32_bf16 v[232:235], a[216:219], a[152:155], v[232:235]
    ds_read_b64_tr_b16 a[232:233], v48 offset:8192
    v_mul_f32 v98, s34, v98
    v_mfma_f32_16x16x32_bf16 v[232:235], a[220:223], a[164:167], v[232:235]
    ds_read_b64_tr_b16 a[234:235], v48 offset:10240
    v_mul_f32 v99, s34, v99
    v_mfma_f32_16x16x32_bf16 v[168:171], a[220:223], a[160:163], v[168:171]
    v_mfma_f32_16x16x32_bf16 v[168:171], a[216:219], a[148:151], v[168:171]
    ds_read_b64_tr_b16 a[236:237], v48 offset:12288
    v_mul_f32 v100, s34, v100
    v_mfma_f32_16x16x32_bf16 v[104:107], a[216:219], a[144:147], v[104:107]
    ds_read_b64_tr_b16 a[238:239], v48 offset:14336
    v_mul_f32 v101, s34, v101
    v_mfma_f32_16x16x32_bf16 v[104:107], a[220:223], a[156:159], v[104:107]
    s_waitcnt lgkmcnt(4)
    s_waitcnt vmcnt(12)
    s_barrier
    v_mfma_f32_16x16x32_bf16 v[108:111], a[224:227], a[120:123], v[108:111]
    ds_read_b64_tr_b16 a[192:193], v37 offset:16384
    v_mul_f32 v102, s34, v102
    v_mfma_f32_16x16x32_bf16 v[108:111], a[228:231], a[132:135], v[108:111]
    ds_read_b64_tr_b16 a[194:195], v37 offset:18432
    v_mul_f32 v103, s34, v103
    v_mfma_f32_16x16x32_bf16 v[172:175], a[228:231], a[136:139], v[172:175]
    v_mfma_f32_16x16x32_bf16 v[172:175], a[224:227], a[124:127], v[172:175]
    ds_read_b64_tr_b16 a[196:197], v37 offset:20480
    v_cvt_pk_bf16_f32 v96, v96, v97
    v_mfma_f32_16x16x32_bf16 v[236:239], a[224:227], a[128:131], v[236:239]
    ds_read_b64_tr_b16 a[198:199], v37 offset:22528
    v_cvt_pk_bf16_f32 v97, v98, v99
    v_mfma_f32_16x16x32_bf16 v[236:239], a[228:231], a[140:143], v[236:239]
    s_waitcnt lgkmcnt(4)
    v_mfma_f32_16x16x32_bf16 v[236:239], a[232:235], a[152:155], v[236:239]
    s_add_u32 m0, s28, 98304
    ds_read_b64_tr_b16 a[200:201], v37 offset:24576
    v_cvt_pk_bf16_f32 v98, v100, v101
    v_mfma_f32_16x16x32_bf16 v[236:239], a[236:239], a[164:167], v[236:239]
    s_xor_b32 s29, s61, 2048
    ds_read_b64_tr_b16 a[202:203], v37 offset:26624
    v_cvt_pk_bf16_f32 v99, v102, v103
    v_mfma_f32_16x16x32_bf16 v[172:175], a[236:239], a[160:163], v[172:175]
    buffer_load_dwordx4 v49, s[16:19], s29 offen nt lds
    v_mul_f32 v160, s34, v160
    v_mfma_f32_16x16x32_bf16 v[172:175], a[232:235], a[148:151], v[172:175]
    ds_read_b64_tr_b16 a[204:205], v37 offset:28672
    v_mul_f32 v161, s34, v161
    v_mfma_f32_16x16x32_bf16 v[108:111], a[232:235], a[144:147], v[108:111]
    ds_read_b64_tr_b16 a[206:207], v37 offset:30720
    v_mul_f32 v162, s34, v162
    v_mfma_f32_16x16x32_bf16 v[108:111], a[236:239], a[156:159], v[108:111]
    s_waitcnt lgkmcnt(4)
    buffer_load_dwordx4 v50, s[16:19], s29 offen offset:1024 nt lds
    v_mul_f32 v163, s34, v163
    v_mfma_f32_16x16x32_bf16 v[112:115], a[192:195], a[72:75], v[112:115]
    ds_read_b64_tr_b16 a[208:209], v38 offset:16384
    v_mul_f32 v164, s34, v164
    v_mfma_f32_16x16x32_bf16 v[112:115], a[196:199], a[84:87], v[112:115]
    ds_read_b64_tr_b16 a[210:211], v38 offset:18432
    v_mul_f32 v165, s34, v165
    v_mfma_f32_16x16x32_bf16 v[176:179], a[196:199], a[88:91], v[176:179]
    buffer_load_dwordx4 v51, s[16:19], s29 offen offset:2048 nt lds
    v_mul_f32 v166, s34, v166
    v_mfma_f32_16x16x32_bf16 v[176:179], a[192:195], a[76:79], v[176:179]
    ds_read_b64_tr_b16 a[212:213], v38 offset:20480
    v_mul_f32 v167, s34, v167
    v_mfma_f32_16x16x32_bf16 v[240:243], a[192:195], a[80:83], v[240:243]
    ds_read_b64_tr_b16 a[214:215], v38 offset:22528
    v_cvt_pk_bf16_f32 v160, v160, v161
    v_mfma_f32_16x16x32_bf16 v[240:243], a[196:199], a[92:95], v[240:243]
    s_waitcnt lgkmcnt(4)
    buffer_load_dwordx4 v52, s[16:19], s29 offen offset:3072 nt lds
    v_cvt_pk_bf16_f32 v161, v162, v163
    v_mfma_f32_16x16x32_bf16 v[240:243], a[200:203], a[104:107], v[240:243]
    ds_read_b64_tr_b16 a[216:217], v38 offset:24576
    v_cvt_pk_bf16_f32 v162, v164, v165
    v_mfma_f32_16x16x32_bf16 v[240:243], a[204:207], a[116:119], v[240:243]
    ds_read_b64_tr_b16 a[218:219], v38 offset:26624
    v_cvt_pk_bf16_f32 v163, v166, v167
    v_mfma_f32_16x16x32_bf16 v[176:179], a[204:207], a[112:115], v[176:179]
    v_permlane16_swap_b32 v96, v98
    v_mfma_f32_16x16x32_bf16 v[176:179], a[200:203], a[100:103], v[176:179]
    ds_read_b64_tr_b16 a[220:221], v38 offset:28672
    v_mul_f32 v224, s34, v224
    v_mfma_f32_16x16x32_bf16 v[112:115], a[200:203], a[96:99], v[112:115]
    ds_read_b64_tr_b16 a[222:223], v38 offset:30720
    v_mul_f32 v225, s34, v225
    v_mfma_f32_16x16x32_bf16 v[112:115], a[204:207], a[108:111], v[112:115]
    s_waitcnt lgkmcnt(4)
    v_permlane16_swap_b32 v97, v99
    v_mfma_f32_16x16x32_bf16 v[116:119], a[208:211], a[72:75], v[116:119]
    ds_read_b64_tr_b16 a[224:225], v39 offset:16384
    v_mul_f32 v226, s34, v226
    v_mfma_f32_16x16x32_bf16 v[116:119], a[212:215], a[84:87], v[116:119]
    ds_read_b64_tr_b16 a[226:227], v39 offset:18432
    v_mul_f32 v227, s34, v227
    v_mfma_f32_16x16x32_bf16 v[180:183], a[212:215], a[88:91], v[180:183]
    v_permlane16_swap_b32 v160, v162
    v_mfma_f32_16x16x32_bf16 v[180:183], a[208:211], a[76:79], v[180:183]
    ds_read_b64_tr_b16 a[228:229], v39 offset:20480
    v_mul_f32 v228, s34, v228
    v_mfma_f32_16x16x32_bf16 v[244:247], a[208:211], a[80:83], v[244:247]
    ds_read_b64_tr_b16 a[230:231], v39 offset:22528
    v_mul_f32 v229, s34, v229
    v_mfma_f32_16x16x32_bf16 v[244:247], a[212:215], a[92:95], v[244:247]
    s_waitcnt lgkmcnt(4)
    v_permlane16_swap_b32 v161, v163
    v_mfma_f32_16x16x32_bf16 v[244:247], a[216:219], a[104:107], v[244:247]
    ds_read_b64_tr_b16 a[232:233], v39 offset:24576
    v_mul_f32 v230, s34, v230
    v_mfma_f32_16x16x32_bf16 v[244:247], a[220:223], a[116:119], v[244:247]
    ds_read_b64_tr_b16 a[234:235], v39 offset:26624
    v_mul_f32 v231, s34, v231
    v_mfma_f32_16x16x32_bf16 v[180:183], a[220:223], a[112:115], v[180:183]
    v_mfma_f32_16x16x32_bf16 v[180:183], a[216:219], a[100:103], v[180:183]
    ds_read_b64_tr_b16 a[236:237], v39 offset:28672
    v_cvt_pk_bf16_f32 v224, v224, v225
    v_mfma_f32_16x16x32_bf16 v[116:119], a[216:219], a[96:99], v[116:119]
    ds_read_b64_tr_b16 a[238:239], v39 offset:30720
    v_cvt_pk_bf16_f32 v225, v226, v227
    v_mfma_f32_16x16x32_bf16 v[116:119], a[220:223], a[108:111], v[116:119]
    s_waitcnt lgkmcnt(4)
    v_mfma_f32_16x16x32_bf16 v[120:123], a[224:227], a[72:75], v[120:123]
    ds_read_b64_tr_b16 a[192:193], v40 offset:16384
    v_cvt_pk_bf16_f32 v226, v228, v229
    v_mfma_f32_16x16x32_bf16 v[120:123], a[228:231], a[84:87], v[120:123]
    ds_read_b64_tr_b16 a[194:195], v40 offset:18432
    v_cvt_pk_bf16_f32 v227, v230, v231
    v_mfma_f32_16x16x32_bf16 v[184:187], a[228:231], a[88:91], v[184:187]
    v_permlane16_swap_b32 v224, v226
    v_mfma_f32_16x16x32_bf16 v[184:187], a[224:227], a[76:79], v[184:187]
    ds_read_b64_tr_b16 a[196:197], v40 offset:20480
    v_mul_f32 v104, s34, v104
    v_mfma_f32_16x16x32_bf16 v[248:251], a[224:227], a[80:83], v[248:251]
    ds_read_b64_tr_b16 a[198:199], v40 offset:22528
    v_mul_f32 v105, s34, v105
    v_mfma_f32_16x16x32_bf16 v[248:251], a[228:231], a[92:95], v[248:251]
    s_waitcnt lgkmcnt(4)
    v_permlane16_swap_b32 v225, v227
    v_mfma_f32_16x16x32_bf16 v[248:251], a[232:235], a[104:107], v[248:251]
    ds_read_b64_tr_b16 a[200:201], v40 offset:24576
    v_mul_f32 v106, s34, v106
    v_mfma_f32_16x16x32_bf16 v[248:251], a[236:239], a[116:119], v[248:251]
    ds_read_b64_tr_b16 a[202:203], v40 offset:26624
    v_mul_f32 v107, s34, v107
    v_mfma_f32_16x16x32_bf16 v[184:187], a[236:239], a[112:115], v[184:187]
    v_mfma_f32_16x16x32_bf16 v[184:187], a[232:235], a[100:103], v[184:187]
    ds_read_b64_tr_b16 a[204:205], v40 offset:28672
    v_mul_f32 v108, s34, v108
    v_mfma_f32_16x16x32_bf16 v[120:123], a[232:235], a[96:99], v[120:123]
    ds_read_b64_tr_b16 a[206:207], v40 offset:30720
    v_mul_f32 v109, s34, v109
    v_mfma_f32_16x16x32_bf16 v[120:123], a[236:239], a[108:111], v[120:123]
    s_waitcnt lgkmcnt(4)
    s_waitcnt vmcnt(8)
    s_barrier
    v_mfma_f32_16x16x32_bf16 v[124:127], a[192:195], a[72:75], v[124:127]
    ds_read_b64_tr_b16 a[208:209], v37 offset:49152
    v_mul_f32 v110, s34, v110
    v_mfma_f32_16x16x32_bf16 v[124:127], a[196:199], a[84:87], v[124:127]
    ds_read_b64_tr_b16 a[210:211], v37 offset:51200
    v_mul_f32 v111, s34, v111
    v_mfma_f32_16x16x32_bf16 v[188:191], a[196:199], a[88:91], v[188:191]
    v_mfma_f32_16x16x32_bf16 v[188:191], a[192:195], a[76:79], v[188:191]
    ds_read_b64_tr_b16 a[212:213], v37 offset:53248
    v_cvt_pk_bf16_f32 v104, v104, v105
    v_mfma_f32_16x16x32_bf16 v[252:255], a[192:195], a[80:83], v[252:255]
    ds_read_b64_tr_b16 a[214:215], v37 offset:55296
    v_cvt_pk_bf16_f32 v105, v106, v107
    v_mfma_f32_16x16x32_bf16 v[252:255], a[196:199], a[92:95], v[252:255]
    s_waitcnt lgkmcnt(4)
    v_mfma_f32_16x16x32_bf16 v[252:255], a[200:203], a[104:107], v[252:255]
    ds_read_b64_tr_b16 a[216:217], v37 offset:57344
    v_cvt_pk_bf16_f32 v106, v108, v109
    v_mfma_f32_16x16x32_bf16 v[252:255], a[204:207], a[116:119], v[252:255]
    ds_read_b64_tr_b16 a[218:219], v37 offset:59392
    v_cvt_pk_bf16_f32 v107, v110, v111
    v_mfma_f32_16x16x32_bf16 v[188:191], a[204:207], a[112:115], v[188:191]
    v_permlane16_swap_b32 v104, v106
    v_mfma_f32_16x16x32_bf16 v[188:191], a[200:203], a[100:103], v[188:191]
    ds_read_b64_tr_b16 a[220:221], v37 offset:61440
    v_mul_f32 v168, s34, v168
    v_mfma_f32_16x16x32_bf16 v[124:127], a[200:203], a[96:99], v[124:127]
    ds_read_b64_tr_b16 a[222:223], v37 offset:63488
    v_mul_f32 v169, s34, v169
    v_mfma_f32_16x16x32_bf16 v[124:127], a[204:207], a[108:111], v[124:127]
    s_waitcnt lgkmcnt(4)
    v_permlane16_swap_b32 v105, v107
    v_mfma_f32_16x16x32_bf16 v[112:115], a[208:211], a[120:123], v[112:115]
    s_add_u32 m0, s28, 131072
    ds_read_b64_tr_b16 a[224:225], v38 offset:49152
    v_mul_f32 v170, s34, v170
    v_mfma_f32_16x16x32_bf16 v[112:115], a[212:215], a[132:135], v[112:115]
    s_xor_b32 s29, s61, 4096
    ds_read_b64_tr_b16 a[226:227], v38 offset:51200
    v_mul_f32 v171, s34, v171
    v_mfma_f32_16x16x32_bf16 v[176:179], a[212:215], a[136:139], v[176:179]
    buffer_load_dwordx4 v49, s[12:15], s29 offen nt lds
    v_mul_f32 v172, s34, v172
    v_mfma_f32_16x16x32_bf16 v[176:179], a[208:211], a[124:127], v[176:179]
    ds_read_b64_tr_b16 a[228:229], v38 offset:53248
    v_mul_f32 v173, s34, v173
    v_mfma_f32_16x16x32_bf16 v[240:243], a[208:211], a[128:131], v[240:243]
    ds_read_b64_tr_b16 a[230:231], v38 offset:55296
    v_mul_f32 v174, s34, v174
    v_mfma_f32_16x16x32_bf16 v[240:243], a[212:215], a[140:143], v[240:243]
    s_waitcnt lgkmcnt(4)
    buffer_load_dwordx4 v50, s[12:15], s29 offen offset:1024 nt lds
    v_mul_f32 v175, s34, v175
    v_mfma_f32_16x16x32_bf16 v[240:243], a[216:219], a[152:155], v[240:243]
    ds_read_b64_tr_b16 a[232:233], v38 offset:57344
    v_cvt_pk_bf16_f32 v168, v168, v169
    v_mfma_f32_16x16x32_bf16 v[240:243], a[220:223], a[164:167], v[240:243]
    ds_read_b64_tr_b16 a[234:235], v38 offset:59392
    v_cvt_pk_bf16_f32 v169, v170, v171
    v_mfma_f32_16x16x32_bf16 v[176:179], a[220:223], a[160:163], v[176:179]
    buffer_load_dwordx4 v51, s[12:15], s29 offen offset:2048 nt lds
    v_cvt_pk_bf16_f32 v170, v172, v173
    v_mfma_f32_16x16x32_bf16 v[176:179], a[216:219], a[148:151], v[176:179]
    ds_read_b64_tr_b16 a[236:237], v38 offset:61440
    v_cvt_pk_bf16_f32 v171, v174, v175
    v_mfma_f32_16x16x32_bf16 v[112:115], a[216:219], a[144:147], v[112:115]
    ds_read_b64_tr_b16 a[238:239], v38 offset:63488
    v_mul_f32 v232, s34, v232
    v_mfma_f32_16x16x32_bf16 v[112:115], a[220:223], a[156:159], v[112:115]
    s_waitcnt lgkmcnt(4)
    buffer_load_dwordx4 v52, s[12:15], s29 offen offset:3072 nt lds
    v_mul_f32 v233, s34, v233
    v_mfma_f32_16x16x32_bf16 v[116:119], a[224:227], a[120:123], v[116:119]
    ds_read_b64_tr_b16 a[192:193], v39 offset:49152
    v_mul_f32 v234, s34, v234
    v_mfma_f32_16x16x32_bf16 v[116:119], a[228:231], a[132:135], v[116:119]
    ds_read_b64_tr_b16 a[194:195], v39 offset:51200
    v_mul_f32 v235, s34, v235
    v_mfma_f32_16x16x32_bf16 v[180:183], a[228:231], a[136:139], v[180:183]
    v_permlane16_swap_b32 v168, v170
    v_mfma_f32_16x16x32_bf16 v[180:183], a[224:227], a[124:127], v[180:183]
    ds_read_b64_tr_b16 a[196:197], v39 offset:53248
    v_mul_f32 v236, s34, v236
    v_mfma_f32_16x16x32_bf16 v[244:247], a[224:227], a[128:131], v[244:247]
    ds_read_b64_tr_b16 a[198:199], v39 offset:55296
    v_mul_f32 v237, s34, v237
    v_mfma_f32_16x16x32_bf16 v[244:247], a[228:231], a[140:143], v[244:247]
    s_waitcnt lgkmcnt(4)
    v_permlane16_swap_b32 v169, v171
    v_mfma_f32_16x16x32_bf16 v[244:247], a[232:235], a[152:155], v[244:247]
    ds_read_b64_tr_b16 a[200:201], v39 offset:57344
    v_mul_f32 v238, s34, v238
    v_mfma_f32_16x16x32_bf16 v[244:247], a[236:239], a[164:167], v[244:247]
    ds_read_b64_tr_b16 a[202:203], v39 offset:59392
    v_mul_f32 v239, s34, v239
    v_mfma_f32_16x16x32_bf16 v[180:183], a[236:239], a[160:163], v[180:183]
    v_mfma_f32_16x16x32_bf16 v[180:183], a[232:235], a[148:151], v[180:183]
    ds_read_b64_tr_b16 a[204:205], v39 offset:61440
    v_cvt_pk_bf16_f32 v232, v232, v233
    v_mfma_f32_16x16x32_bf16 v[116:119], a[232:235], a[144:147], v[116:119]
    ds_read_b64_tr_b16 a[206:207], v39 offset:63488
    v_cvt_pk_bf16_f32 v233, v234, v235
    v_mfma_f32_16x16x32_bf16 v[116:119], a[236:239], a[156:159], v[116:119]
    s_waitcnt lgkmcnt(4)
    v_mfma_f32_16x16x32_bf16 v[120:123], a[192:195], a[120:123], v[120:123]
    ds_read_b64_tr_b16 a[208:209], v40 offset:49152
    v_cvt_pk_bf16_f32 v234, v236, v237
    v_mfma_f32_16x16x32_bf16 v[120:123], a[196:199], a[132:135], v[120:123]
    ds_read_b64_tr_b16 a[210:211], v40 offset:51200
    v_cvt_pk_bf16_f32 v235, v238, v239
    v_mfma_f32_16x16x32_bf16 v[184:187], a[196:199], a[136:139], v[184:187]
    v_permlane16_swap_b32 v232, v234
    v_mfma_f32_16x16x32_bf16 v[184:187], a[192:195], a[124:127], v[184:187]
    ds_read_b64_tr_b16 a[212:213], v40 offset:53248
    v_mul_f32 v112, s34, v112
    v_mfma_f32_16x16x32_bf16 v[248:251], a[192:195], a[128:131], v[248:251]
    ds_read_b64_tr_b16 a[214:215], v40 offset:55296
    v_mul_f32 v113, s34, v113
    v_mfma_f32_16x16x32_bf16 v[248:251], a[196:199], a[140:143], v[248:251]
    s_waitcnt lgkmcnt(4)
    v_permlane16_swap_b32 v233, v235
    v_mfma_f32_16x16x32_bf16 v[248:251], a[200:203], a[152:155], v[248:251]
    ds_read_b64_tr_b16 a[216:217], v40 offset:57344
    v_mul_f32 v114, s34, v114
    v_mfma_f32_16x16x32_bf16 v[248:251], a[204:207], a[164:167], v[248:251]
    ds_read_b64_tr_b16 a[218:219], v40 offset:59392
    v_mul_f32 v115, s34, v115
    v_mfma_f32_16x16x32_bf16 v[184:187], a[204:207], a[160:163], v[184:187]
    v_mfma_f32_16x16x32_bf16 v[184:187], a[200:203], a[148:151], v[184:187]
    ds_read_b64_tr_b16 a[220:221], v40 offset:61440
    v_mul_f32 v116, s34, v116
    v_mfma_f32_16x16x32_bf16 v[120:123], a[200:203], a[144:147], v[120:123]
    ds_read_b64_tr_b16 a[222:223], v40 offset:63488
    v_mul_f32 v117, s34, v117
    v_mfma_f32_16x16x32_bf16 v[120:123], a[204:207], a[156:159], v[120:123]
    s_waitcnt lgkmcnt(4)
    s_waitcnt vmcnt(48)
    s_barrier
    v_mfma_f32_16x16x32_bf16 v[124:127], a[208:211], a[120:123], v[124:127]
    ds_read_b128 a[224:227], v29 offset:49152
    v_mul_f32 v118, s34, v118
    v_mfma_f32_16x16x32_bf16 v[124:127], a[212:215], a[132:135], v[124:127]
    v_mul_f32 v119, s34, v119
    v_cvt_pk_bf16_f32 v112, v112, v113
    v_mfma_f32_16x16x32_bf16 v[188:191], a[212:215], a[136:139], v[188:191]
    v_cvt_pk_bf16_f32 v113, v114, v115
    v_cvt_pk_bf16_f32 v114, v116, v117
    v_mfma_f32_16x16x32_bf16 v[188:191], a[208:211], a[124:127], v[188:191]
    ds_read_b128 a[228:231], v30 offset:49152
    v_cvt_pk_bf16_f32 v115, v118, v119
    v_mfma_f32_16x16x32_bf16 v[252:255], a[208:211], a[128:131], v[252:255]
    v_permlane16_swap_b32 v112, v114
    v_mfma_f32_16x16x32_bf16 v[252:255], a[212:215], a[140:143], v[252:255]
    s_waitcnt lgkmcnt(2)
    v_permlane16_swap_b32 v113, v115
    v_mul_f32 v176, s34, v176
    v_mfma_f32_16x16x32_bf16 v[252:255], a[216:219], a[152:155], v[252:255]
    ds_read_b128 a[232:235], v29 offset:57344
    v_mul_f32 v177, s34, v177
    v_mfma_f32_16x16x32_bf16 v[252:255], a[220:223], a[164:167], v[252:255]
    v_mul_f32 v178, s34, v178
    v_mul_f32 v179, s34, v179
    v_mfma_f32_16x16x32_bf16 v[188:191], a[220:223], a[160:163], v[188:191]
    v_mul_f32 v180, s34, v180
    v_mul_f32 v181, s34, v181
    v_mfma_f32_16x16x32_bf16 v[188:191], a[216:219], a[148:151], v[188:191]
    ds_read_b128 a[236:239], v30 offset:57344
    v_mul_f32 v182, s34, v182
    v_mfma_f32_16x16x32_bf16 v[124:127], a[216:219], a[144:147], v[124:127]
    v_mul_f32 v183, s34, v183
    v_cvt_pk_bf16_f32 v176, v176, v177
    v_mfma_f32_16x16x32_bf16 v[124:127], a[220:223], a[156:159], v[124:127]
    s_waitcnt lgkmcnt(2)
    v_cvt_pk_bf16_f32 v177, v178, v179
    v_cvt_pk_bf16_f32 v178, v180, v181
    v_mfma_f32_16x16x32_bf16 v[68:71], a[224:227], v[64:67], 0
    ds_read_b128 a[192:195], v31 offset:49152
    v_cvt_pk_bf16_f32 v179, v182, v183
    v_mfma_f32_16x16x32_bf16 v[68:71], a[228:231], v[72:75], v[68:71]
    v_permlane16_swap_b32 v176, v178
    v_mfma_f32_16x16x32_bf16 v[132:135], a[228:231], v[136:139], 0
    v_permlane16_swap_b32 v177, v179
    v_mul_f32 v240, s34, v240
    v_mfma_f32_16x16x32_bf16 v[132:135], a[224:227], v[128:131], v[132:135]
    ds_read_b128 a[196:199], v32 offset:49152
    v_mul_f32 v241, s34, v241
    v_mfma_f32_16x16x32_bf16 v[196:199], a[224:227], v[192:195], 0
    v_mul_f32 v242, s34, v242
    v_mul_f32 v243, s34, v243
    v_mfma_f32_16x16x32_bf16 v[196:199], a[228:231], v[200:203], v[196:199]
    s_waitcnt lgkmcnt(2)
    v_mul_f32 v244, s34, v244
    v_mul_f32 v245, s34, v245
    v_mfma_f32_16x16x32_bf16 v[204:207], a[232:235], v[192:195], 0
    ds_read_b128 a[200:203], v31 offset:57344
    v_mul_f32 v246, s34, v246
    v_mfma_f32_16x16x32_bf16 v[204:207], a[236:239], v[200:203], v[204:207]
    v_mul_f32 v247, s34, v247
    v_cvt_pk_bf16_f32 v240, v240, v241
    v_mfma_f32_16x16x32_bf16 v[140:143], a[236:239], v[136:139], 0
    v_cvt_pk_bf16_f32 v241, v242, v243
    v_cvt_pk_bf16_f32 v242, v244, v245
    v_mfma_f32_16x16x32_bf16 v[140:143], a[232:235], v[128:131], v[140:143]
    s_add_u32 m0, s28, 16384
    ds_read_b128 a[204:207], v32 offset:57344
    v_cvt_pk_bf16_f32 v243, v246, v247
    v_mfma_f32_16x16x32_bf16 v[76:79], a[232:235], v[64:67], 0
    s_xor_b32 s29, s61, 3072
    v_permlane16_swap_b32 v240, v242
    v_mfma_f32_16x16x32_bf16 v[76:79], a[236:239], v[72:75], v[76:79]
    s_waitcnt lgkmcnt(2)
    buffer_load_dwordx4 v49, s[16:19], s29 offen nt lds
    v_mul_f32 v120, s34, v120
    v_mfma_f32_16x16x32_bf16 v[68:71], a[192:195], v[80:83], v[68:71]
    ds_read_b128 a[208:211], v29 offset:49408
    v_mul_f32 v121, s34, v121
    v_mfma_f32_16x16x32_bf16 v[68:71], a[196:199], v[88:91], v[68:71]
    v_permlane16_swap_b32 v241, v243
    v_mfma_f32_16x16x32_bf16 v[132:135], a[196:199], v[152:155], v[132:135]
    buffer_load_dwordx4 v50, s[16:19], s29 offen offset:1024 nt lds
    v_mul_f32 v122, s34, v122
    v_mfma_f32_16x16x32_bf16 v[132:135], a[192:195], v[144:147], v[132:135]
    ds_read_b128 a[212:215], v30 offset:49408
    v_mul_f32 v123, s34, v123
    v_mfma_f32_16x16x32_bf16 v[196:199], a[192:195], v[208:211], v[196:199]
    v_mul_f32 v124, s34, v124
    v_mul_f32 v125, s34, v125
    v_mfma_f32_16x16x32_bf16 v[196:199], a[196:199], v[216:219], v[196:199]
    s_waitcnt lgkmcnt(2)
    buffer_load_dwordx4 v51, s[16:19], s29 offen offset:2048 nt lds
    v_mul_f32 v126, s34, v126
    v_mfma_f32_16x16x32_bf16 v[204:207], a[200:203], v[208:211], v[204:207]
    ds_read_b128 a[216:219], v29 offset:57600
    v_mul_f32 v127, s34, v127
    v_mfma_f32_16x16x32_bf16 v[204:207], a[204:207], v[216:219], v[204:207]
    v_cvt_pk_bf16_f32 v120, v120, v121
    v_cvt_pk_bf16_f32 v121, v122, v123
    v_mfma_f32_16x16x32_bf16 v[140:143], a[204:207], v[152:155], v[140:143]
    buffer_load_dwordx4 v52, s[16:19], s29 offen offset:3072 nt lds
    v_cvt_pk_bf16_f32 v122, v124, v125
    v_mfma_f32_16x16x32_bf16 v[140:143], a[200:203], v[144:147], v[140:143]
    ds_read_b128 a[220:223], v30 offset:57600
    v_cvt_pk_bf16_f32 v123, v126, v127
    v_mfma_f32_16x16x32_bf16 v[76:79], a[200:203], v[80:83], v[76:79]
    v_permlane16_swap_b32 v120, v122
    v_mfma_f32_16x16x32_bf16 v[76:79], a[204:207], v[88:91], v[76:79]
    s_waitcnt lgkmcnt(2)
    v_permlane16_swap_b32 v121, v123
    v_mul_f32 v184, s34, v184
    v_mfma_f32_16x16x32_bf16 v[68:71], a[208:211], v[96:99], v[68:71]
    ds_read_b128 a[224:227], v31 offset:49408
    v_mul_f32 v185, s34, v185
    v_mfma_f32_16x16x32_bf16 v[68:71], a[212:215], v[104:107], v[68:71]
    v_mul_f32 v186, s34, v186
    v_mul_f32 v187, s34, v187
    v_mfma_f32_16x16x32_bf16 v[132:135], a[212:215], v[168:171], v[132:135]
    v_mul_f32 v188, s34, v188
    v_mul_f32 v189, s34, v189
    v_mfma_f32_16x16x32_bf16 v[132:135], a[208:211], v[160:163], v[132:135]
    ds_read_b128 a[228:231], v32 offset:49408
    v_mul_f32 v190, s34, v190
    v_mfma_f32_16x16x32_bf16 v[196:199], a[208:211], v[224:227], v[196:199]
    v_mul_f32 v191, s34, v191
    v_cvt_pk_bf16_f32 v184, v184, v185
    v_mfma_f32_16x16x32_bf16 v[196:199], a[212:215], v[232:235], v[196:199]
    s_waitcnt lgkmcnt(2)
    v_cvt_pk_bf16_f32 v185, v186, v187
    v_cvt_pk_bf16_f32 v186, v188, v189
    v_mfma_f32_16x16x32_bf16 v[204:207], a[216:219], v[224:227], v[204:207]
    ds_read_b128 a[232:235], v31 offset:57600
    v_cvt_pk_bf16_f32 v187, v190, v191
    v_mfma_f32_16x16x32_bf16 v[204:207], a[220:223], v[232:235], v[204:207]
    v_permlane16_swap_b32 v184, v186
    v_mfma_f32_16x16x32_bf16 v[140:143], a[220:223], v[168:171], v[140:143]
    v_permlane16_swap_b32 v185, v187
    v_mul_f32 v248, s34, v248
    v_mfma_f32_16x16x32_bf16 v[140:143], a[216:219], v[160:163], v[140:143]
    ds_read_b128 a[236:239], v32 offset:57600
    v_mul_f32 v249, s34, v249
    v_mfma_f32_16x16x32_bf16 v[76:79], a[216:219], v[96:99], v[76:79]
    v_mul_f32 v250, s34, v250
    v_mul_f32 v251, s34, v251
    v_mul_f32 v252, s34, v252
    v_mul_f32 v253, s34, v253
    v_mul_f32 v254, s34, v254
    v_mul_f32 v255, s34, v255
    v_cvt_pk_bf16_f32 v248, v248, v249
    v_cvt_pk_bf16_f32 v249, v250, v251
    v_cvt_pk_bf16_f32 v250, v252, v253
    v_cvt_pk_bf16_f32 v251, v254, v255
    v_mfma_f32_16x16x32_bf16 v[76:79], a[220:223], v[104:107], v[76:79]
    s_waitcnt lgkmcnt(2)
    s_waitcnt vmcnt(44)
    s_barrier
    v_mfma_f32_16x16x32_bf16 v[68:71], a[224:227], v[112:115], v[68:71]
    ds_read_b128 a[192:195], v29 offset:16384
    v_permlane16_swap_b32 v248, v250
    v_permlane16_swap_b32 v249, v251
    v_mfma_f32_16x16x32_bf16 v[68:71], a[228:231], v[120:123], v[68:71]
    v_mfma_f32_16x16x32_bf16 v[132:135], a[228:231], v[184:187], v[132:135]
    v_mfma_f32_16x16x32_bf16 v[132:135], a[224:227], v[176:179], v[132:135]
    ds_read_b128 a[196:199], v30 offset:16384
    v_mfma_f32_16x16x32_bf16 v[196:199], a[224:227], v[240:243], v[196:199]
    v_mfma_f32_16x16x32_bf16 v[196:199], a[228:231], v[248:251], v[196:199]
    s_waitcnt lgkmcnt(2)
    v_mfma_f32_16x16x32_bf16 v[204:207], a[232:235], v[240:243], v[204:207]
    ds_read_b128 a[200:203], v31 offset:16384
    v_mfma_f32_16x16x32_bf16 v[204:207], a[236:239], v[248:251], v[204:207]
    v_mfma_f32_16x16x32_bf16 v[140:143], a[236:239], v[184:187], v[140:143]
    v_mfma_f32_16x16x32_bf16 v[140:143], a[232:235], v[176:179], v[140:143]
    ds_read_b128 a[204:207], v32 offset:16384
    v_mfma_f32_16x16x32_bf16 v[76:79], a[232:235], v[112:115], v[76:79]
    v_mfma_f32_16x16x32_bf16 v[76:79], a[236:239], v[120:123], v[76:79]
    s_waitcnt lgkmcnt(2)
    v_max3_f32 v61, v68, v69, v70
    v_max3_f32 v62, v132, v133, v134
    v_max3_f32 v63, v196, v197, v198
    s_nop 3
    v_max3_f32 v61, v61, v71, v76
    v_max3_f32 v62, v62, v135, v140
    v_max3_f32 v63, v63, v199, v204
    v_max3_f32 v61, v61, v77, v78
    v_max3_f32 v62, v62, v141, v142
    v_max3_f32 v63, v63, v205, v206
    v_max_f32 v61, v61, v79
    v_max_f32 v62, v62, v143
    v_max_f32 v63, v63, v207
    v_mov_b32 v58, v61
    v_mov_b32 v59, v62
    v_mov_b32 v60, v63
    v_permlane32_swap_b32 v61, v58
    v_permlane32_swap_b32 v62, v59
    v_permlane32_swap_b32 v63, v60
    v_max_f32 v61, v61, v58
    v_max_f32 v62, v62, v59
    v_max_f32 v63, v63, v60
    v_mov_b32 v58, v61
    v_mov_b32 v59, v62
    v_mov_b32 v60, v63
    v_permlane16_swap_b32 v61, v58
    v_permlane16_swap_b32 v62, v59
    v_permlane16_swap_b32 v63, v60
    v_max_f32 v61, v61, v58
    v_max_f32 v62, v62, v59
    v_max_f32 v63, v63, v60
    v_sub_f32 v124, 0, v61
    v_sub_f32 v188, 0, v62
    v_sub_f32 v252, 0, v63
    v_sub_f32 v125, 0, v61
    v_sub_f32 v189, 0, v62
    v_sub_f32 v253, 0, v63
    v_sub_f32 v126, 0, v61
    v_sub_f32 v190, 0, v62
    v_sub_f32 v254, 0, v63
    v_sub_f32 v127, 0, v61
    v_sub_f32 v191, 0, v62
    v_sub_f32 v255, 0, v63
    v_mfma_f32_16x16x32_bf16 v[84:87], a[192:195], v[64:67], v[124:127]
    ds_read_b128 a[208:211], v29 offset:16640
    v_add_f32 v68, v124, v68
    v_mfma_f32_16x16x32_bf16 v[84:87], a[196:199], v[72:75], v[84:87]
    v_exp_f32 v68, v68
    v_mfma_f32_16x16x32_bf16 v[148:151], a[196:199], v[136:139], v[188:191]
    v_mfma_f32_16x16x32_bf16 v[148:151], a[192:195], v[128:131], v[148:151]
    ds_read_b128 a[212:215], v30 offset:16640
    v_add_f32 v69, v124, v69
    v_mfma_f32_16x16x32_bf16 v[212:215], a[192:195], v[192:195], v[252:255]
    v_exp_f32 v69, v69
    v_mfma_f32_16x16x32_bf16 v[212:215], a[196:199], v[200:203], v[212:215]
    s_waitcnt lgkmcnt(2)
    v_cvt_pk_bf16_f32 v116, v68, v69
    v_mfma_f32_16x16x32_bf16 v[212:215], a[200:203], v[208:211], v[212:215]
    ds_read_b128 a[216:219], v31 offset:16640
    v_add_f32 v70, v124, v70
    v_mfma_f32_16x16x32_bf16 v[212:215], a[204:207], v[216:219], v[212:215]
    v_exp_f32 v70, v70
    v_mfma_f32_16x16x32_bf16 v[148:151], a[204:207], v[152:155], v[148:151]
    v_mfma_f32_16x16x32_bf16 v[148:151], a[200:203], v[144:147], v[148:151]
    ds_read_b128 a[220:223], v32 offset:16640
    v_add_f32 v71, v124, v71
    v_mfma_f32_16x16x32_bf16 v[84:87], a[200:203], v[80:83], v[84:87]
    v_exp_f32 v71, v71
    v_mfma_f32_16x16x32_bf16 v[84:87], a[204:207], v[88:91], v[84:87]
    s_waitcnt lgkmcnt(2)
    v_cvt_pk_bf16_f32 v117, v70, v71
    v_add_f32 v76, v124, v76
    v_mfma_f32_16x16x32_bf16 v[84:87], a[208:211], v[96:99], v[84:87]
    ds_read_b128 a[224:227], v29 offset:24576
    v_add_f32 v77, v124, v77
    v_mfma_f32_16x16x32_bf16 v[84:87], a[212:215], v[104:107], v[84:87]
    v_exp_f32 v76, v76
    v_mfma_f32_16x16x32_bf16 v[148:151], a[212:215], v[168:171], v[148:151]
    v_exp_f32 v77, v77
    v_mfma_f32_16x16x32_bf16 v[148:151], a[208:211], v[160:163], v[148:151]
    ds_read_b128 a[228:231], v30 offset:24576
    v_add_f32 v78, v124, v78
    v_mfma_f32_16x16x32_bf16 v[212:215], a[208:211], v[224:227], v[212:215]
    s_add_u32 m0, s28, 49152
    v_exp_f32 v78, v78
    v_mfma_f32_16x16x32_bf16 v[212:215], a[212:215], v[232:235], v[212:215]
    s_waitcnt lgkmcnt(2)
    s_xor_b32 s29, s61, 5120
    v_add_f32 v79, v124, v79
    v_mfma_f32_16x16x32_bf16 v[212:215], a[216:219], v[240:243], v[212:215]
    ds_read_b128 a[232:235], v31 offset:24576
    buffer_load_dwordx4 v49, s[12:15], s29 offen nt lds
    v_mfma_f32_16x16x32_bf16 v[212:215], a[220:223], v[248:251], v[212:215]
    v_exp_f32 v79, v79
    v_mfma_f32_16x16x32_bf16 v[148:151], a[220:223], v[184:187], v[148:151]
    v_cvt_pk_bf16_f32 v118, v76, v77
    v_cvt_pk_bf16_f32 v119, v78, v79
    v_mfma_f32_16x16x32_bf16 v[148:151], a[216:219], v[176:179], v[148:151]
    ds_read_b128 a[236:239], v32 offset:24576
    buffer_load_dwordx4 v50, s[12:15], s29 offen offset:1024 nt lds
    v_mfma_f32_16x16x32_bf16 v[84:87], a[216:219], v[112:115], v[84:87]
    v_mfma_f32_16x16x32_bf16 v[84:87], a[220:223], v[120:123], v[84:87]
    s_waitcnt lgkmcnt(2)
    v_mfma_f32_16x16x32_bf16 v[92:95], a[224:227], v[64:67], v[124:127]
    ds_read_b128 a[192:195], v29 offset:24832
    buffer_load_dwordx4 v51, s[12:15], s29 offen offset:2048 nt lds
    v_mfma_f32_16x16x32_bf16 v[92:95], a[228:231], v[72:75], v[92:95]
    v_exp_f32 v228, v212
    v_mfma_f32_16x16x32_bf16 v[156:159], a[228:231], v[136:139], v[188:191]
    v_exp_f32 v229, v213
    v_mfma_f32_16x16x32_bf16 v[156:159], a[224:227], v[128:131], v[156:159]
    ds_read_b128 a[196:199], v30 offset:24832
    buffer_load_dwordx4 v52, s[12:15], s29 offen offset:3072 nt lds
    v_mfma_f32_16x16x32_bf16 v[220:223], a[224:227], v[192:195], v[252:255]
    v_exp_f32 v230, v214
    v_mfma_f32_16x16x32_bf16 v[220:223], a[228:231], v[200:203], v[220:223]
    s_waitcnt lgkmcnt(2)
    v_exp_f32 v231, v215
    v_mfma_f32_16x16x32_bf16 v[220:223], a[232:235], v[208:211], v[220:223]
    ds_read_b128 a[200:203], v31 offset:24832
    v_add_f32 v132, v188, v132
    v_mfma_f32_16x16x32_bf16 v[220:223], a[236:239], v[216:219], v[220:223]
    v_exp_f32 v132, v132
    v_mfma_f32_16x16x32_bf16 v[156:159], a[236:239], v[152:155], v[156:159]
    v_exp_f32 v164, v148
    v_mfma_f32_16x16x32_bf16 v[156:159], a[232:235], v[144:147], v[156:159]
    ds_read_b128 a[204:207], v32 offset:24832
    v_add_f32 v133, v188, v133
    v_mfma_f32_16x16x32_bf16 v[92:95], a[232:235], v[80:83], v[92:95]
    v_exp_f32 v133, v133
    v_mfma_f32_16x16x32_bf16 v[92:95], a[236:239], v[88:91], v[92:95]
    s_waitcnt lgkmcnt(2)
    s_waitcnt vmcnt(40)
    s_barrier
    v_mfma_f32_16x16x32_bf16 v[92:95], a[192:195], v[96:99], v[92:95]
    ds_read_b64_tr_b16 a[208:209], v1 offset:0
    v_add_f32 v134, v188, v134
    v_mfma_f32_16x16x32_bf16 v[92:95], a[196:199], v[104:107], v[92:95]
    ds_read_b64_tr_b16 a[210:211], v1 offset:8192
    v_add_f32 v135, v188, v135
    v_mfma_f32_16x16x32_bf16 v[156:159], a[196:199], v[168:171], v[156:159]
    v_exp_f32 v134, v134
    v_mfma_f32_16x16x32_bf16 v[156:159], a[192:195], v[160:163], v[156:159]
    ds_read_b64_tr_b16 a[212:213], v2 offset:0
    v_cvt_pk_bf16_f32 v180, v132, v133
    v_mfma_f32_16x16x32_bf16 v[220:223], a[192:195], v[224:227], v[220:223]
    ds_read_b64_tr_b16 a[214:215], v2 offset:8192
    v_add_f32 v140, v188, v140
    v_mfma_f32_16x16x32_bf16 v[220:223], a[196:199], v[232:235], v[220:223]
    s_waitcnt lgkmcnt(4)
    v_exp_f32 v135, v135
    v_mfma_f32_16x16x32_bf16 v[220:223], a[200:203], v[240:243], v[220:223]
    ds_read_b64_tr_b16 a[216:217], v3 offset:0
    v_cvt_pk_bf16_f32 v181, v134, v135
    v_mfma_f32_16x16x32_bf16 v[220:223], a[204:207], v[248:251], v[220:223]
    ds_read_b64_tr_b16 a[218:219], v3 offset:8192
    v_add_f32 v141, v188, v141
    v_mfma_f32_16x16x32_bf16 v[156:159], a[204:207], v[184:187], v[156:159]
    v_exp_f32 v140, v140
    v_mfma_f32_16x16x32_bf16 v[156:159], a[200:203], v[176:179], v[156:159]
    ds_read_b64_tr_b16 a[220:221], v4 offset:0
    v_add_f32 v142, v188, v142
    v_mfma_f32_16x16x32_bf16 v[92:95], a[200:203], v[112:115], v[92:95]
    ds_read_b64_tr_b16 a[222:223], v4 offset:8192
    v_add_f32 v143, v188, v143
    v_mfma_f32_16x16x32_bf16 v[92:95], a[204:207], v[120:123], v[92:95]
    s_waitcnt lgkmcnt(6)
    v_exp_f32 v141, v141
    v_exp_f32 v142, v142
    v_exp_f32 v143, v143
    v_cvt_pk_bf16_f32 v182, v140, v141
    v_cvt_pk_bf16_f32 v183, v142, v143
    v_add_f32 v196, v252, v196
    v_exp_f32 v196, v196
    v_add_f32 v197, v252, v197
    v_exp_f32 v197, v197
    v_add_f32 v198, v252, v198
    v_exp_f32 v198, v198
    v_add_f32 v199, v252, v199
    v_exp_f32 v199, v199
    v_cvt_pk_bf16_f32 v244, v196, v197
    v_cvt_pk_bf16_f32 v245, v198, v199
    v_add_f32 v204, v252, v204
    v_exp_f32 v204, v204
    v_add_f32 v205, v252, v205
    v_exp_f32 v205, v205
    v_add_f32 v206, v252, v206
    v_exp_f32 v206, v206
    v_add_f32 v207, v252, v207
    v_exp_f32 v207, v207
    v_cvt_pk_bf16_f32 v246, v204, v205
    v_cvt_pk_bf16_f32 v247, v206, v207
    v_mfma_f32_16x16x32_bf16 a[0:3], a[208:211], v[116:119], 0
    ds_read_b64_tr_b16 a[224:225], v5 offset:0
    v_add_f32 v58, v68, v69
    v_mfma_f32_16x16x32_bf16 a[4:7], a[208:211], v[180:183], 0
    ds_read_b64_tr_b16 a[226:227], v5 offset:8192
    v_add_f32 v58, v58, v70
    v_mfma_f32_16x16x32_bf16 a[8:11], a[208:211], v[244:247], 0
    s_waitcnt lgkmcnt(6)
    v_exp_f32 v165, v149
    v_mfma_f32_16x16x32_bf16 a[20:23], a[212:215], v[244:247], 0
    ds_read_b64_tr_b16 a[228:229], v6 offset:0
    v_add_f32 v58, v58, v71
    v_mfma_f32_16x16x32_bf16 a[16:19], a[212:215], v[180:183], 0
    ds_read_b64_tr_b16 a[230:231], v6 offset:8192
    v_add_f32 v58, v58, v76
    v_mfma_f32_16x16x32_bf16 a[12:15], a[212:215], v[116:119], 0
    s_waitcnt lgkmcnt(6)
    v_exp_f32 v166, v150
    v_mfma_f32_16x16x32_bf16 a[24:27], a[216:219], v[116:119], 0
    ds_read_b64_tr_b16 a[232:233], v7 offset:0
    v_add_f32 v58, v58, v77
    v_mfma_f32_16x16x32_bf16 a[28:31], a[216:219], v[180:183], 0
    ds_read_b64_tr_b16 a[234:235], v7 offset:8192
    v_add_f32 v58, v58, v78
    v_mfma_f32_16x16x32_bf16 a[32:35], a[216:219], v[244:247], 0
    s_waitcnt lgkmcnt(6)
    v_exp_f32 v167, v151
    v_mfma_f32_16x16x32_bf16 a[44:47], a[220:223], v[244:247], 0
    ds_read_b64_tr_b16 a[236:237], v8 offset:0
    v_add_f32 v58, v58, v79
    v_mfma_f32_16x16x32_bf16 a[40:43], a[220:223], v[180:183], 0
    ds_read_b64_tr_b16 a[238:239], v8 offset:8192
    v_add_f32 v59, v132, v133
    v_mfma_f32_16x16x32_bf16 a[36:39], a[220:223], v[116:119], 0
    s_waitcnt lgkmcnt(6)
    v_exp_f32 v100, v84
    v_mfma_f32_16x16x32_bf16 a[48:51], a[224:227], v[116:119], 0
    ds_read_b64_tr_b16 a[192:193], v1 offset:256
    v_add_f32 v59, v59, v134
    v_mfma_f32_16x16x32_bf16 a[52:55], a[224:227], v[180:183], 0
    ds_read_b64_tr_b16 a[194:195], v1 offset:8448
    v_add_f32 v59, v59, v135
    v_mfma_f32_16x16x32_bf16 a[56:59], a[224:227], v[244:247], 0
    s_waitcnt lgkmcnt(6)
    v_exp_f32 v101, v85
    v_mfma_f32_16x16x32_bf16 a[68:71], a[228:231], v[244:247], 0
    ds_read_b64_tr_b16 a[196:197], v2 offset:256
    v_add_f32 v59, v59, v140
    v_mfma_f32_16x16x32_bf16 a[64:67], a[228:231], v[180:183], 0
    ds_read_b64_tr_b16 a[198:199], v2 offset:8448
    v_add_f32 v59, v59, v141
    v_mfma_f32_16x16x32_bf16 a[60:63], a[228:231], v[116:119], 0
    s_waitcnt lgkmcnt(6)
    v_exp_f32 v102, v86
    v_mfma_f32_16x16x32_bf16 a[72:75], a[232:235], v[116:119], 0
    ds_read_b64_tr_b16 a[200:201], v3 offset:256
    v_add_f32 v59, v59, v142
    v_mfma_f32_16x16x32_bf16 a[76:79], a[232:235], v[180:183], 0
    ds_read_b64_tr_b16 a[202:203], v3 offset:8448
    v_add_f32 v59, v59, v143
    v_mfma_f32_16x16x32_bf16 a[80:83], a[232:235], v[244:247], 0
    s_waitcnt lgkmcnt(6)
    v_exp_f32 v103, v87
    v_mfma_f32_16x16x32_bf16 a[92:95], a[236:239], v[244:247], 0
    ds_read_b64_tr_b16 a[204:205], v4 offset:256
    v_add_f32 v60, v196, v197
    v_mfma_f32_16x16x32_bf16 a[88:91], a[236:239], v[180:183], 0
    ds_read_b64_tr_b16 a[206:207], v4 offset:8448
    v_add_f32 v60, v60, v198
    v_mfma_f32_16x16x32_bf16 a[84:87], a[236:239], v[116:119], 0
    s_waitcnt lgkmcnt(6)
    v_exp_f32 v236, v220
    v_mfma_f32_16x16x32_bf16 a[96:99], a[192:195], v[116:119], 0
    ds_read_b64_tr_b16 a[208:209], v5 offset:256
    v_add_f32 v60, v60, v199
    v_mfma_f32_16x16x32_bf16 a[100:103], a[192:195], v[180:183], 0
    s_add_u32 m0, s28, 114688
    ds_read_b64_tr_b16 a[210:211], v5 offset:8448
    v_add_f32 v60, v60, v204
    v_mfma_f32_16x16x32_bf16 a[104:107], a[192:195], v[244:247], 0
    s_waitcnt lgkmcnt(6)
    s_xor_b32 s29, s61, 4096
    v_add_f32 v60, v60, v205
    v_mfma_f32_16x16x32_bf16 a[116:119], a[196:199], v[244:247], 0
    ds_read_b64_tr_b16 a[212:213], v6 offset:256
    buffer_load_dwordx4 v49, s[16:19], s29 offen nt lds
    v_mfma_f32_16x16x32_bf16 a[112:115], a[196:199], v[180:183], 0
    ds_read_b64_tr_b16 a[214:215], v6 offset:8448
    v_add_f32 v60, v60, v206
    v_mfma_f32_16x16x32_bf16 a[108:111], a[196:199], v[116:119], 0
    s_waitcnt lgkmcnt(6)
    v_exp_f32 v237, v221
    v_mfma_f32_16x16x32_bf16 a[120:123], a[200:203], v[116:119], 0
    ds_read_b64_tr_b16 a[216:217], v7 offset:256
    buffer_load_dwordx4 v50, s[16:19], s29 offen offset:1024 nt lds
    v_mfma_f32_16x16x32_bf16 a[124:127], a[200:203], v[180:183], 0
    ds_read_b64_tr_b16 a[218:219], v7 offset:8448
    v_add_f32 v60, v60, v207
    v_mfma_f32_16x16x32_bf16 a[128:131], a[200:203], v[244:247], 0
    s_waitcnt lgkmcnt(6)
    v_exp_f32 v238, v222
    v_mfma_f32_16x16x32_bf16 a[140:143], a[204:207], v[244:247], 0
    ds_read_b64_tr_b16 a[220:221], v8 offset:256
    buffer_load_dwordx4 v51, s[16:19], s29 offen offset:2048 nt lds
    v_mfma_f32_16x16x32_bf16 a[136:139], a[204:207], v[180:183], 0
    ds_read_b64_tr_b16 a[222:223], v8 offset:8448
    v_add_f32 v61, v100, v101
    v_mfma_f32_16x16x32_bf16 a[132:135], a[204:207], v[116:119], 0
    s_waitcnt lgkmcnt(6)
    s_waitcnt vmcnt(35)
    s_barrier
    v_mfma_f32_16x16x32_bf16 a[144:147], a[208:211], v[116:119], 0
    ds_read_b128 a[224:227], v33 offset:16384
    buffer_load_dwordx4 v52, s[16:19], s29 offen offset:3072 nt lds
    v_mfma_f32_16x16x32_bf16 a[148:151], a[208:211], v[180:183], 0
    v_exp_f32 v239, v223
    v_mfma_f32_16x16x32_bf16 a[152:155], a[208:211], v[244:247], 0
    s_waitcnt lgkmcnt(5)
    v_exp_f32 v172, v156
    v_mfma_f32_16x16x32_bf16 a[164:167], a[212:215], v[244:247], 0
    ds_read_b128 a[228:231], v34 offset:16384
    v_add_f32 v61, v61, v102
    v_mfma_f32_16x16x32_bf16 a[160:163], a[212:215], v[180:183], 0
    v_exp_f32 v173, v157
    v_mfma_f32_16x16x32_bf16 a[156:159], a[212:215], v[116:119], 0
    s_waitcnt lgkmcnt(4)
    v_exp_f32 v174, v158
    v_mfma_f32_16x16x32_bf16 a[168:171], a[216:219], v[116:119], 0
    ds_read_b128 a[232:235], v35 offset:16384
    v_add_f32 v61, v61, v103
    v_mfma_f32_16x16x32_bf16 a[172:175], a[216:219], v[180:183], 0
    v_exp_f32 v175, v159
    v_mfma_f32_16x16x32_bf16 a[176:179], a[216:219], v[244:247], 0
    s_waitcnt lgkmcnt(3)
    v_exp_f32 v108, v92
    v_mfma_f32_16x16x32_bf16 a[188:191], a[220:223], v[244:247], 0
    ds_read_b128 a[236:239], v36 offset:16384
    v_exp_f32 v109, v93
    v_exp_f32 v110, v94
    v_exp_f32 v111, v95
    v_add_f32 v61, v61, v108
    v_add_f32 v61, v61, v109
    v_add_f32 v61, v61, v110
    v_add_f32 v61, v61, v111
    v_add_f32 v62, v164, v165
    v_add_f32 v62, v62, v166
    v_add_f32 v62, v62, v167
    v_add_f32 v62, v62, v172
    v_add_f32 v62, v62, v173
    v_add_f32 v62, v62, v174
    v_add_f32 v62, v62, v175
    v_add_f32 v63, v228, v229
    v_add_f32 v63, v63, v230
    v_add_f32 v63, v63, v231
    v_add_f32 v63, v63, v236
    v_add_f32 v63, v63, v237
    v_add_f32 v63, v63, v238
    v_add_f32 v63, v63, v239
    v_mfma_f32_16x16x32_bf16 a[184:187], a[220:223], v[180:183], 0
    v_max3_f32 v0, v61, v62, v63
    v_cmp_lt_f32 vcc, s35, v0
    v_mfma_f32_16x16x32_bf16 a[180:183], a[220:223], v[116:119], 0
    s_cbranch_vccnz L_rare1
L_ret1:
    s_waitcnt lgkmcnt(2)
    v_cvt_pk_bf16_f32 v116, v100, v101
    v_mfma_f32_16x16x32_bf16 v[84:87], a[224:227], v[64:67], v[124:127]
    s_andn2_b32 s52, s48, 1023
    ds_read_b128 a[192:195], v33 offset:16640
    v_cvt_pk_bf16_f32 v117, v102, v103
    v_mfma_f32_16x16x32_bf16 v[84:87], a[228:231], v[72:75], v[84:87]
    s_lshl_b32 s3, s58, 16
    v_cvt_pk_bf16_f32 v118, v108, v109
    v_cvt_pk_bf16_f32 v119, v110, v111
    v_mfma_f32_16x16x32_bf16 v[148:151], a[228:231], v[136:139], v[188:191]
    v_cvt_pk_bf16_f32 v180, v164, v165
    v_cvt_pk_bf16_f32 v181, v166, v167
    v_mfma_f32_16x16x32_bf16 v[148:151], a[224:227], v[128:131], v[148:151]
    ds_read_b128 a[196:199], v34 offset:16640
    v_cvt_pk_bf16_f32 v182, v172, v173
    v_mfma_f32_16x16x32_bf16 v[212:215], a[224:227], v[192:195], v[252:255]
    v_cvt_pk_bf16_f32 v183, v174, v175
    v_cvt_pk_bf16_f32 v244, v228, v229
    v_mfma_f32_16x16x32_bf16 v[212:215], a[228:231], v[200:203], v[212:215]
    s_waitcnt lgkmcnt(2)
    v_cvt_pk_bf16_f32 v245, v230, v231
    v_cvt_pk_bf16_f32 v246, v236, v237
    v_mfma_f32_16x16x32_bf16 v[212:215], a[232:235], v[208:211], v[212:215]
    ds_read_b128 a[200:203], v35 offset:16640
    v_cvt_pk_bf16_f32 v247, v238, v239
    v_mfma_f32_16x16x32_bf16 v[212:215], a[236:239], v[216:219], v[212:215]
    v_add_f32 v58, v58, v61
    v_add_f32 v59, v59, v62
    v_mfma_f32_16x16x32_bf16 v[148:151], a[236:239], v[152:155], v[148:151]
    v_add_f32 v60, v60, v63
    v_mbcnt_lo_u32_b32 v135, -1, 0
    v_mfma_f32_16x16x32_bf16 v[148:151], a[232:235], v[144:147], v[148:151]
    ds_read_b128 a[204:207], v36 offset:16640
    v_mbcnt_hi_u32_b32 v135, -1, v135
    v_mfma_f32_16x16x32_bf16 v[84:87], a[232:235], v[80:83], v[84:87]
    v_min_u32 v134, 47, v135
    v_lshl_add_u32 v134, v134, 4, s52
    v_mfma_f32_16x16x32_bf16 v[84:87], a[236:239], v[88:91], v[84:87]
    s_waitcnt lgkmcnt(2)
    v_mov_b32 v140, 0
    v_mov_b32 v141, 0
    v_mfma_f32_16x16x32_bf16 v[84:87], a[192:195], v[96:99], v[84:87]
    ds_read_b128 a[208:211], v33 offset:24576
    v_mov_b32 v142, 0
    v_mfma_f32_16x16x32_bf16 v[84:87], a[196:199], v[104:107], v[84:87]
    v_mov_b32 v143, 0
    v_mfma_f32_16x16x32_bf16 v[148:151], a[196:199], v[168:171], v[148:151]
    buffer_store_dwordx4 v[140:143], v134, s[36:39], s3 offen sc1
    v_mfma_f32_16x16x32_bf16 v[148:151], a[192:195], v[160:163], v[148:151]
    ds_read_b128 a[212:215], v34 offset:24576
    v_mfma_f32_16x16x32_bf16 v[212:215], a[192:195], v[224:227], v[212:215]
    v_lshl_add_u32 v134, v135, 12, s28
    v_mov_b32 v132, 1
    v_mfma_f32_16x16x32_bf16 v[212:215], a[196:199], v[232:235], v[212:215]
    s_waitcnt lgkmcnt(2)
    v_mfma_f32_16x16x32_bf16 v[212:215], a[200:203], v[240:243], v[212:215]
    ds_read_b128 a[216:219], v35 offset:24576
    v_mfma_f32_16x16x32_bf16 v[212:215], a[204:207], v[248:251], v[212:215]
    v_mfma_f32_16x16x32_bf16 v[148:151], a[204:207], v[184:187], v[148:151]
    v_mfma_f32_16x16x32_bf16 v[148:151], a[200:203], v[176:179], v[148:151]
    ds_read_b128 a[220:223], v36 offset:24576
    v_mfma_f32_16x16x32_bf16 v[84:87], a[200:203], v[112:115], v[84:87]
    v_mfma_f32_16x16x32_bf16 v[84:87], a[204:207], v[120:123], v[84:87]
    s_waitcnt lgkmcnt(2)
    v_mfma_f32_16x16x32_bf16 v[92:95], a[208:211], v[64:67], v[124:127]
    ds_read_b128 a[224:227], v33 offset:24832
    v_mfma_f32_16x16x32_bf16 v[92:95], a[212:215], v[72:75], v[92:95]
    v_exp_f32 v228, v212
    v_mfma_f32_16x16x32_bf16 v[156:159], a[212:215], v[136:139], v[188:191]
    v_exp_f32 v229, v213
    v_mfma_f32_16x16x32_bf16 v[156:159], a[208:211], v[128:131], v[156:159]
    ds_read_b128 a[228:231], v34 offset:24832
    v_add_f32 v63, v228, v229
    v_mfma_f32_16x16x32_bf16 v[220:223], a[208:211], v[192:195], v[252:255]
    v_exp_f32 v230, v214
    v_mfma_f32_16x16x32_bf16 v[220:223], a[212:215], v[200:203], v[220:223]
    s_waitcnt lgkmcnt(2)
    v_exp_f32 v231, v215
    v_mfma_f32_16x16x32_bf16 v[220:223], a[216:219], v[208:211], v[220:223]
    ds_read_b128 a[232:235], v35 offset:24832
    v_add_f32 v63, v63, v230
    v_mfma_f32_16x16x32_bf16 v[220:223], a[220:223], v[216:219], v[220:223]
    v_exp_f32 v164, v148
    v_mfma_f32_16x16x32_bf16 v[156:159], a[220:223], v[152:155], v[156:159]
    v_exp_f32 v165, v149
    v_mfma_f32_16x16x32_bf16 v[156:159], a[216:219], v[144:147], v[156:159]
    ds_read_b128 a[236:239], v36 offset:24832
    v_add_f32 v62, v164, v165
    v_mfma_f32_16x16x32_bf16 v[92:95], a[216:219], v[80:83], v[92:95]
    s_add_u32 m0, s28, 81920
    v_exp_f32 v166, v150
    v_mfma_f32_16x16x32_bf16 v[92:95], a[220:223], v[88:91], v[92:95]
    s_waitcnt lgkmcnt(2)
    s_waitcnt vmcnt(29)
    s_xor_b32 s29, s61, 6144
    s_barrier
    v_mfma_f32_16x16x32_bf16 v[92:95], a[224:227], v[96:99], v[92:95]
    ds_read_b64_tr_b16 a[192:193], v1 offset:32768
    buffer_load_dwordx4 v49, s[12:15], s29 offen nt lds
    v_mfma_f32_16x16x32_bf16 v[92:95], a[228:231], v[104:107], v[92:95]
    ds_read_b64_tr_b16 a[194:195], v1 offset:40960
    v_add_f32 v62, v62, v166
    v_mfma_f32_16x16x32_bf16 v[156:159], a[228:231], v[168:171], v[156:159]
    v_exp_f32 v167, v151
    v_mfma_f32_16x16x32_bf16 v[156:159], a[224:227], v[160:163], v[156:159]
    ds_read_b64_tr_b16 a[196:197], v2 offset:32768
    buffer_load_dwordx4 v50, s[12:15], s29 offen offset:1024 nt lds
    v_mfma_f32_16x16x32_bf16 v[220:223], a[224:227], v[224:227], v[220:223]
    ds_read_b64_tr_b16 a[198:199], v2 offset:40960
    v_add_f32 v62, v62, v167
    v_mfma_f32_16x16x32_bf16 v[220:223], a[228:231], v[232:235], v[220:223]
    s_waitcnt lgkmcnt(4)
    v_exp_f32 v100, v84
    v_mfma_f32_16x16x32_bf16 v[220:223], a[232:235], v[240:243], v[220:223]
    ds_read_b64_tr_b16 a[200:201], v3 offset:32768
    buffer_load_dwordx4 v51, s[12:15], s29 offen offset:2048 nt lds
    v_mfma_f32_16x16x32_bf16 v[220:223], a[236:239], v[248:251], v[220:223]
    ds_read_b64_tr_b16 a[202:203], v3 offset:40960
    v_add_f32 v63, v63, v231
    v_mfma_f32_16x16x32_bf16 v[156:159], a[236:239], v[184:187], v[156:159]
    v_exp_f32 v101, v85
    v_mfma_f32_16x16x32_bf16 v[156:159], a[232:235], v[176:179], v[156:159]
    ds_read_b64_tr_b16 a[204:205], v4 offset:32768
    buffer_load_dwordx4 v52, s[12:15], s29 offen offset:3072 nt lds
    v_mfma_f32_16x16x32_bf16 v[92:95], a[232:235], v[112:115], v[92:95]
    ds_read_b64_tr_b16 a[206:207], v4 offset:40960
    v_add_f32 v61, v100, v101
    v_mfma_f32_16x16x32_bf16 v[92:95], a[236:239], v[120:123], v[92:95]
    s_waitcnt lgkmcnt(6)
    v_exp_f32 v102, v86
    v_mfma_f32_16x16x32_bf16 a[0:3], a[192:195], v[116:119], a[0:3]
    ds_read_b64_tr_b16 a[208:209], v5 offset:32768
    v_add_f32 v61, v61, v102
    v_mfma_f32_16x16x32_bf16 a[4:7], a[192:195], v[180:183], a[4:7]
    ds_read_b64_tr_b16 a[210:211], v5 offset:40960
    v_mfma_f32_16x16x32_bf16 a[8:11], a[192:195], v[244:247], a[8:11]
    s_waitcnt lgkmcnt(6)
    v_exp_f32 v103, v87
    v_mfma_f32_16x16x32_bf16 a[20:23], a[196:199], v[244:247], a[20:23]
    ds_read_b64_tr_b16 a[212:213], v6 offset:32768
    v_add_f32 v61, v61, v103
    v_mfma_f32_16x16x32_bf16 a[16:19], a[196:199], v[180:183], a[16:19]
    ds_read_b64_tr_b16 a[214:215], v6 offset:40960
    v_mfma_f32_16x16x32_bf16 a[12:15], a[196:199], v[116:119], a[12:15]
    s_waitcnt lgkmcnt(6)
    v_exp_f32 v236, v220
    v_mfma_f32_16x16x32_bf16 a[24:27], a[200:203], v[116:119], a[24:27]
    ds_read_b64_tr_b16 a[216:217], v7 offset:32768
    v_add_f32 v63, v63, v236
    v_mfma_f32_16x16x32_bf16 a[28:31], a[200:203], v[180:183], a[28:31]
    ds_read_b64_tr_b16 a[218:219], v7 offset:40960
    v_mfma_f32_16x16x32_bf16 a[32:35], a[200:203], v[244:247], a[32:35]
    s_waitcnt lgkmcnt(6)
    v_exp_f32 v237, v221
    v_mfma_f32_16x16x32_bf16 a[44:47], a[204:207], v[244:247], a[44:47]
    ds_read_b64_tr_b16 a[220:221], v8 offset:32768
    v_add_f32 v63, v63, v237
    v_mfma_f32_16x16x32_bf16 a[40:43], a[204:207], v[180:183], a[40:43]
    ds_read_b64_tr_b16 a[222:223], v8 offset:40960
    v_mfma_f32_16x16x32_bf16 a[36:39], a[204:207], v[116:119], a[36:39]
    s_waitcnt lgkmcnt(6)
    v_exp_f32 v238, v222
    v_mfma_f32_16x16x32_bf16 a[48:51], a[208:211], v[116:119], a[48:51]
    ds_read_b64_tr_b16 a[224:225], v1 offset:33024
    v_add_f32 v63, v63, v238
    v_mfma_f32_16x16x32_bf16 a[52:55], a[208:211], v[180:183], a[52:55]
    ds_read_b64_tr_b16 a[226:227], v1 offset:41216
    v_mfma_f32_16x16x32_bf16 a[56:59], a[208:211], v[244:247], a[56:59]
    s_waitcnt lgkmcnt(6)
    v_exp_f32 v239, v223
    v_mfma_f32_16x16x32_bf16 a[68:71], a[212:215], v[244:247], a[68:71]
    ds_read_b64_tr_b16 a[228:229], v2 offset:33024
    v_add_f32 v63, v63, v239
    v_mfma_f32_16x16x32_bf16 a[64:67], a[212:215], v[180:183], a[64:67]
    ds_read_b64_tr_b16 a[230:231], v2 offset:41216
    v_mfma_f32_16x16x32_bf16 a[60:63], a[212:215], v[116:119], a[60:63]
    s_waitcnt lgkmcnt(6)
    v_exp_f32 v172, v156
    v_mfma_f32_16x16x32_bf16 a[72:75], a[216:219], v[116:119], a[72:75]
    ds_read_b64_tr_b16 a[232:233], v3 offset:33024
    v_add_f32 v62, v62, v172
    v_mfma_f32_16x16x32_bf16 a[76:79], a[216:219], v[180:183], a[76:79]
    ds_read_b64_tr_b16 a[234:235], v3 offset:41216
    v_mfma_f32_16x16x32_bf16 a[80:83], a[216:219], v[244:247], a[80:83]
    s_waitcnt lgkmcnt(6)
    v_exp_f32 v173, v157
    v_mfma_f32_16x16x32_bf16 a[92:95], a[220:223], v[244:247], a[92:95]
    ds_read_b64_tr_b16 a[236:237], v4 offset:33024
    v_add_f32 v62, v62, v173
    v_mfma_f32_16x16x32_bf16 a[88:91], a[220:223], v[180:183], a[88:91]
    ds_read_b64_tr_b16 a[238:239], v4 offset:41216
    v_mfma_f32_16x16x32_bf16 a[84:87], a[220:223], v[116:119], a[84:87]
    s_waitcnt lgkmcnt(6)
    v_exp_f32 v174, v158
    v_mfma_f32_16x16x32_bf16 a[96:99], a[224:227], v[116:119], a[96:99]
    ds_read_b64_tr_b16 a[192:193], v5 offset:33024
    v_add_f32 v62, v62, v174
    v_mfma_f32_16x16x32_bf16 a[100:103], a[224:227], v[180:183], a[100:103]
    ds_read_b64_tr_b16 a[194:195], v5 offset:41216
    v_mfma_f32_16x16x32_bf16 a[104:107], a[224:227], v[244:247], a[104:107]
    s_waitcnt lgkmcnt(6)
    v_exp_f32 v175, v159
    v_mfma_f32_16x16x32_bf16 a[116:119], a[228:231], v[244:247], a[116:119]
    ds_read_b64_tr_b16 a[196:197], v6 offset:33024
    v_add_f32 v62, v62, v175
    v_mfma_f32_16x16x32_bf16 a[112:115], a[228:231], v[180:183], a[112:115]
    ds_read_b64_tr_b16 a[198:199], v6 offset:41216
    v_mfma_f32_16x16x32_bf16 a[108:111], a[228:231], v[116:119], a[108:111]
    s_waitcnt lgkmcnt(6)
    v_exp_f32 v108, v92
    v_mfma_f32_16x16x32_bf16 a[120:123], a[232:235], v[116:119], a[120:123]
    ds_read_b64_tr_b16 a[200:201], v7 offset:33024
    v_add_f32 v61, v61, v108
    v_mfma_f32_16x16x32_bf16 a[124:127], a[232:235], v[180:183], a[124:127]
    ds_read_b64_tr_b16 a[202:203], v7 offset:41216
    v_mfma_f32_16x16x32_bf16 a[128:131], a[232:235], v[244:247], a[128:131]
    s_waitcnt lgkmcnt(6)
    v_exp_f32 v109, v93
    v_mfma_f32_16x16x32_bf16 a[140:143], a[236:239], v[244:247], a[140:143]
    ds_read_b64_tr_b16 a[204:205], v8 offset:33024
    v_add_f32 v61, v61, v109
    v_mfma_f32_16x16x32_bf16 a[136:139], a[236:239], v[180:183], a[136:139]
    ds_read_b64_tr_b16 a[206:207], v8 offset:41216
    v_mfma_f32_16x16x32_bf16 a[132:135], a[236:239], v[116:119], a[132:135]
    s_waitcnt lgkmcnt(6)
    s_waitcnt vmcnt(25)
    s_barrier
    v_mfma_f32_16x16x32_bf16 a[144:147], a[192:195], v[116:119], a[144:147]
    ds_read_b128 a[208:211], v29 offset:0
    v_mfma_f32_16x16x32_bf16 a[148:151], a[192:195], v[180:183], a[148:151]
    v_exp_f32 v110, v94
    v_mfma_f32_16x16x32_bf16 a[152:155], a[192:195], v[244:247], a[152:155]
    s_waitcnt lgkmcnt(5)
    v_exp_f32 v111, v95
    v_mfma_f32_16x16x32_bf16 a[164:167], a[196:199], v[244:247], a[164:167]
    ds_read_b128 a[212:215], v30 offset:0
    v_add_f32 v61, v61, v110
    v_mfma_f32_16x16x32_bf16 a[160:163], a[196:199], v[180:183], a[160:163]
    v_mfma_f32_16x16x32_bf16 a[156:159], a[196:199], v[116:119], a[156:159]
    s_waitcnt lgkmcnt(4)
    v_mfma_f32_16x16x32_bf16 a[168:171], a[200:203], v[116:119], a[168:171]
    ds_read_b128 a[216:219], v31 offset:0
    v_add_f32 v61, v61, v111
    v_mfma_f32_16x16x32_bf16 a[172:175], a[200:203], v[180:183], a[172:175]
    s_add_u32 m0, s28, 0
    v_max3_f32 v0, v61, v62, v63
    v_cmp_lt_f32 vcc, s35, v0
    v_mfma_f32_16x16x32_bf16 a[176:179], a[200:203], v[244:247], a[176:179]
    s_waitcnt lgkmcnt(3)
    s_xor_b32 s29, s61, 5120
    v_mfma_f32_16x16x32_bf16 a[188:191], a[204:207], v[244:247], a[188:191]
    ds_read_b128 a[220:223], v32 offset:0
    buffer_load_dwordx4 v49, s[16:19], s29 offen nt lds
    v_mfma_f32_16x16x32_bf16 a[184:187], a[204:207], v[180:183], a[184:187]
    v_mfma_f32_16x16x32_bf16 a[180:183], a[204:207], v[116:119], a[180:183]
    s_cbranch_vccnz L_rare2
L_ret2:
    s_waitcnt lgkmcnt(2)
    v_cvt_pk_bf16_f32 v116, v100, v101
    v_mfma_f32_16x16x32_bf16 v[84:87], a[208:211], v[64:67], v[124:127]
    ds_read_b128 a[224:227], v29 offset:256
    buffer_load_dwordx4 v50, s[16:19], s29 offen offset:1024 nt lds
    v_mfma_f32_16x16x32_bf16 v[84:87], a[212:215], v[72:75], v[84:87]
    v_cvt_pk_bf16_f32 v117, v102, v103
    v_cvt_pk_bf16_f32 v118, v108, v109
    v_mfma_f32_16x16x32_bf16 v[148:151], a[212:215], v[136:139], v[188:191]
    v_cvt_pk_bf16_f32 v119, v110, v111
    v_cvt_pk_bf16_f32 v180, v164, v165
    v_mfma_f32_16x16x32_bf16 v[148:151], a[208:211], v[128:131], v[148:151]
    ds_read_b128 a[228:231], v30 offset:256
    buffer_load_dwordx4 v51, s[16:19], s29 offen offset:2048 nt lds
    v_mfma_f32_16x16x32_bf16 v[212:215], a[208:211], v[192:195], v[252:255]
    v_cvt_pk_bf16_f32 v181, v166, v167
    v_cvt_pk_bf16_f32 v182, v172, v173
    v_mfma_f32_16x16x32_bf16 v[212:215], a[212:215], v[200:203], v[212:215]
    s_waitcnt lgkmcnt(2)
    v_cvt_pk_bf16_f32 v183, v174, v175
    v_cvt_pk_bf16_f32 v244, v228, v229
    v_mfma_f32_16x16x32_bf16 v[212:215], a[216:219], v[208:211], v[212:215]
    ds_read_b128 a[232:235], v31 offset:256
    buffer_load_dwordx4 v52, s[16:19], s29 offen offset:3072 nt lds
    v_mfma_f32_16x16x32_bf16 v[212:215], a[220:223], v[216:219], v[212:215]
    v_cvt_pk_bf16_f32 v245, v230, v231
    v_cvt_pk_bf16_f32 v246, v236, v237
    v_mfma_f32_16x16x32_bf16 v[148:151], a[220:223], v[152:155], v[148:151]
    v_cvt_pk_bf16_f32 v247, v238, v239
    v_add_f32 v58, v58, v61
    v_mfma_f32_16x16x32_bf16 v[148:151], a[216:219], v[144:147], v[148:151]
    ds_read_b128 a[236:239], v32 offset:256
    v_add_f32 v59, v59, v62
    v_mfma_f32_16x16x32_bf16 v[84:87], a[216:219], v[80:83], v[84:87]
    v_add_f32 v60, v60, v63
    v_mfma_f32_16x16x32_bf16 v[84:87], a[220:223], v[88:91], v[84:87]
    s_waitcnt lgkmcnt(2)
    v_mfma_f32_16x16x32_bf16 v[84:87], a[224:227], v[96:99], v[84:87]
    ds_read_b128 a[192:195], v29 offset:8192
    v_mfma_f32_16x16x32_bf16 v[84:87], a[228:231], v[104:107], v[84:87]
    v_mfma_f32_16x16x32_bf16 v[148:151], a[228:231], v[168:171], v[148:151]
    v_mfma_f32_16x16x32_bf16 v[148:151], a[224:227], v[160:163], v[148:151]
    ds_read_b128 a[196:199], v30 offset:8192
    v_mfma_f32_16x16x32_bf16 v[212:215], a[224:227], v[224:227], v[212:215]
    v_mfma_f32_16x16x32_bf16 v[212:215], a[228:231], v[232:235], v[212:215]
    s_waitcnt lgkmcnt(2)
    v_mfma_f32_16x16x32_bf16 v[212:215], a[232:235], v[240:243], v[212:215]
    ds_read_b128 a[200:203], v31 offset:8192
    v_mfma_f32_16x16x32_bf16 v[212:215], a[236:239], v[248:251], v[212:215]
    v_mfma_f32_16x16x32_bf16 v[148:151], a[236:239], v[184:187], v[148:151]
    v_mfma_f32_16x16x32_bf16 v[148:151], a[232:235], v[176:179], v[148:151]
    ds_read_b128 a[204:207], v32 offset:8192
    v_mfma_f32_16x16x32_bf16 v[84:87], a[232:235], v[112:115], v[84:87]
    v_mfma_f32_16x16x32_bf16 v[84:87], a[236:239], v[120:123], v[84:87]
    s_waitcnt lgkmcnt(2)
    v_mfma_f32_16x16x32_bf16 v[92:95], a[192:195], v[64:67], v[124:127]
    ds_read_b128 a[208:211], v29 offset:8448
    v_mfma_f32_16x16x32_bf16 v[92:95], a[196:199], v[72:75], v[92:95]
    v_exp_f32 v228, v212
    v_mfma_f32_16x16x32_bf16 v[156:159], a[196:199], v[136:139], v[188:191]
    v_exp_f32 v229, v213
    v_mfma_f32_16x16x32_bf16 v[156:159], a[192:195], v[128:131], v[156:159]
    ds_read_b128 a[212:215], v30 offset:8448
    v_add_f32 v63, v228, v229
    v_mfma_f32_16x16x32_bf16 v[220:223], a[192:195], v[192:195], v[252:255]
    v_exp_f32 v230, v214
    v_mfma_f32_16x16x32_bf16 v[220:223], a[196:199], v[200:203], v[220:223]
    s_waitcnt lgkmcnt(2)
    v_exp_f32 v231, v215
    v_mfma_f32_16x16x32_bf16 v[220:223], a[200:203], v[208:211], v[220:223]
    ds_read_b128 a[216:219], v31 offset:8448
    v_add_f32 v63, v63, v230
    v_mfma_f32_16x16x32_bf16 v[220:223], a[204:207], v[216:219], v[220:223]
    v_exp_f32 v164, v148
    v_mfma_f32_16x16x32_bf16 v[156:159], a[204:207], v[152:155], v[156:159]
    v_exp_f32 v165, v149
    v_mfma_f32_16x16x32_bf16 v[156:159], a[200:203], v[144:147], v[156:159]
    ds_read_b128 a[220:223], v32 offset:8448
    v_add_f32 v62, v164, v165
    v_mfma_f32_16x16x32_bf16 v[92:95], a[200:203], v[80:83], v[92:95]
    s_waitcnt vmcnt(8)
    v_exp_f32 v166, v150
    v_mfma_f32_16x16x32_bf16 v[92:95], a[204:207], v[88:91], v[92:95]
    s_waitcnt lgkmcnt(2)
    s_waitcnt vmcnt(25)
    s_barrier
    v_mfma_f32_16x16x32_bf16 v[92:95], a[208:211], v[96:99], v[92:95]
    ds_read_b64_tr_b16 a[224:225], v9 offset:32768
    v_add_f32 v62, v62, v166
    v_mfma_f32_16x16x32_bf16 v[92:95], a[212:215], v[104:107], v[92:95]
    ds_read_b64_tr_b16 a[226:227], v9 offset:40960
    v_add_f32 v63, v63, v231
    v_mfma_f32_16x16x32_bf16 v[156:159], a[212:215], v[168:171], v[156:159]
    v_exp_f32 v167, v151
    v_mfma_f32_16x16x32_bf16 v[156:159], a[208:211], v[160:163], v[156:159]
    ds_read_b64_tr_b16 a[228:229], v10 offset:32768
    v_add_f32 v62, v62, v167
    v_mfma_f32_16x16x32_bf16 v[220:223], a[208:211], v[224:227], v[220:223]
    ds_read_b64_tr_b16 a[230:231], v10 offset:40960
    v_mfma_f32_16x16x32_bf16 v[220:223], a[212:215], v[232:235], v[220:223]
    s_waitcnt lgkmcnt(4)
    v_exp_f32 v100, v84
    v_mfma_f32_16x16x32_bf16 v[220:223], a[216:219], v[240:243], v[220:223]
    ds_read_b64_tr_b16 a[232:233], v11 offset:32768
    v_mfma_f32_16x16x32_bf16 v[220:223], a[220:223], v[248:251], v[220:223]
    ds_read_b64_tr_b16 a[234:235], v11 offset:40960
    v_mfma_f32_16x16x32_bf16 v[156:159], a[220:223], v[184:187], v[156:159]
    v_exp_f32 v101, v85
    v_mfma_f32_16x16x32_bf16 v[156:159], a[216:219], v[176:179], v[156:159]
    ds_read_b64_tr_b16 a[236:237], v12 offset:32768
    v_add_f32 v61, v100, v101
    v_mfma_f32_16x16x32_bf16 v[92:95], a[216:219], v[112:115], v[92:95]
    ds_read_b64_tr_b16 a[238:239], v12 offset:40960
    v_mfma_f32_16x16x32_bf16 v[92:95], a[220:223], v[120:123], v[92:95]
    s_waitcnt lgkmcnt(6)
    v_exp_f32 v102, v86
    v_mfma_f32_16x16x32_bf16 a[0:3], a[224:227], v[116:119], a[0:3]
    ds_read_b64_tr_b16 a[192:193], v13 offset:32768
    v_add_f32 v61, v61, v102
    v_mfma_f32_16x16x32_bf16 a[4:7], a[224:227], v[180:183], a[4:7]
    ds_read_b64_tr_b16 a[194:195], v13 offset:40960
    v_mfma_f32_16x16x32_bf16 a[8:11], a[224:227], v[244:247], a[8:11]
    s_waitcnt lgkmcnt(6)
    v_exp_f32 v103, v87
    v_mfma_f32_16x16x32_bf16 a[20:23], a[228:231], v[244:247], a[20:23]
    ds_read_b64_tr_b16 a[196:197], v14 offset:32768
    v_add_f32 v61, v61, v103
    v_mfma_f32_16x16x32_bf16 a[16:19], a[228:231], v[180:183], a[16:19]
    s_add_u32 m0, s28, 147456
    ds_read_b64_tr_b16 a[198:199], v14 offset:40960
    v_mfma_f32_16x16x32_bf16 a[12:15], a[228:231], v[116:119], a[12:15]
    s_waitcnt lgkmcnt(6)
    s_xor_b32 s29, s61, 7168
    v_mfma_f32_16x16x32_bf16 a[24:27], a[232:235], v[116:119], a[24:27]
    ds_read_b64_tr_b16 a[200:201], v15 offset:32768
    buffer_load_dwordx4 v49, s[12:15], s29 offen nt lds
    v_mfma_f32_16x16x32_bf16 a[28:31], a[232:235], v[180:183], a[28:31]
    ds_read_b64_tr_b16 a[202:203], v15 offset:40960
    v_mfma_f32_16x16x32_bf16 a[32:35], a[232:235], v[244:247], a[32:35]
    s_waitcnt lgkmcnt(6)
    v_exp_f32 v236, v220
    v_mfma_f32_16x16x32_bf16 a[44:47], a[236:239], v[244:247], a[44:47]
    ds_read_b64_tr_b16 a[204:205], v16 offset:32768
    buffer_load_dwordx4 v50, s[12:15], s29 offen offset:1024 nt lds
    s_cmp_eq_u32 s63, 0
    s_cselect_b32 s52, s85, 4096
    v_mfma_f32_16x16x32_bf16 a[40:43], a[236:239], v[180:183], a[40:43]
    ds_read_b64_tr_b16 a[206:207], v16 offset:40960
    v_add_f32 v63, v63, v236
    v_mfma_f32_16x16x32_bf16 a[36:39], a[236:239], v[116:119], a[36:39]
    s_waitcnt lgkmcnt(6)
    v_exp_f32 v237, v221
    v_mfma_f32_16x16x32_bf16 a[48:51], a[192:195], v[116:119], a[48:51]
    ds_read_b64_tr_b16 a[208:209], v9 offset:33024
    buffer_load_dwordx4 v51, s[12:15], s29 offen offset:2048 nt lds
    v_mfma_f32_16x16x32_bf16 a[52:55], a[192:195], v[180:183], a[52:55]
    ds_read_b64_tr_b16 a[210:211], v9 offset:41216
    v_add_f32 v63, v63, v237
    v_mfma_f32_16x16x32_bf16 a[56:59], a[192:195], v[244:247], a[56:59]
    s_waitcnt lgkmcnt(6)
    v_exp_f32 v238, v222
    v_mfma_f32_16x16x32_bf16 a[68:71], a[196:199], v[244:247], a[68:71]
    ds_read_b64_tr_b16 a[212:213], v10 offset:33024
    buffer_load_dwordx4 v52, s[12:15], s29 offen offset:3072 nt lds
    v_mfma_f32_16x16x32_bf16 a[64:67], a[196:199], v[180:183], a[64:67]
    ds_read_b64_tr_b16 a[214:215], v10 offset:41216
    v_add_f32 v63, v63, v238
    v_mfma_f32_16x16x32_bf16 a[60:63], a[196:199], v[116:119], a[60:63]
    s_waitcnt lgkmcnt(6)
    v_exp_f32 v239, v223
    v_mfma_f32_16x16x32_bf16 a[72:75], a[200:203], v[116:119], a[72:75]
    ds_read_b64_tr_b16 a[216:217], v11 offset:33024
    v_add_f32 v63, v63, v239
    v_mfma_f32_16x16x32_bf16 a[76:79], a[200:203], v[180:183], a[76:79]
    ds_read_b64_tr_b16 a[218:219], v11 offset:41216
    buffer_atomic_add v132, v134, s[40:43], s52 offen sc1
    v_mfma_f32_16x16x32_bf16 a[80:83], a[200:203], v[244:247], a[80:83]
    s_waitcnt lgkmcnt(6)
    v_exp_f32 v172, v156
    v_mfma_f32_16x16x32_bf16 a[92:95], a[204:207], v[244:247], a[92:95]
    ds_read_b64_tr_b16 a[220:221], v12 offset:33024
    v_add_f32 v62, v62, v172
    v_mfma_f32_16x16x32_bf16 a[88:91], a[204:207], v[180:183], a[88:91]
    ds_read_b64_tr_b16 a[222:223], v12 offset:41216
    v_mfma_f32_16x16x32_bf16 a[84:87], a[204:207], v[116:119], a[84:87]
    s_waitcnt lgkmcnt(6)
    v_exp_f32 v173, v157
    v_mfma_f32_16x16x32_bf16 a[96:99], a[208:211], v[116:119], a[96:99]
    ds_read_b64_tr_b16 a[224:225], v13 offset:33024
    v_add_f32 v62, v62, v173
    v_mfma_f32_16x16x32_bf16 a[100:103], a[208:211], v[180:183], a[100:103]
    ds_read_b64_tr_b16 a[226:227], v13 offset:41216
    v_mfma_f32_16x16x32_bf16 a[104:107], a[208:211], v[244:247], a[104:107]
    s_waitcnt lgkmcnt(6)
    v_exp_f32 v174, v158
    v_mfma_f32_16x16x32_bf16 a[116:119], a[212:215], v[244:247], a[116:119]
    ds_read_b64_tr_b16 a[228:229], v14 offset:33024
    v_add_f32 v62, v62, v174
    v_mfma_f32_16x16x32_bf16 a[112:115], a[212:215], v[180:183], a[112:115]
    ds_read_b64_tr_b16 a[230:231], v14 offset:41216
    v_mfma_f32_16x16x32_bf16 a[108:111], a[212:215], v[116:119], a[108:111]
    s_waitcnt lgkmcnt(6)
    v_exp_f32 v175, v159
    v_mfma_f32_16x16x32_bf16 a[120:123], a[216:219], v[116:119], a[120:123]
    ds_read_b64_tr_b16 a[232:233], v15 offset:33024
    v_add_f32 v62, v62, v175
    v_mfma_f32_16x16x32_bf16 a[124:127], a[216:219], v[180:183], a[124:127]
    ds_read_b64_tr_b16 a[234:235], v15 offset:41216
    v_mfma_f32_16x16x32_bf16 a[128:131], a[216:219], v[244:247], a[128:131]
    s_waitcnt lgkmcnt(6)
    v_exp_f32 v108, v92
    v_mfma_f32_16x16x32_bf16 a[140:143], a[220:223], v[244:247], a[140:143]
    ds_read_b64_tr_b16 a[236:237], v16 offset:33024
    v_add_f32 v61, v61, v108
    v_mfma_f32_16x16x32_bf16 a[136:139], a[220:223], v[180:183], a[136:139]
    ds_read_b64_tr_b16 a[238:239], v16 offset:41216
    v_mfma_f32_16x16x32_bf16 a[132:135], a[220:223], v[116:119], a[132:135]
    s_waitcnt lgkmcnt(6)
    s_waitcnt vmcnt(26)
    s_barrier
    v_mfma_f32_16x16x32_bf16 a[144:147], a[224:227], v[116:119], a[144:147]
    ds_read_b128 a[192:195], v33 offset:0
    v_mfma_f32_16x16x32_bf16 a[148:151], a[224:227], v[180:183], a[148:151]
    v_exp_f32 v109, v93
    v_mfma_f32_16x16x32_bf16 a[152:155], a[224:227], v[244:247], a[152:155]
    s_waitcnt lgkmcnt(5)
    v_exp_f32 v110, v94
    v_mfma_f32_16x16x32_bf16 a[164:167], a[228:231], v[244:247], a[164:167]
    ds_read_b128 a[196:199], v34 offset:0
    v_add_f32 v61, v61, v109
    v_mfma_f32_16x16x32_bf16 a[160:163], a[228:231], v[180:183], a[160:163]
    v_exp_f32 v111, v95
    v_mfma_f32_16x16x32_bf16 a[156:159], a[228:231], v[116:119], a[156:159]
    s_waitcnt lgkmcnt(4)
    v_mfma_f32_16x16x32_bf16 a[168:171], a[232:235], v[116:119], a[168:171]
    ds_read_b128 a[200:203], v35 offset:0
    v_add_f32 v61, v61, v110
    v_mfma_f32_16x16x32_bf16 a[172:175], a[232:235], v[180:183], a[172:175]
    v_mfma_f32_16x16x32_bf16 a[176:179], a[232:235], v[244:247], a[176:179]
    s_waitcnt lgkmcnt(3)
    v_mfma_f32_16x16x32_bf16 a[188:191], a[236:239], v[244:247], a[188:191]
    ds_read_b128 a[204:207], v36 offset:0
    v_add_f32 v61, v61, v111
    v_mfma_f32_16x16x32_bf16 a[184:187], a[236:239], v[180:183], a[184:187]
    v_max3_f32 v0, v61, v62, v63
    v_cmp_lt_f32 vcc, s35, v0
    v_mfma_f32_16x16x32_bf16 a[180:183], a[236:239], v[116:119], a[180:183]
    s_cbranch_vccnz L_rare3
L_ret3:
    s_waitcnt lgkmcnt(2)
    v_cvt_pk_bf16_f32 v116, v100, v101
    v_mfma_f32_16x16x32_bf16 v[84:87], a[192:195], v[64:67], v[124:127]
    ds_read_b128 a[208:211], v33 offset:256
    v_cvt_pk_bf16_f32 v117, v102, v103
    v_mfma_f32_16x16x32_bf16 v[84:87], a[196:199], v[72:75], v[84:87]
    v_cvt_pk_bf16_f32 v118, v108, v109
    v_cvt_pk_bf16_f32 v119, v110, v111
    v_mfma_f32_16x16x32_bf16 v[148:151], a[196:199], v[136:139], v[188:191]
    v_cvt_pk_bf16_f32 v180, v164, v165
    v_cvt_pk_bf16_f32 v181, v166, v167
    v_mfma_f32_16x16x32_bf16 v[148:151], a[192:195], v[128:131], v[148:151]
    ds_read_b128 a[212:215], v34 offset:256
    v_cvt_pk_bf16_f32 v182, v172, v173
    v_mfma_f32_16x16x32_bf16 v[212:215], a[192:195], v[192:195], v[252:255]
    v_cvt_pk_bf16_f32 v183, v174, v175
    v_cvt_pk_bf16_f32 v244, v228, v229
    v_mfma_f32_16x16x32_bf16 v[212:215], a[196:199], v[200:203], v[212:215]
    s_waitcnt lgkmcnt(2)
    v_cvt_pk_bf16_f32 v245, v230, v231
    v_cvt_pk_bf16_f32 v246, v236, v237
    v_mfma_f32_16x16x32_bf16 v[212:215], a[200:203], v[208:211], v[212:215]
    ds_read_b128 a[216:219], v35 offset:256
    v_cvt_pk_bf16_f32 v247, v238, v239
    v_mfma_f32_16x16x32_bf16 v[212:215], a[204:207], v[216:219], v[212:215]
    v_add_f32 v58, v58, v61
    v_add_f32 v59, v59, v62
    v_mfma_f32_16x16x32_bf16 v[148:151], a[204:207], v[152:155], v[148:151]
    v_add_f32 v60, v60, v63
    v_mfma_f32_16x16x32_bf16 v[148:151], a[200:203], v[144:147], v[148:151]
    ds_read_b128 a[220:223], v36 offset:256
    v_mfma_f32_16x16x32_bf16 v[84:87], a[200:203], v[80:83], v[84:87]
    v_mfma_f32_16x16x32_bf16 v[84:87], a[204:207], v[88:91], v[84:87]
    s_waitcnt lgkmcnt(2)
    v_mfma_f32_16x16x32_bf16 v[84:87], a[208:211], v[96:99], v[84:87]
    ds_read_b128 a[224:227], v33 offset:8192
    v_mfma_f32_16x16x32_bf16 v[84:87], a[212:215], v[104:107], v[84:87]
    s_add_u32 m0, s28, 32768
    v_mfma_f32_16x16x32_bf16 v[148:151], a[212:215], v[168:171], v[148:151]
    s_xor_b32 s29, s61, 6144
    v_mfma_f32_16x16x32_bf16 v[148:151], a[208:211], v[160:163], v[148:151]
    ds_read_b128 a[228:231], v34 offset:8192
    buffer_load_dwordx4 v49, s[16:19], s29 offen nt lds
    v_mfma_f32_16x16x32_bf16 v[212:215], a[208:211], v[224:227], v[212:215]
    v_mfma_f32_16x16x32_bf16 v[212:215], a[212:215], v[232:235], v[212:215]
    s_waitcnt lgkmcnt(2)
    v_mfma_f32_16x16x32_bf16 v[212:215], a[216:219], v[240:243], v[212:215]
    ds_read_b128 a[232:235], v35 offset:8192
    buffer_load_dwordx4 v50, s[16:19], s29 offen offset:1024 nt lds
    v_mfma_f32_16x16x32_bf16 v[212:215], a[220:223], v[248:251], v[212:215]
    v_mfma_f32_16x16x32_bf16 v[148:151], a[220:223], v[184:187], v[148:151]
    v_mfma_f32_16x16x32_bf16 v[148:151], a[216:219], v[176:179], v[148:151]
    ds_read_b128 a[236:239], v36 offset:8192
    buffer_load_dwordx4 v51, s[16:19], s29 offen offset:2048 nt lds
    v_mfma_f32_16x16x32_bf16 v[84:87], a[216:219], v[112:115], v[84:87]
    v_mfma_f32_16x16x32_bf16 v[84:87], a[220:223], v[120:123], v[84:87]
    s_waitcnt lgkmcnt(2)
    v_mfma_f32_16x16x32_bf16 v[92:95], a[224:227], v[64:67], v[124:127]
    ds_read_b128 a[192:195], v33 offset:8448
    buffer_load_dwordx4 v52, s[16:19], s29 offen offset:3072 nt lds
    v_mfma_f32_16x16x32_bf16 v[92:95], a[228:231], v[72:75], v[92:95]
    v_exp_f32 v228, v212
    v_mfma_f32_16x16x32_bf16 v[156:159], a[228:231], v[136:139], v[188:191]
    v_exp_f32 v229, v213
    v_mfma_f32_16x16x32_bf16 v[156:159], a[224:227], v[128:131], v[156:159]
    ds_read_b128 a[196:199], v34 offset:8448
    v_add_f32 v63, v228, v229
    v_mfma_f32_16x16x32_bf16 v[220:223], a[224:227], v[192:195], v[252:255]
    v_exp_f32 v230, v214
    v_mfma_f32_16x16x32_bf16 v[220:223], a[228:231], v[200:203], v[220:223]
    s_waitcnt lgkmcnt(2)
    v_exp_f32 v231, v215
    v_mfma_f32_16x16x32_bf16 v[220:223], a[232:235], v[208:211], v[220:223]
    ds_read_b128 a[200:203], v35 offset:8448
    v_add_f32 v63, v63, v230
    v_mfma_f32_16x16x32_bf16 v[220:223], a[236:239], v[216:219], v[220:223]
    v_exp_f32 v164, v148
    v_mfma_f32_16x16x32_bf16 v[156:159], a[236:239], v[152:155], v[156:159]
    v_exp_f32 v165, v149
    v_mfma_f32_16x16x32_bf16 v[156:159], a[232:235], v[144:147], v[156:159]
    ds_read_b128 a[204:207], v36 offset:8448
    v_add_f32 v62, v164, v165
    v_mfma_f32_16x16x32_bf16 v[92:95], a[232:235], v[80:83], v[92:95]
    v_exp_f32 v166, v150
    v_mfma_f32_16x16x32_bf16 v[92:95], a[236:239], v[88:91], v[92:95]
    s_waitcnt lgkmcnt(2)
    s_waitcnt vmcnt(26)
    s_barrier
    v_mfma_f32_16x16x32_bf16 v[92:95], a[192:195], v[96:99], v[92:95]
    ds_read_b64_tr_b16 a[208:209], v1 offset:16384
    v_add_f32 v62, v62, v166
    v_mfma_f32_16x16x32_bf16 v[92:95], a[196:199], v[104:107], v[92:95]
    ds_read_b64_tr_b16 a[210:211], v1 offset:24576
    v_add_f32 v63, v63, v231
    v_mfma_f32_16x16x32_bf16 v[156:159], a[196:199], v[168:171], v[156:159]
    v_exp_f32 v167, v151
    v_mfma_f32_16x16x32_bf16 v[156:159], a[192:195], v[160:163], v[156:159]
    ds_read_b64_tr_b16 a[212:213], v2 offset:16384
    v_add_f32 v62, v62, v167
    v_mfma_f32_16x16x32_bf16 v[220:223], a[192:195], v[224:227], v[220:223]
    ds_read_b64_tr_b16 a[214:215], v2 offset:24576
    v_mfma_f32_16x16x32_bf16 v[220:223], a[196:199], v[232:235], v[220:223]
    s_waitcnt lgkmcnt(4)
    v_exp_f32 v100, v84
    v_mfma_f32_16x16x32_bf16 v[220:223], a[200:203], v[240:243], v[220:223]
    ds_read_b64_tr_b16 a[216:217], v3 offset:16384
    v_mfma_f32_16x16x32_bf16 v[220:223], a[204:207], v[248:251], v[220:223]
    ds_read_b64_tr_b16 a[218:219], v3 offset:24576
    v_mfma_f32_16x16x32_bf16 v[156:159], a[204:207], v[184:187], v[156:159]
    v_exp_f32 v101, v85
    v_mfma_f32_16x16x32_bf16 v[156:159], a[200:203], v[176:179], v[156:159]
    ds_read_b64_tr_b16 a[220:221], v4 offset:16384
    v_add_f32 v61, v100, v101
    v_mfma_f32_16x16x32_bf16 v[92:95], a[200:203], v[112:115], v[92:95]
    ds_read_b64_tr_b16 a[222:223], v4 offset:24576
    v_mfma_f32_16x16x32_bf16 v[92:95], a[204:207], v[120:123], v[92:95]
    s_waitcnt lgkmcnt(6)
    v_exp_f32 v102, v86
    v_mfma_f32_16x16x32_bf16 a[0:3], a[208:211], v[116:119], a[0:3]
    ds_read_b64_tr_b16 a[224:225], v5 offset:16384
    v_add_f32 v61, v61, v102
    v_mfma_f32_16x16x32_bf16 a[4:7], a[208:211], v[180:183], a[4:7]
    ds_read_b64_tr_b16 a[226:227], v5 offset:24576
    v_mfma_f32_16x16x32_bf16 a[8:11], a[208:211], v[244:247], a[8:11]
    s_waitcnt lgkmcnt(6)
    v_exp_f32 v103, v87
    v_mfma_f32_16x16x32_bf16 a[20:23], a[212:215], v[244:247], a[20:23]
    ds_read_b64_tr_b16 a[228:229], v6 offset:16384
    v_add_f32 v61, v61, v103
    v_mfma_f32_16x16x32_bf16 a[16:19], a[212:215], v[180:183], a[16:19]
    ds_read_b64_tr_b16 a[230:231], v6 offset:24576
    v_mfma_f32_16x16x32_bf16 a[12:15], a[212:215], v[116:119], a[12:15]
    s_waitcnt lgkmcnt(6)
    v_exp_f32 v236, v220
    v_mfma_f32_16x16x32_bf16 a[24:27], a[216:219], v[116:119], a[24:27]
    ds_read_b64_tr_b16 a[232:233], v7 offset:16384
    v_add_f32 v63, v63, v236
    v_mfma_f32_16x16x32_bf16 a[28:31], a[216:219], v[180:183], a[28:31]
    ds_read_b64_tr_b16 a[234:235], v7 offset:24576
    v_mfma_f32_16x16x32_bf16 a[32:35], a[216:219], v[244:247], a[32:35]
    s_waitcnt lgkmcnt(6)
    v_exp_f32 v237, v221
    v_mfma_f32_16x16x32_bf16 a[44:47], a[220:223], v[244:247], a[44:47]
    ds_read_b64_tr_b16 a[236:237], v8 offset:16384
    v_add_f32 v63, v63, v237
    v_mfma_f32_16x16x32_bf16 a[40:43], a[220:223], v[180:183], a[40:43]
    ds_read_b64_tr_b16 a[238:239], v8 offset:24576
    v_mfma_f32_16x16x32_bf16 a[36:39], a[220:223], v[116:119], a[36:39]
    s_waitcnt lgkmcnt(6)
    v_exp_f32 v238, v222
    v_mfma_f32_16x16x32_bf16 a[48:51], a[224:227], v[116:119], a[48:51]
    ds_read_b64_tr_b16 a[192:193], v1 offset:16640
    v_add_f32 v63, v63, v238
    v_mfma_f32_16x16x32_bf16 a[52:55], a[224:227], v[180:183], a[52:55]
    ds_read_b64_tr_b16 a[194:195], v1 offset:24832
    v_mfma_f32_16x16x32_bf16 a[56:59], a[224:227], v[244:247], a[56:59]
    s_waitcnt lgkmcnt(6)
    v_exp_f32 v239, v223
    v_mfma_f32_16x16x32_bf16 a[68:71], a[228:231], v[244:247], a[68:71]
    ds_read_b64_tr_b16 a[196:197], v2 offset:16640
    v_add_f32 v63, v63, v239
    v_mfma_f32_16x16x32_bf16 a[64:67], a[228:231], v[180:183], a[64:67]
    ds_read_b64_tr_b16 a[198:199], v2 offset:24832
    v_mfma_f32_16x16x32_bf16 a[60:63], a[228:231], v[116:119], a[60:63]
    s_waitcnt lgkmcnt(6)
    v_exp_f32 v172, v156
    v_mfma_f32_16x16x32_bf16 a[72:75], a[232:235], v[116:119], a[72:75]
    ds_read_b64_tr_b16 a[200:201], v3 offset:16640
    v_add_f32 v62, v62, v172
    v_mfma_f32_16x16x32_bf16 a[76:79], a[232:235], v[180:183], a[76:79]
    ds_read_b64_tr_b16 a[202:203], v3 offset:24832
    v_mfma_f32_16x16x32_bf16 a[80:83], a[232:235], v[244:247], a[80:83]
    s_waitcnt lgkmcnt(6)
    v_exp_f32 v173, v157
    v_mfma_f32_16x16x32_bf16 a[92:95], a[236:239], v[244:247], a[92:95]
    ds_read_b64_tr_b16 a[204:205], v4 offset:16640
    v_add_f32 v62, v62, v173
    v_mfma_f32_16x16x32_bf16 a[88:91], a[236:239], v[180:183], a[88:91]
    s_add_u32 m0, s28, 65536
    ds_read_b64_tr_b16 a[206:207], v4 offset:24832
    v_mfma_f32_16x16x32_bf16 a[84:87], a[236:239], v[116:119], a[84:87]
    s_waitcnt lgkmcnt(6)
    s_xor_b32 s29, s61, 131072
    v_mfma_f32_16x16x32_bf16 a[96:99], a[192:195], v[116:119], a[96:99]
    ds_read_b64_tr_b16 a[208:209], v5 offset:16640
    buffer_load_dwordx4 v49, s[12:15], s29 offen nt lds
    v_mfma_f32_16x16x32_bf16 a[100:103], a[192:195], v[180:183], a[100:103]
    ds_read_b64_tr_b16 a[210:211], v5 offset:24832
    v_mfma_f32_16x16x32_bf16 a[104:107], a[192:195], v[244:247], a[104:107]
    s_waitcnt lgkmcnt(6)
    v_exp_f32 v174, v158
    v_mfma_f32_16x16x32_bf16 a[116:119], a[196:199], v[244:247], a[116:119]
    ds_read_b64_tr_b16 a[212:213], v6 offset:16640
    buffer_load_dwordx4 v50, s[12:15], s29 offen offset:1024 nt lds
    v_mfma_f32_16x16x32_bf16 a[112:115], a[196:199], v[180:183], a[112:115]
    ds_read_b64_tr_b16 a[214:215], v6 offset:24832
    v_add_f32 v62, v62, v174
    v_mfma_f32_16x16x32_bf16 a[108:111], a[196:199], v[116:119], a[108:111]
    s_waitcnt lgkmcnt(6)
    v_exp_f32 v175, v159
    v_mfma_f32_16x16x32_bf16 a[120:123], a[200:203], v[116:119], a[120:123]
    ds_read_b64_tr_b16 a[216:217], v7 offset:16640
    buffer_load_dwordx4 v51, s[12:15], s29 offen offset:2048 nt lds
    v_mfma_f32_16x16x32_bf16 a[124:127], a[200:203], v[180:183], a[124:127]
    ds_read_b64_tr_b16 a[218:219], v7 offset:24832
    v_add_f32 v62, v62, v175
    v_mfma_f32_16x16x32_bf16 a[128:131], a[200:203], v[244:247], a[128:131]
    s_waitcnt lgkmcnt(6)
    v_exp_f32 v108, v92
    v_mfma_f32_16x16x32_bf16 a[140:143], a[204:207], v[244:247], a[140:143]
    ds_read_b64_tr_b16 a[220:221], v8 offset:16640
    buffer_load_dwordx4 v52, s[12:15], s29 offen offset:3072 nt lds
    v_mfma_f32_16x16x32_bf16 a[136:139], a[204:207], v[180:183], a[136:139]
    ds_read_b64_tr_b16 a[222:223], v8 offset:24832
    v_add_f32 v61, v61, v108
    v_mfma_f32_16x16x32_bf16 a[132:135], a[204:207], v[116:119], a[132:135]
    s_waitcnt lgkmcnt(6)
    s_waitcnt vmcnt(26)
    s_barrier
    v_mfma_f32_16x16x32_bf16 a[144:147], a[208:211], v[116:119], a[144:147]
    ds_read_b128 a[224:227], v25 offset:49152
    v_mfma_f32_16x16x32_bf16 a[148:151], a[208:211], v[180:183], a[148:151]
    v_exp_f32 v109, v93
    v_mfma_f32_16x16x32_bf16 a[152:155], a[208:211], v[244:247], a[152:155]
    s_waitcnt lgkmcnt(5)
    v_exp_f32 v110, v94
    v_mfma_f32_16x16x32_bf16 a[164:167], a[212:215], v[244:247], a[164:167]
    ds_read_b128 a[228:231], v26 offset:49152
    v_add_f32 v61, v61, v109
    v_mfma_f32_16x16x32_bf16 a[160:163], a[212:215], v[180:183], a[160:163]
    v_exp_f32 v111, v95
    v_mfma_f32_16x16x32_bf16 a[156:159], a[212:215], v[116:119], a[156:159]
    s_waitcnt lgkmcnt(4)
    v_mfma_f32_16x16x32_bf16 a[168:171], a[216:219], v[116:119], a[168:171]
    ds_read_b128 a[232:235], v27 offset:49152
    v_add_f32 v61, v61, v110
    v_mfma_f32_16x16x32_bf16 a[172:175], a[216:219], v[180:183], a[172:175]
    v_mfma_f32_16x16x32_bf16 a[176:179], a[216:219], v[244:247], a[176:179]
    s_waitcnt lgkmcnt(3)
    v_mfma_f32_16x16x32_bf16 a[188:191], a[220:223], v[244:247], a[188:191]
    ds_read_b128 a[236:239], v28 offset:49152
    v_add_f32 v61, v61, v111
    v_mfma_f32_16x16x32_bf16 a[184:187], a[220:223], v[180:183], a[184:187]
    v_max3_f32 v0, v61, v62, v63
    v_cmp_lt_f32 vcc, s35, v0
    v_mfma_f32_16x16x32_bf16 a[180:183], a[220:223], v[116:119], a[180:183]
    s_cbranch_vccnz L_rare4
L_ret4:
    s_waitcnt lgkmcnt(2)
    v_cvt_pk_bf16_f32 v116, v100, v101
    v_mfma_f32_16x16x32_bf16 v[84:87], a[224:227], v[64:67], v[124:127]
    ds_read_b128 a[192:195], v25 offset:49408
    v_cvt_pk_bf16_f32 v117, v102, v103
    v_mfma_f32_16x16x32_bf16 v[84:87], a[228:231], v[72:75], v[84:87]
    v_cvt_pk_bf16_f32 v118, v108, v109
    v_cvt_pk_bf16_f32 v119, v110, v111
    v_mfma_f32_16x16x32_bf16 v[148:151], a[228:231], v[136:139], v[188:191]
    v_cvt_pk_bf16_f32 v180, v164, v165
    v_cvt_pk_bf16_f32 v181, v166, v167
    v_mfma_f32_16x16x32_bf16 v[148:151], a[224:227], v[128:131], v[148:151]
    ds_read_b128 a[196:199], v26 offset:49408
    v_cvt_pk_bf16_f32 v182, v172, v173
    v_mfma_f32_16x16x32_bf16 v[212:215], a[224:227], v[192:195], v[252:255]
    v_cvt_pk_bf16_f32 v183, v174, v175
    v_cvt_pk_bf16_f32 v244, v228, v229
    v_mfma_f32_16x16x32_bf16 v[212:215], a[228:231], v[200:203], v[212:215]
    s_waitcnt lgkmcnt(2)
    v_cvt_pk_bf16_f32 v245, v230, v231
    v_cvt_pk_bf16_f32 v246, v236, v237
    v_mfma_f32_16x16x32_bf16 v[212:215], a[232:235], v[208:211], v[212:215]
    ds_read_b128 a[200:203], v27 offset:49408
    v_cvt_pk_bf16_f32 v247, v238, v239
    v_mfma_f32_16x16x32_bf16 v[212:215], a[236:239], v[216:219], v[212:215]
    v_add_f32 v58, v58, v61
    v_add_f32 v59, v59, v62
    v_mfma_f32_16x16x32_bf16 v[148:151], a[236:239], v[152:155], v[148:151]
    v_add_f32 v60, v60, v63
    v_mfma_f32_16x16x32_bf16 v[148:151], a[232:235], v[144:147], v[148:151]
    ds_read_b128 a[204:207], v28 offset:49408
    s_cmp_eq_u32 s63, 1
    s_cselect_b32 s52, s85, 4096
    v_mfma_f32_16x16x32_bf16 v[84:87], a[232:235], v[80:83], v[84:87]
    buffer_atomic_add v132, v134, s[40:43], s52 offen sc1
    v_mfma_f32_16x16x32_bf16 v[84:87], a[236:239], v[88:91], v[84:87]
    s_waitcnt lgkmcnt(2)
    v_mfma_f32_16x16x32_bf16 v[84:87], a[192:195], v[96:99], v[84:87]
    ds_read_b128 a[208:211], v25 offset:57344
    v_mfma_f32_16x16x32_bf16 v[84:87], a[196:199], v[104:107], v[84:87]
    v_mfma_f32_16x16x32_bf16 v[148:151], a[196:199], v[168:171], v[148:151]
    v_mfma_f32_16x16x32_bf16 v[148:151], a[192:195], v[160:163], v[148:151]
    ds_read_b128 a[212:215], v26 offset:57344
    v_mfma_f32_16x16x32_bf16 v[212:215], a[192:195], v[224:227], v[212:215]
    v_mfma_f32_16x16x32_bf16 v[212:215], a[196:199], v[232:235], v[212:215]
    s_waitcnt lgkmcnt(2)
    v_mfma_f32_16x16x32_bf16 v[212:215], a[200:203], v[240:243], v[212:215]
    ds_read_b128 a[216:219], v27 offset:57344
    v_mfma_f32_16x16x32_bf16 v[212:215], a[204:207], v[248:251], v[212:215]
    v_mfma_f32_16x16x32_bf16 v[148:151], a[204:207], v[184:187], v[148:151]
    v_mfma_f32_16x16x32_bf16 v[148:151], a[200:203], v[176:179], v[148:151]
    ds_read_b128 a[220:223], v28 offset:57344
    v_mfma_f32_16x16x32_bf16 v[84:87], a[200:203], v[112:115], v[84:87]
    v_mfma_f32_16x16x32_bf16 v[84:87], a[204:207], v[120:123], v[84:87]
    s_waitcnt lgkmcnt(2)
    v_mfma_f32_16x16x32_bf16 v[92:95], a[208:211], v[64:67], v[124:127]
    ds_read_b128 a[224:227], v25 offset:57600
    v_mfma_f32_16x16x32_bf16 v[92:95], a[212:215], v[72:75], v[92:95]
    v_exp_f32 v228, v212
    v_mfma_f32_16x16x32_bf16 v[156:159], a[212:215], v[136:139], v[188:191]
    v_exp_f32 v229, v213
    v_mfma_f32_16x16x32_bf16 v[156:159], a[208:211], v[128:131], v[156:159]
    ds_read_b128 a[228:231], v26 offset:57600
    v_add_f32 v63, v228, v229
    v_mfma_f32_16x16x32_bf16 v[220:223], a[208:211], v[192:195], v[252:255]
    v_exp_f32 v230, v214
    v_mfma_f32_16x16x32_bf16 v[220:223], a[212:215], v[200:203], v[220:223]
    s_waitcnt lgkmcnt(2)
    v_exp_f32 v231, v215
    v_mfma_f32_16x16x32_bf16 v[220:223], a[216:219], v[208:211], v[220:223]
    ds_read_b128 a[232:235], v27 offset:57600
    v_add_f32 v63, v63, v230
    v_mfma_f32_16x16x32_bf16 v[220:223], a[220:223], v[216:219], v[220:223]
    s_add_u32 m0, s28, 98304
    v_exp_f32 v164, v148
    v_mfma_f32_16x16x32_bf16 v[156:159], a[220:223], v[152:155], v[156:159]
    s_xor_b32 s29, s61, 7168
    v_exp_f32 v165, v149
    v_mfma_f32_16x16x32_bf16 v[156:159], a[216:219], v[144:147], v[156:159]
    ds_read_b128 a[236:239], v28 offset:57600
    buffer_load_dwordx4 v49, s[16:19], s29 offen nt lds
    v_mfma_f32_16x16x32_bf16 v[92:95], a[216:219], v[80:83], v[92:95]
    v_exp_f32 v166, v150
    v_mfma_f32_16x16x32_bf16 v[92:95], a[220:223], v[88:91], v[92:95]
    s_waitcnt lgkmcnt(2)
    s_waitcnt vmcnt(24)
    s_barrier
    v_mfma_f32_16x16x32_bf16 v[92:95], a[224:227], v[96:99], v[92:95]
    ds_read_b64_tr_b16 a[192:193], v9 offset:49152
    buffer_load_dwordx4 v50, s[16:19], s29 offen offset:1024 nt lds
    v_mfma_f32_16x16x32_bf16 v[92:95], a[228:231], v[104:107], v[92:95]
    ds_read_b64_tr_b16 a[194:195], v9 offset:57344
    v_add_f32 v62, v164, v165
    v_mfma_f32_16x16x32_bf16 v[156:159], a[228:231], v[168:171], v[156:159]
    v_exp_f32 v167, v151
    v_mfma_f32_16x16x32_bf16 v[156:159], a[224:227], v[160:163], v[156:159]
    ds_read_b64_tr_b16 a[196:197], v10 offset:49152
    buffer_load_dwordx4 v51, s[16:19], s29 offen offset:2048 nt lds
    v_mfma_f32_16x16x32_bf16 v[220:223], a[224:227], v[224:227], v[220:223]
    ds_read_b64_tr_b16 a[198:199], v10 offset:57344
    v_add_f32 v62, v62, v166
    v_mfma_f32_16x16x32_bf16 v[220:223], a[228:231], v[232:235], v[220:223]
    s_waitcnt lgkmcnt(4)
    v_exp_f32 v100, v84
    v_mfma_f32_16x16x32_bf16 v[220:223], a[232:235], v[240:243], v[220:223]
    ds_read_b64_tr_b16 a[200:201], v11 offset:49152
    buffer_load_dwordx4 v52, s[16:19], s29 offen offset:3072 nt lds
    v_mfma_f32_16x16x32_bf16 v[220:223], a[236:239], v[248:251], v[220:223]
    ds_read_b64_tr_b16 a[202:203], v11 offset:57344
    v_add_f32 v62, v62, v167
    v_mfma_f32_16x16x32_bf16 v[156:159], a[236:239], v[184:187], v[156:159]
    v_exp_f32 v101, v85
    v_mfma_f32_16x16x32_bf16 v[156:159], a[232:235], v[176:179], v[156:159]
    ds_read_b64_tr_b16 a[204:205], v12 offset:49152
    v_add_f32 v61, v100, v101
    v_mfma_f32_16x16x32_bf16 v[92:95], a[232:235], v[112:115], v[92:95]
    ds_read_b64_tr_b16 a[206:207], v12 offset:57344
    v_add_f32 v63, v63, v231
    v_mfma_f32_16x16x32_bf16 v[92:95], a[236:239], v[120:123], v[92:95]
    s_waitcnt lgkmcnt(6)
    v_exp_f32 v102, v86
    v_mfma_f32_16x16x32_bf16 a[0:3], a[192:195], v[116:119], a[0:3]
    ds_read_b64_tr_b16 a[208:209], v13 offset:49152
    v_add_f32 v61, v61, v102
    v_mfma_f32_16x16x32_bf16 a[4:7], a[192:195], v[180:183], a[4:7]
    ds_read_b64_tr_b16 a[210:211], v13 offset:57344
    v_mfma_f32_16x16x32_bf16 a[8:11], a[192:195], v[244:247], a[8:11]
    s_waitcnt lgkmcnt(6)
    v_exp_f32 v103, v87
    v_mfma_f32_16x16x32_bf16 a[20:23], a[196:199], v[244:247], a[20:23]
    ds_read_b64_tr_b16 a[212:213], v14 offset:49152
    v_add_f32 v61, v61, v103
    v_mfma_f32_16x16x32_bf16 a[16:19], a[196:199], v[180:183], a[16:19]
    ds_read_b64_tr_b16 a[214:215], v14 offset:57344
    v_mfma_f32_16x16x32_bf16 a[12:15], a[196:199], v[116:119], a[12:15]
    s_waitcnt lgkmcnt(6)
    v_exp_f32 v236, v220
    v_mfma_f32_16x16x32_bf16 a[24:27], a[200:203], v[116:119], a[24:27]
    ds_read_b64_tr_b16 a[216:217], v15 offset:49152
    v_add_f32 v63, v63, v236
    v_mfma_f32_16x16x32_bf16 a[28:31], a[200:203], v[180:183], a[28:31]
    ds_read_b64_tr_b16 a[218:219], v15 offset:57344
    v_mfma_f32_16x16x32_bf16 a[32:35], a[200:203], v[244:247], a[32:35]
    s_waitcnt lgkmcnt(6)
    v_exp_f32 v237, v221
    v_mfma_f32_16x16x32_bf16 a[44:47], a[204:207], v[244:247], a[44:47]
    ds_read_b64_tr_b16 a[220:221], v16 offset:49152
    v_add_f32 v63, v63, v237
    v_mfma_f32_16x16x32_bf16 a[40:43], a[204:207], v[180:183], a[40:43]
    ds_read_b64_tr_b16 a[222:223], v16 offset:57344
    v_mfma_f32_16x16x32_bf16 a[36:39], a[204:207], v[116:119], a[36:39]
    s_waitcnt lgkmcnt(6)
    v_exp_f32 v238, v222
    v_mfma_f32_16x16x32_bf16 a[48:51], a[208:211], v[116:119], a[48:51]
    ds_read_b64_tr_b16 a[224:225], v9 offset:49408
    v_add_f32 v63, v63, v238
    v_mfma_f32_16x16x32_bf16 a[52:55], a[208:211], v[180:183], a[52:55]
    ds_read_b64_tr_b16 a[226:227], v9 offset:57600
    v_mfma_f32_16x16x32_bf16 a[56:59], a[208:211], v[244:247], a[56:59]
    s_waitcnt lgkmcnt(6)
    v_exp_f32 v239, v223
    v_mfma_f32_16x16x32_bf16 a[68:71], a[212:215], v[244:247], a[68:71]
    ds_read_b64_tr_b16 a[228:229], v10 offset:49408
    v_add_f32 v63, v63, v239
    v_mfma_f32_16x16x32_bf16 a[64:67], a[212:215], v[180:183], a[64:67]
    ds_read_b64_tr_b16 a[230:231], v10 offset:57600
    v_mfma_f32_16x16x32_bf16 a[60:63], a[212:215], v[116:119], a[60:63]
    s_waitcnt lgkmcnt(6)
    v_exp_f32 v172, v156
    v_mfma_f32_16x16x32_bf16 a[72:75], a[216:219], v[116:119], a[72:75]
    ds_read_b64_tr_b16 a[232:233], v11 offset:49408
    v_add_f32 v62, v62, v172
    v_mfma_f32_16x16x32_bf16 a[76:79], a[216:219], v[180:183], a[76:79]
    ds_read_b64_tr_b16 a[234:235], v11 offset:57600
    v_mfma_f32_16x16x32_bf16 a[80:83], a[216:219], v[244:247], a[80:83]
    s_waitcnt lgkmcnt(6)
    v_exp_f32 v173, v157
    v_mfma_f32_16x16x32_bf16 a[92:95], a[220:223], v[244:247], a[92:95]
    ds_read_b64_tr_b16 a[236:237], v12 offset:49408
    v_add_f32 v62, v62, v173
    v_mfma_f32_16x16x32_bf16 a[88:91], a[220:223], v[180:183], a[88:91]
    ds_read_b64_tr_b16 a[238:239], v12 offset:57600
    v_mfma_f32_16x16x32_bf16 a[84:87], a[220:223], v[116:119], a[84:87]
    s_waitcnt lgkmcnt(6)
    v_exp_f32 v174, v158
    v_mfma_f32_16x16x32_bf16 a[96:99], a[224:227], v[116:119], a[96:99]
    ds_read_b64_tr_b16 a[192:193], v13 offset:49408
    v_add_f32 v62, v62, v174
    v_mfma_f32_16x16x32_bf16 a[100:103], a[224:227], v[180:183], a[100:103]
    ds_read_b64_tr_b16 a[194:195], v13 offset:57600
    v_mfma_f32_16x16x32_bf16 a[104:107], a[224:227], v[244:247], a[104:107]
    s_waitcnt lgkmcnt(6)
    v_exp_f32 v175, v159
    v_mfma_f32_16x16x32_bf16 a[116:119], a[228:231], v[244:247], a[116:119]
    ds_read_b64_tr_b16 a[196:197], v14 offset:49408
    v_add_f32 v62, v62, v175
    v_mfma_f32_16x16x32_bf16 a[112:115], a[228:231], v[180:183], a[112:115]
    ds_read_b64_tr_b16 a[198:199], v14 offset:57600
    v_mfma_f32_16x16x32_bf16 a[108:111], a[228:231], v[116:119], a[108:111]
    s_waitcnt lgkmcnt(6)
    v_exp_f32 v108, v92
    v_mfma_f32_16x16x32_bf16 a[120:123], a[232:235], v[116:119], a[120:123]
    ds_read_b64_tr_b16 a[200:201], v15 offset:49408
    v_add_f32 v61, v61, v108
    v_mfma_f32_16x16x32_bf16 a[124:127], a[232:235], v[180:183], a[124:127]
    ds_read_b64_tr_b16 a[202:203], v15 offset:57600
    v_mfma_f32_16x16x32_bf16 a[128:131], a[232:235], v[244:247], a[128:131]
    s_waitcnt lgkmcnt(6)
    v_exp_f32 v109, v93
    v_mfma_f32_16x16x32_bf16 a[140:143], a[236:239], v[244:247], a[140:143]
    ds_read_b64_tr_b16 a[204:205], v16 offset:49408
    v_add_f32 v61, v61, v109
    v_mfma_f32_16x16x32_bf16 a[136:139], a[236:239], v[180:183], a[136:139]
    ds_read_b64_tr_b16 a[206:207], v16 offset:57600
    v_mfma_f32_16x16x32_bf16 a[132:135], a[236:239], v[116:119], a[132:135]
    s_waitcnt lgkmcnt(6)
    s_waitcnt vmcnt(22)
    s_barrier
    v_mfma_f32_16x16x32_bf16 a[144:147], a[192:195], v[116:119], a[144:147]
    ds_read_b128 a[208:211], v29 offset:16384
    v_mfma_f32_16x16x32_bf16 a[148:151], a[192:195], v[180:183], a[148:151]
    v_exp_f32 v110, v94
    v_mfma_f32_16x16x32_bf16 a[152:155], a[192:195], v[244:247], a[152:155]
    s_waitcnt lgkmcnt(5)
    v_exp_f32 v111, v95
    v_mfma_f32_16x16x32_bf16 a[164:167], a[196:199], v[244:247], a[164:167]
    ds_read_b128 a[212:215], v30 offset:16384
    v_add_f32 v61, v61, v110
    v_mfma_f32_16x16x32_bf16 a[160:163], a[196:199], v[180:183], a[160:163]
    s_add_u32 m0, s28, 131072
    v_mfma_f32_16x16x32_bf16 a[156:159], a[196:199], v[116:119], a[156:159]
    s_waitcnt lgkmcnt(4)
    s_xor_b32 s29, s61, 132096
    v_add_f32 v61, v61, v111
    v_mfma_f32_16x16x32_bf16 a[168:171], a[200:203], v[116:119], a[168:171]
    ds_read_b128 a[216:219], v31 offset:16384
    buffer_load_dwordx4 v49, s[12:15], s29 offen nt lds
    v_mfma_f32_16x16x32_bf16 a[172:175], a[200:203], v[180:183], a[172:175]
    v_max3_f32 v0, v61, v62, v63
    v_cmp_lt_f32 vcc, s35, v0
    v_mfma_f32_16x16x32_bf16 a[176:179], a[200:203], v[244:247], a[176:179]
    s_waitcnt lgkmcnt(3)
    v_mfma_f32_16x16x32_bf16 a[188:191], a[204:207], v[244:247], a[188:191]
    ds_read_b128 a[220:223], v32 offset:16384
    buffer_load_dwordx4 v50, s[12:15], s29 offen offset:1024 nt lds
    v_mfma_f32_16x16x32_bf16 a[184:187], a[204:207], v[180:183], a[184:187]
    v_mfma_f32_16x16x32_bf16 a[180:183], a[204:207], v[116:119], a[180:183]
    s_cbranch_vccnz L_rare5
L_ret5:
    s_waitcnt lgkmcnt(2)
    v_cvt_pk_bf16_f32 v116, v100, v101
    v_mfma_f32_16x16x32_bf16 v[84:87], a[208:211], v[64:67], v[124:127]
    ds_read_b128 a[224:227], v29 offset:16640
    buffer_load_dwordx4 v51, s[12:15], s29 offen offset:2048 nt lds
    v_mfma_f32_16x16x32_bf16 v[84:87], a[212:215], v[72:75], v[84:87]
    v_cvt_pk_bf16_f32 v117, v102, v103
    v_cvt_pk_bf16_f32 v118, v108, v109
    v_mfma_f32_16x16x32_bf16 v[148:151], a[212:215], v[136:139], v[188:191]
    v_cvt_pk_bf16_f32 v119, v110, v111
    v_cvt_pk_bf16_f32 v180, v164, v165
    v_mfma_f32_16x16x32_bf16 v[148:151], a[208:211], v[128:131], v[148:151]
    ds_read_b128 a[228:231], v30 offset:16640
    buffer_load_dwordx4 v52, s[12:15], s29 offen offset:3072 nt lds
    v_mfma_f32_16x16x32_bf16 v[212:215], a[208:211], v[192:195], v[252:255]
    v_cvt_pk_bf16_f32 v181, v166, v167
    v_cvt_pk_bf16_f32 v182, v172, v173
    v_mfma_f32_16x16x32_bf16 v[212:215], a[212:215], v[200:203], v[212:215]
    s_waitcnt lgkmcnt(2)
    v_cvt_pk_bf16_f32 v183, v174, v175
    v_cvt_pk_bf16_f32 v244, v228, v229
    v_mfma_f32_16x16x32_bf16 v[212:215], a[216:219], v[208:211], v[212:215]
    ds_read_b128 a[232:235], v31 offset:16640
    v_cvt_pk_bf16_f32 v245, v230, v231
    v_mfma_f32_16x16x32_bf16 v[212:215], a[220:223], v[216:219], v[212:215]
    v_cvt_pk_bf16_f32 v246, v236, v237
    v_cvt_pk_bf16_f32 v247, v238, v239
    v_mfma_f32_16x16x32_bf16 v[148:151], a[220:223], v[152:155], v[148:151]
    v_add_f32 v58, v58, v61
    v_add_f32 v59, v59, v62
    v_mfma_f32_16x16x32_bf16 v[148:151], a[216:219], v[144:147], v[148:151]
    ds_read_b128 a[236:239], v32 offset:16640
    v_add_f32 v60, v60, v63
    v_mfma_f32_16x16x32_bf16 v[84:87], a[216:219], v[80:83], v[84:87]
    v_mfma_f32_16x16x32_bf16 v[84:87], a[220:223], v[88:91], v[84:87]
    s_waitcnt lgkmcnt(2)
    v_mfma_f32_16x16x32_bf16 v[84:87], a[224:227], v[96:99], v[84:87]
    ds_read_b128 a[192:195], v29 offset:24576
    v_mfma_f32_16x16x32_bf16 v[84:87], a[228:231], v[104:107], v[84:87]
    v_mfma_f32_16x16x32_bf16 v[148:151], a[228:231], v[168:171], v[148:151]
    v_mfma_f32_16x16x32_bf16 v[148:151], a[224:227], v[160:163], v[148:151]
    ds_read_b128 a[196:199], v30 offset:24576
    v_mfma_f32_16x16x32_bf16 v[212:215], a[224:227], v[224:227], v[212:215]
    v_mfma_f32_16x16x32_bf16 v[212:215], a[228:231], v[232:235], v[212:215]
    s_waitcnt lgkmcnt(2)
    v_mfma_f32_16x16x32_bf16 v[212:215], a[232:235], v[240:243], v[212:215]
    ds_read_b128 a[200:203], v31 offset:24576
    v_mfma_f32_16x16x32_bf16 v[212:215], a[236:239], v[248:251], v[212:215]
    v_mfma_f32_16x16x32_bf16 v[148:151], a[236:239], v[184:187], v[148:151]
    v_mfma_f32_16x16x32_bf16 v[148:151], a[232:235], v[176:179], v[148:151]
    ds_read_b128 a[204:207], v32 offset:24576
    v_mfma_f32_16x16x32_bf16 v[84:87], a[232:235], v[112:115], v[84:87]
    v_mfma_f32_16x16x32_bf16 v[84:87], a[236:239], v[120:123], v[84:87]
    s_waitcnt lgkmcnt(2)
    v_mfma_f32_16x16x32_bf16 v[92:95], a[192:195], v[64:67], v[124:127]
    ds_read_b128 a[208:211], v29 offset:24832
    v_mfma_f32_16x16x32_bf16 v[92:95], a[196:199], v[72:75], v[92:95]
    v_exp_f32 v228, v212
    v_mfma_f32_16x16x32_bf16 v[156:159], a[196:199], v[136:139], v[188:191]
    v_exp_f32 v229, v213
    v_mfma_f32_16x16x32_bf16 v[156:159], a[192:195], v[128:131], v[156:159]
    ds_read_b128 a[212:215], v30 offset:24832
    v_add_f32 v63, v228, v229
    v_mfma_f32_16x16x32_bf16 v[220:223], a[192:195], v[192:195], v[252:255]
    v_exp_f32 v230, v214
    v_mfma_f32_16x16x32_bf16 v[220:223], a[196:199], v[200:203], v[220:223]
    s_waitcnt lgkmcnt(2)
    v_exp_f32 v231, v215
    v_mfma_f32_16x16x32_bf16 v[220:223], a[200:203], v[208:211], v[220:223]
    ds_read_b128 a[216:219], v31 offset:24832
    v_add_f32 v63, v63, v230
    v_mfma_f32_16x16x32_bf16 v[220:223], a[204:207], v[216:219], v[220:223]
    v_exp_f32 v164, v148
    v_mfma_f32_16x16x32_bf16 v[156:159], a[204:207], v[152:155], v[156:159]
    v_exp_f32 v165, v149
    v_mfma_f32_16x16x32_bf16 v[156:159], a[200:203], v[144:147], v[156:159]
    ds_read_b128 a[220:223], v32 offset:24832
    v_add_f32 v62, v164, v165
    v_mfma_f32_16x16x32_bf16 v[92:95], a[200:203], v[80:83], v[92:95]
    v_exp_f32 v166, v150
    v_mfma_f32_16x16x32_bf16 v[92:95], a[204:207], v[88:91], v[92:95]
    s_waitcnt lgkmcnt(2)
    s_waitcnt vmcnt(22)
    s_barrier
    v_mfma_f32_16x16x32_bf16 v[92:95], a[208:211], v[96:99], v[92:95]
    ds_read_b64_tr_b16 a[224:225], v1 offset:0
    v_add_f32 v62, v62, v166
    v_mfma_f32_16x16x32_bf16 v[92:95], a[212:215], v[104:107], v[92:95]
    ds_read_b64_tr_b16 a[226:227], v1 offset:8192
    v_add_f32 v63, v63, v231
    v_mfma_f32_16x16x32_bf16 v[156:159], a[212:215], v[168:171], v[156:159]
    v_exp_f32 v167, v151
    v_mfma_f32_16x16x32_bf16 v[156:159], a[208:211], v[160:163], v[156:159]
    ds_read_b64_tr_b16 a[228:229], v2 offset:0
    v_add_f32 v62, v62, v167
    v_mfma_f32_16x16x32_bf16 v[220:223], a[208:211], v[224:227], v[220:223]
    ds_read_b64_tr_b16 a[230:231], v2 offset:8192
    v_mfma_f32_16x16x32_bf16 v[220:223], a[212:215], v[232:235], v[220:223]
    s_waitcnt lgkmcnt(4)
    v_exp_f32 v100, v84
    v_mfma_f32_16x16x32_bf16 v[220:223], a[216:219], v[240:243], v[220:223]
    ds_read_b64_tr_b16 a[232:233], v3 offset:0
    v_mfma_f32_16x16x32_bf16 v[220:223], a[220:223], v[248:251], v[220:223]
    ds_read_b64_tr_b16 a[234:235], v3 offset:8192
    v_mfma_f32_16x16x32_bf16 v[156:159], a[220:223], v[184:187], v[156:159]
    v_exp_f32 v101, v85
    v_mfma_f32_16x16x32_bf16 v[156:159], a[216:219], v[176:179], v[156:159]
    ds_read_b64_tr_b16 a[236:237], v4 offset:0
    v_add_f32 v61, v100, v101
    v_mfma_f32_16x16x32_bf16 v[92:95], a[216:219], v[112:115], v[92:95]
    ds_read_b64_tr_b16 a[238:239], v4 offset:8192
    v_mfma_f32_16x16x32_bf16 v[92:95], a[220:223], v[120:123], v[92:95]
    s_waitcnt lgkmcnt(6)
    v_exp_f32 v102, v86
    v_mfma_f32_16x16x32_bf16 a[0:3], a[224:227], v[116:119], a[0:3]
    ds_read_b64_tr_b16 a[192:193], v5 offset:0
    v_add_f32 v61, v61, v102
    v_mfma_f32_16x16x32_bf16 a[4:7], a[224:227], v[180:183], a[4:7]
    s_add_u32 m0, s28, 16384
    ds_read_b64_tr_b16 a[194:195], v5 offset:8192
    v_mfma_f32_16x16x32_bf16 a[8:11], a[224:227], v[244:247], a[8:11]
    s_waitcnt lgkmcnt(6)
    s_xor_b32 s29, s61, 131072
    v_mfma_f32_16x16x32_bf16 a[20:23], a[228:231], v[244:247], a[20:23]
    ds_read_b64_tr_b16 a[196:197], v6 offset:0
    buffer_load_dwordx4 v49, s[16:19], s29 offen nt lds
    v_mfma_f32_16x16x32_bf16 a[16:19], a[228:231], v[180:183], a[16:19]
    ds_read_b64_tr_b16 a[198:199], v6 offset:8192
    v_mfma_f32_16x16x32_bf16 a[12:15], a[228:231], v[116:119], a[12:15]
    s_waitcnt lgkmcnt(6)
    v_exp_f32 v103, v87
    v_mfma_f32_16x16x32_bf16 a[24:27], a[232:235], v[116:119], a[24:27]
    ds_read_b64_tr_b16 a[200:201], v7 offset:0
    buffer_load_dwordx4 v50, s[16:19], s29 offen offset:1024 nt lds
    v_mfma_f32_16x16x32_bf16 a[28:31], a[232:235], v[180:183], a[28:31]
    ds_read_b64_tr_b16 a[202:203], v7 offset:8192
    v_add_f32 v61, v61, v103
    v_mfma_f32_16x16x32_bf16 a[32:35], a[232:235], v[244:247], a[32:35]
    s_waitcnt lgkmcnt(6)
    v_exp_f32 v236, v220
    v_mfma_f32_16x16x32_bf16 a[44:47], a[236:239], v[244:247], a[44:47]
    ds_read_b64_tr_b16 a[204:205], v8 offset:0
    buffer_load_dwordx4 v51, s[16:19], s29 offen offset:2048 nt lds
    s_cmp_eq_u32 s63, 2
    s_cselect_b32 s52, s85, 4096
    v_mfma_f32_16x16x32_bf16 a[40:43], a[236:239], v[180:183], a[40:43]
    ds_read_b64_tr_b16 a[206:207], v8 offset:8192
    v_add_f32 v63, v63, v236
    v_mfma_f32_16x16x32_bf16 a[36:39], a[236:239], v[116:119], a[36:39]
    s_waitcnt lgkmcnt(6)
    v_exp_f32 v237, v221
    v_mfma_f32_16x16x32_bf16 a[48:51], a[192:195], v[116:119], a[48:51]
    ds_read_b64_tr_b16 a[208:209], v1 offset:256
    buffer_load_dwordx4 v52, s[16:19], s29 offen offset:3072 nt lds
    v_mfma_f32_16x16x32_bf16 a[52:55], a[192:195], v[180:183], a[52:55]
    ds_read_b64_tr_b16 a[210:211], v1 offset:8448
    v_add_f32 v63, v63, v237
    v_mfma_f32_16x16x32_bf16 a[56:59], a[192:195], v[244:247], a[56:59]
    s_waitcnt lgkmcnt(6)
    v_exp_f32 v238, v222
    v_mfma_f32_16x16x32_bf16 a[68:71], a[196:199], v[244:247], a[68:71]
    ds_read_b64_tr_b16 a[212:213], v2 offset:256
    v_add_f32 v63, v63, v238
    v_mfma_f32_16x16x32_bf16 a[64:67], a[196:199], v[180:183], a[64:67]
    ds_read_b64_tr_b16 a[214:215], v2 offset:8448
    buffer_atomic_add v132, v134, s[40:43], s52 offen sc1
    v_mfma_f32_16x16x32_bf16 a[60:63], a[196:199], v[116:119], a[60:63]
    s_waitcnt lgkmcnt(6)
    v_exp_f32 v239, v223
    v_mfma_f32_16x16x32_bf16 a[72:75], a[200:203], v[116:119], a[72:75]
    ds_read_b64_tr_b16 a[216:217], v3 offset:256
    v_add_f32 v63, v63, v239
    v_mfma_f32_16x16x32_bf16 a[76:79], a[200:203], v[180:183], a[76:79]
    ds_read_b64_tr_b16 a[218:219], v3 offset:8448
    v_mfma_f32_16x16x32_bf16 a[80:83], a[200:203], v[244:247], a[80:83]
    s_waitcnt lgkmcnt(6)
    v_exp_f32 v172, v156
    v_mfma_f32_16x16x32_bf16 a[92:95], a[204:207], v[244:247], a[92:95]
    ds_read_b64_tr_b16 a[220:221], v4 offset:256
    v_add_f32 v62, v62, v172
    v_mfma_f32_16x16x32_bf16 a[88:91], a[204:207], v[180:183], a[88:91]
    ds_read_b64_tr_b16 a[222:223], v4 offset:8448
    v_mfma_f32_16x16x32_bf16 a[84:87], a[204:207], v[116:119], a[84:87]
    s_waitcnt lgkmcnt(6)
    v_exp_f32 v173, v157
    v_mfma_f32_16x16x32_bf16 a[96:99], a[208:211], v[116:119], a[96:99]
    ds_read_b64_tr_b16 a[224:225], v5 offset:256
    v_add_f32 v62, v62, v173
    v_mfma_f32_16x16x32_bf16 a[100:103], a[208:211], v[180:183], a[100:103]
    ds_read_b64_tr_b16 a[226:227], v5 offset:8448
    v_mfma_f32_16x16x32_bf16 a[104:107], a[208:211], v[244:247], a[104:107]
    s_waitcnt lgkmcnt(6)
    v_exp_f32 v174, v158
    v_mfma_f32_16x16x32_bf16 a[116:119], a[212:215], v[244:247], a[116:119]
    ds_read_b64_tr_b16 a[228:229], v6 offset:256
    v_add_f32 v62, v62, v174
    v_mfma_f32_16x16x32_bf16 a[112:115], a[212:215], v[180:183], a[112:115]
    ds_read_b64_tr_b16 a[230:231], v6 offset:8448
    v_mfma_f32_16x16x32_bf16 a[108:111], a[212:215], v[116:119], a[108:111]
    s_waitcnt lgkmcnt(6)
    v_exp_f32 v175, v159
    v_mfma_f32_16x16x32_bf16 a[120:123], a[216:219], v[116:119], a[120:123]
    ds_read_b64_tr_b16 a[232:233], v7 offset:256
    v_add_f32 v62, v62, v175
    v_mfma_f32_16x16x32_bf16 a[124:127], a[216:219], v[180:183], a[124:127]
    ds_read_b64_tr_b16 a[234:235], v7 offset:8448
    v_mfma_f32_16x16x32_bf16 a[128:131], a[216:219], v[244:247], a[128:131]
    s_waitcnt lgkmcnt(6)
    v_exp_f32 v108, v92
    v_mfma_f32_16x16x32_bf16 a[140:143], a[220:223], v[244:247], a[140:143]
    ds_read_b64_tr_b16 a[236:237], v8 offset:256
    v_add_f32 v61, v61, v108
    v_mfma_f32_16x16x32_bf16 a[136:139], a[220:223], v[180:183], a[136:139]
    ds_read_b64_tr_b16 a[238:239], v8 offset:8448
    v_mfma_f32_16x16x32_bf16 a[132:135], a[220:223], v[116:119], a[132:135]
    s_waitcnt lgkmcnt(6)
    s_waitcnt vmcnt(23)
    s_barrier
    v_mfma_f32_16x16x32_bf16 a[144:147], a[224:227], v[116:119], a[144:147]
    ds_read_b128 a[192:195], v33 offset:16384
    v_mfma_f32_16x16x32_bf16 a[148:151], a[224:227], v[180:183], a[148:151]
    v_exp_f32 v109, v93
    v_mfma_f32_16x16x32_bf16 a[152:155], a[224:227], v[244:247], a[152:155]
    s_waitcnt lgkmcnt(5)
    v_exp_f32 v110, v94
    v_mfma_f32_16x16x32_bf16 a[164:167], a[228:231], v[244:247], a[164:167]
    ds_read_b128 a[196:199], v34 offset:16384
    v_add_f32 v61, v61, v109
    v_mfma_f32_16x16x32_bf16 a[160:163], a[228:231], v[180:183], a[160:163]
    v_exp_f32 v111, v95
    v_mfma_f32_16x16x32_bf16 a[156:159], a[228:231], v[116:119], a[156:159]
    s_waitcnt lgkmcnt(4)
    v_mfma_f32_16x16x32_bf16 a[168:171], a[232:235], v[116:119], a[168:171]
    ds_read_b128 a[200:203], v35 offset:16384
    v_add_f32 v61, v61, v110
    v_mfma_f32_16x16x32_bf16 a[172:175], a[232:235], v[180:183], a[172:175]
    v_mfma_f32_16x16x32_bf16 a[176:179], a[232:235], v[244:247], a[176:179]
    s_waitcnt lgkmcnt(3)
    v_mfma_f32_16x16x32_bf16 a[188:191], a[236:239], v[244:247], a[188:191]
    ds_read_b128 a[204:207], v36 offset:16384
    v_add_f32 v61, v61, v111
    v_mfma_f32_16x16x32_bf16 a[184:187], a[236:239], v[180:183], a[184:187]
    v_max3_f32 v0, v61, v62, v63
    v_cmp_lt_f32 vcc, s35, v0
    v_mfma_f32_16x16x32_bf16 a[180:183], a[236:239], v[116:119], a[180:183]
    s_cbranch_vccnz L_rare6
L_ret6:
    s_waitcnt lgkmcnt(2)
    v_cvt_pk_bf16_f32 v116, v100, v101
    v_mfma_f32_16x16x32_bf16 v[84:87], a[192:195], v[64:67], v[124:127]
    ds_read_b128 a[208:211], v33 offset:16640
    v_cvt_pk_bf16_f32 v117, v102, v103
    v_mfma_f32_16x16x32_bf16 v[84:87], a[196:199], v[72:75], v[84:87]
    v_cvt_pk_bf16_f32 v118, v108, v109
    v_cvt_pk_bf16_f32 v119, v110, v111
    v_mfma_f32_16x16x32_bf16 v[148:151], a[196:199], v[136:139], v[188:191]
    v_cvt_pk_bf16_f32 v180, v164, v165
    v_cvt_pk_bf16_f32 v181, v166, v167
    v_mfma_f32_16x16x32_bf16 v[148:151], a[192:195], v[128:131], v[148:151]
    ds_read_b128 a[212:215], v34 offset:16640
    v_cvt_pk_bf16_f32 v182, v172, v173
    v_mfma_f32_16x16x32_bf16 v[212:215], a[192:195], v[192:195], v[252:255]
    v_cvt_pk_bf16_f32 v183, v174, v175
    v_cvt_pk_bf16_f32 v244, v228, v229
    v_mfma_f32_16x16x32_bf16 v[212:215], a[196:199], v[200:203], v[212:215]
    s_waitcnt lgkmcnt(2)
    v_cvt_pk_bf16_f32 v245, v230, v231
    v_cvt_pk_bf16_f32 v246, v236, v237
    v_mfma_f32_16x16x32_bf16 v[212:215], a[200:203], v[208:211], v[212:215]
    ds_read_b128 a[216:219], v35 offset:16640
    v_cvt_pk_bf16_f32 v247, v238, v239
    v_mfma_f32_16x16x32_bf16 v[212:215], a[204:207], v[216:219], v[212:215]
    v_add_f32 v58, v58, v61
    v_add_f32 v59, v59, v62
    v_mfma_f32_16x16x32_bf16 v[148:151], a[204:207], v[152:155], v[148:151]
    v_add_f32 v60, v60, v63
    v_mfma_f32_16x16x32_bf16 v[148:151], a[200:203], v[144:147], v[148:151]
    ds_read_b128 a[220:223], v36 offset:16640
    v_mfma_f32_16x16x32_bf16 v[84:87], a[200:203], v[80:83], v[84:87]
    s_add_u32 m0, s28, 49152
    v_mfma_f32_16x16x32_bf16 v[84:87], a[204:207], v[88:91], v[84:87]
    s_waitcnt lgkmcnt(2)
    s_xor_b32 s29, s61, 133120
    v_mfma_f32_16x16x32_bf16 v[84:87], a[208:211], v[96:99], v[84:87]
    ds_read_b128 a[224:227], v33 offset:24576
    buffer_load_dwordx4 v49, s[12:15], s29 offen nt lds
    v_mfma_f32_16x16x32_bf16 v[84:87], a[212:215], v[104:107], v[84:87]
    v_mfma_f32_16x16x32_bf16 v[148:151], a[212:215], v[168:171], v[148:151]
    v_mfma_f32_16x16x32_bf16 v[148:151], a[208:211], v[160:163], v[148:151]
    ds_read_b128 a[228:231], v34 offset:24576
    buffer_load_dwordx4 v50, s[12:15], s29 offen offset:1024 nt lds
    v_mfma_f32_16x16x32_bf16 v[212:215], a[208:211], v[224:227], v[212:215]
    v_mfma_f32_16x16x32_bf16 v[212:215], a[212:215], v[232:235], v[212:215]
    s_waitcnt lgkmcnt(2)
    v_mfma_f32_16x16x32_bf16 v[212:215], a[216:219], v[240:243], v[212:215]
    ds_read_b128 a[232:235], v35 offset:24576
    buffer_load_dwordx4 v51, s[12:15], s29 offen offset:2048 nt lds
    v_mfma_f32_16x16x32_bf16 v[212:215], a[220:223], v[248:251], v[212:215]
    v_mfma_f32_16x16x32_bf16 v[148:151], a[220:223], v[184:187], v[148:151]
    v_mfma_f32_16x16x32_bf16 v[148:151], a[216:219], v[176:179], v[148:151]
    ds_read_b128 a[236:239], v36 offset:24576
    buffer_load_dwordx4 v52, s[12:15], s29 offen offset:3072 nt lds
    v_mfma_f32_16x16x32_bf16 v[84:87], a[216:219], v[112:115], v[84:87]
    v_mfma_f32_16x16x32_bf16 v[84:87], a[220:223], v[120:123], v[84:87]
    s_waitcnt lgkmcnt(2)
    v_mfma_f32_16x16x32_bf16 v[92:95], a[224:227], v[64:67], v[124:127]
    ds_read_b128 a[192:195], v33 offset:24832
    v_mfma_f32_16x16x32_bf16 v[92:95], a[228:231], v[72:75], v[92:95]
    v_exp_f32 v228, v212
    v_mfma_f32_16x16x32_bf16 v[156:159], a[228:231], v[136:139], v[188:191]
    v_exp_f32 v229, v213
    v_mfma_f32_16x16x32_bf16 v[156:159], a[224:227], v[128:131], v[156:159]
    ds_read_b128 a[196:199], v34 offset:24832
    v_add_f32 v63, v228, v229
    v_mfma_f32_16x16x32_bf16 v[220:223], a[224:227], v[192:195], v[252:255]
    v_exp_f32 v230, v214
    v_mfma_f32_16x16x32_bf16 v[220:223], a[228:231], v[200:203], v[220:223]
    s_waitcnt lgkmcnt(2)
    v_exp_f32 v231, v215
    v_mfma_f32_16x16x32_bf16 v[220:223], a[232:235], v[208:211], v[220:223]
    ds_read_b128 a[200:203], v35 offset:24832
    v_add_f32 v63, v63, v230
    v_mfma_f32_16x16x32_bf16 v[220:223], a[236:239], v[216:219], v[220:223]
    v_exp_f32 v164, v148
    v_mfma_f32_16x16x32_bf16 v[156:159], a[236:239], v[152:155], v[156:159]
    v_exp_f32 v165, v149
    v_mfma_f32_16x16x32_bf16 v[156:159], a[232:235], v[144:147], v[156:159]
    ds_read_b128 a[204:207], v36 offset:24832
    v_add_f32 v62, v164, v165
    v_mfma_f32_16x16x32_bf16 v[92:95], a[232:235], v[80:83], v[92:95]
    v_exp_f32 v166, v150
    v_mfma_f32_16x16x32_bf16 v[92:95], a[236:239], v[88:91], v[92:95]
    s_waitcnt lgkmcnt(2)
    s_waitcnt vmcnt(22)
    s_barrier
    v_mfma_f32_16x16x32_bf16 v[92:95], a[192:195], v[96:99], v[92:95]
    ds_read_b64_tr_b16 a[208:209], v1 offset:32768
    v_add_f32 v62, v62, v166
    v_mfma_f32_16x16x32_bf16 v[92:95], a[196:199], v[104:107], v[92:95]
    ds_read_b64_tr_b16 a[210:211], v1 offset:40960
    v_add_f32 v63, v63, v231
    v_mfma_f32_16x16x32_bf16 v[156:159], a[196:199], v[168:171], v[156:159]
    v_exp_f32 v167, v151
    v_mfma_f32_16x16x32_bf16 v[156:159], a[192:195], v[160:163], v[156:159]
    ds_read_b64_tr_b16 a[212:213], v2 offset:32768
    v_add_f32 v62, v62, v167
    v_mfma_f32_16x16x32_bf16 v[220:223], a[192:195], v[224:227], v[220:223]
    ds_read_b64_tr_b16 a[214:215], v2 offset:40960
    v_mfma_f32_16x16x32_bf16 v[220:223], a[196:199], v[232:235], v[220:223]
    s_waitcnt lgkmcnt(4)
    v_exp_f32 v100, v84
    v_mfma_f32_16x16x32_bf16 v[220:223], a[200:203], v[240:243], v[220:223]
    ds_read_b64_tr_b16 a[216:217], v3 offset:32768
    v_mfma_f32_16x16x32_bf16 v[220:223], a[204:207], v[248:251], v[220:223]
    ds_read_b64_tr_b16 a[218:219], v3 offset:40960
    v_mfma_f32_16x16x32_bf16 v[156:159], a[204:207], v[184:187], v[156:159]
    v_exp_f32 v101, v85
    v_mfma_f32_16x16x32_bf16 v[156:159], a[200:203], v[176:179], v[156:159]
    ds_read_b64_tr_b16 a[220:221], v4 offset:32768
    v_add_f32 v61, v100, v101
    v_mfma_f32_16x16x32_bf16 v[92:95], a[200:203], v[112:115], v[92:95]
    ds_read_b64_tr_b16 a[222:223], v4 offset:40960
    v_mfma_f32_16x16x32_bf16 v[92:95], a[204:207], v[120:123], v[92:95]
    s_waitcnt lgkmcnt(6)
    v_exp_f32 v102, v86
    v_mfma_f32_16x16x32_bf16 a[0:3], a[208:211], v[116:119], a[0:3]
    ds_read_b64_tr_b16 a[224:225], v5 offset:32768
    v_add_f32 v61, v61, v102
    v_mfma_f32_16x16x32_bf16 a[4:7], a[208:211], v[180:183], a[4:7]
    ds_read_b64_tr_b16 a[226:227], v5 offset:40960
    v_mfma_f32_16x16x32_bf16 a[8:11], a[208:211], v[244:247], a[8:11]
    s_waitcnt lgkmcnt(6)
    v_exp_f32 v103, v87
    v_mfma_f32_16x16x32_bf16 a[20:23], a[212:215], v[244:247], a[20:23]
    ds_read_b64_tr_b16 a[228:229], v6 offset:32768
    v_add_f32 v61, v61, v103
    v_mfma_f32_16x16x32_bf16 a[16:19], a[212:215], v[180:183], a[16:19]
    ds_read_b64_tr_b16 a[230:231], v6 offset:40960
    v_mfma_f32_16x16x32_bf16 a[12:15], a[212:215], v[116:119], a[12:15]
    s_waitcnt lgkmcnt(6)
    v_exp_f32 v236, v220
    v_mfma_f32_16x16x32_bf16 a[24:27], a[216:219], v[116:119], a[24:27]
    ds_read_b64_tr_b16 a[232:233], v7 offset:32768
    v_add_f32 v63, v63, v236
    v_mfma_f32_16x16x32_bf16 a[28:31], a[216:219], v[180:183], a[28:31]
    ds_read_b64_tr_b16 a[234:235], v7 offset:40960
    v_mfma_f32_16x16x32_bf16 a[32:35], a[216:219], v[244:247], a[32:35]
    s_waitcnt lgkmcnt(6)
    v_exp_f32 v237, v221
    v_mfma_f32_16x16x32_bf16 a[44:47], a[220:223], v[244:247], a[44:47]
    ds_read_b64_tr_b16 a[236:237], v8 offset:32768
    v_add_f32 v63, v63, v237
    v_mfma_f32_16x16x32_bf16 a[40:43], a[220:223], v[180:183], a[40:43]
    ds_read_b64_tr_b16 a[238:239], v8 offset:40960
    v_mfma_f32_16x16x32_bf16 a[36:39], a[220:223], v[116:119], a[36:39]
    s_waitcnt lgkmcnt(6)
    v_exp_f32 v238, v222
    v_mfma_f32_16x16x32_bf16 a[48:51], a[224:227], v[116:119], a[48:51]
    ds_read_b64_tr_b16 a[192:193], v1 offset:33024
    v_add_f32 v63, v63, v238
    v_mfma_f32_16x16x32_bf16 a[52:55], a[224:227], v[180:183], a[52:55]
    ds_read_b64_tr_b16 a[194:195], v1 offset:41216
    v_mfma_f32_16x16x32_bf16 a[56:59], a[224:227], v[244:247], a[56:59]
    s_waitcnt lgkmcnt(6)
    v_exp_f32 v239, v223
    v_mfma_f32_16x16x32_bf16 a[68:71], a[228:231], v[244:247], a[68:71]
    ds_read_b64_tr_b16 a[196:197], v2 offset:33024
    v_add_f32 v63, v63, v239
    v_mfma_f32_16x16x32_bf16 a[64:67], a[228:231], v[180:183], a[64:67]
    ds_read_b64_tr_b16 a[198:199], v2 offset:41216
    v_mfma_f32_16x16x32_bf16 a[60:63], a[228:231], v[116:119], a[60:63]
    s_waitcnt lgkmcnt(6)
    v_exp_f32 v172, v156
    v_mfma_f32_16x16x32_bf16 a[72:75], a[232:235], v[116:119], a[72:75]
    ds_read_b64_tr_b16 a[200:201], v3 offset:33024
    v_add_f32 v62, v62, v172
    v_mfma_f32_16x16x32_bf16 a[76:79], a[232:235], v[180:183], a[76:79]
    ds_read_b64_tr_b16 a[202:203], v3 offset:41216
    v_mfma_f32_16x16x32_bf16 a[80:83], a[232:235], v[244:247], a[80:83]
    s_waitcnt lgkmcnt(6)
    v_exp_f32 v173, v157
    v_mfma_f32_16x16x32_bf16 a[92:95], a[236:239], v[244:247], a[92:95]
    ds_read_b64_tr_b16 a[204:205], v4 offset:33024
    v_add_f32 v62, v62, v173
    v_mfma_f32_16x16x32_bf16 a[88:91], a[236:239], v[180:183], a[88:91]
    ds_read_b64_tr_b16 a[206:207], v4 offset:41216
    v_mfma_f32_16x16x32_bf16 a[84:87], a[236:239], v[116:119], a[84:87]
    s_waitcnt lgkmcnt(6)
    v_exp_f32 v174, v158
    v_mfma_f32_16x16x32_bf16 a[96:99], a[192:195], v[116:119], a[96:99]
    ds_read_b64_tr_b16 a[208:209], v5 offset:33024
    v_add_f32 v62, v62, v174
    v_mfma_f32_16x16x32_bf16 a[100:103], a[192:195], v[180:183], a[100:103]
    s_add_u32 m0, s28, 114688
    ds_read_b64_tr_b16 a[210:211], v5 offset:41216
    v_mfma_f32_16x16x32_bf16 a[104:107], a[192:195], v[244:247], a[104:107]
    s_waitcnt lgkmcnt(6)
    s_xor_b32 s29, s61, 132096
    v_mfma_f32_16x16x32_bf16 a[116:119], a[196:199], v[244:247], a[116:119]
    ds_read_b64_tr_b16 a[212:213], v6 offset:33024
    buffer_load_dwordx4 v49, s[16:19], s29 offen nt lds
    v_mfma_f32_16x16x32_bf16 a[112:115], a[196:199], v[180:183], a[112:115]
    ds_read_b64_tr_b16 a[214:215], v6 offset:41216
    v_mfma_f32_16x16x32_bf16 a[108:111], a[196:199], v[116:119], a[108:111]
    s_waitcnt lgkmcnt(6)
    v_exp_f32 v175, v159
    v_mfma_f32_16x16x32_bf16 a[120:123], a[200:203], v[116:119], a[120:123]
    ds_read_b64_tr_b16 a[216:217], v7 offset:33024
    buffer_load_dwordx4 v50, s[16:19], s29 offen offset:1024 nt lds
    v_mfma_f32_16x16x32_bf16 a[124:127], a[200:203], v[180:183], a[124:127]
    ds_read_b64_tr_b16 a[218:219], v7 offset:41216
    v_add_f32 v62, v62, v175
    v_mfma_f32_16x16x32_bf16 a[128:131], a[200:203], v[244:247], a[128:131]
    s_waitcnt lgkmcnt(6)
    v_exp_f32 v108, v92
    v_mfma_f32_16x16x32_bf16 a[140:143], a[204:207], v[244:247], a[140:143]
    ds_read_b64_tr_b16 a[220:221], v8 offset:33024
    buffer_load_dwordx4 v51, s[16:19], s29 offen offset:2048 nt lds
    v_mfma_f32_16x16x32_bf16 a[136:139], a[204:207], v[180:183], a[136:139]
    ds_read_b64_tr_b16 a[222:223], v8 offset:41216
    v_add_f32 v61, v61, v108
    v_mfma_f32_16x16x32_bf16 a[132:135], a[204:207], v[116:119], a[132:135]
    s_waitcnt lgkmcnt(6)
    s_waitcnt vmcnt(21)
    s_barrier
    v_mfma_f32_16x16x32_bf16 a[144:147], a[208:211], v[116:119], a[144:147]
    ds_read_b128 a[224:227], v29 offset:0
    buffer_load_dwordx4 v52, s[16:19], s29 offen offset:3072 nt lds
    v_mfma_f32_16x16x32_bf16 a[148:151], a[208:211], v[180:183], a[148:151]
    v_exp_f32 v109, v93
    v_mfma_f32_16x16x32_bf16 a[152:155], a[208:211], v[244:247], a[152:155]
    s_waitcnt lgkmcnt(5)
    v_exp_f32 v110, v94
    v_mfma_f32_16x16x32_bf16 a[164:167], a[212:215], v[244:247], a[164:167]
    ds_read_b128 a[228:231], v30 offset:0
    v_add_f32 v61, v61, v109
    v_mfma_f32_16x16x32_bf16 a[160:163], a[212:215], v[180:183], a[160:163]
    v_exp_f32 v111, v95
    v_mfma_f32_16x16x32_bf16 a[156:159], a[212:215], v[116:119], a[156:159]
    s_waitcnt lgkmcnt(4)
    v_mfma_f32_16x16x32_bf16 a[168:171], a[216:219], v[116:119], a[168:171]
    ds_read_b128 a[232:235], v31 offset:0
    v_add_f32 v61, v61, v110
    v_mfma_f32_16x16x32_bf16 a[172:175], a[216:219], v[180:183], a[172:175]
    v_mfma_f32_16x16x32_bf16 a[176:179], a[216:219], v[244:247], a[176:179]
    s_waitcnt lgkmcnt(3)
    v_mfma_f32_16x16x32_bf16 a[188:191], a[220:223], v[244:247], a[188:191]
    ds_read_b128 a[236:239], v32 offset:0
    v_add_f32 v61, v61, v111
    v_mfma_f32_16x16x32_bf16 a[184:187], a[220:223], v[180:183], a[184:187]
    v_max3_f32 v0, v61, v62, v63
    v_cmp_lt_f32 vcc, s35, v0
    v_mfma_f32_16x16x32_bf16 a[180:183], a[220:223], v[116:119], a[180:183]
    s_cbranch_vccnz L_rare7
L_ret7:
    s_waitcnt lgkmcnt(2)
    v_cvt_pk_bf16_f32 v116, v100, v101
    v_mfma_f32_16x16x32_bf16 v[84:87], a[224:227], v[64:67], v[124:127]
    ds_read_b128 a[192:195], v29 offset:256
    v_cvt_pk_bf16_f32 v117, v102, v103
    v_mfma_f32_16x16x32_bf16 v[84:87], a[228:231], v[72:75], v[84:87]
    v_cvt_pk_bf16_f32 v118, v108, v109
    v_cvt_pk_bf16_f32 v119, v110, v111
    v_mfma_f32_16x16x32_bf16 v[148:151], a[228:231], v[136:139], v[188:191]
    v_cvt_pk_bf16_f32 v180, v164, v165
    v_cvt_pk_bf16_f32 v181, v166, v167
    v_mfma_f32_16x16x32_bf16 v[148:151], a[224:227], v[128:131], v[148:151]
    ds_read_b128 a[196:199], v30 offset:256
    v_cvt_pk_bf16_f32 v182, v172, v173
    v_mfma_f32_16x16x32_bf16 v[212:215], a[224:227], v[192:195], v[252:255]
    v_cvt_pk_bf16_f32 v183, v174, v175
    v_cvt_pk_bf16_f32 v244, v228, v229
    v_mfma_f32_16x16x32_bf16 v[212:215], a[228:231], v[200:203], v[212:215]
    s_waitcnt lgkmcnt(2)
    v_cvt_pk_bf16_f32 v245, v230, v231
    v_cvt_pk_bf16_f32 v246, v236, v237
    v_mfma_f32_16x16x32_bf16 v[212:215], a[232:235], v[208:211], v[212:215]
    ds_read_b128 a[200:203], v31 offset:256
    v_cvt_pk_bf16_f32 v247, v238, v239
    v_mfma_f32_16x16x32_bf16 v[212:215], a[236:239], v[216:219], v[212:215]
    v_add_f32 v58, v58, v61
    v_add_f32 v59, v59, v62
    v_mfma_f32_16x16x32_bf16 v[148:151], a[236:239], v[152:155], v[148:151]
    v_add_f32 v60, v60, v63
    v_mfma_f32_16x16x32_bf16 v[148:151], a[232:235], v[144:147], v[148:151]
    ds_read_b128 a[204:207], v32 offset:256
    s_cmp_eq_u32 s63, 3
    s_cselect_b32 s52, s85, 4096
    v_mfma_f32_16x16x32_bf16 v[84:87], a[232:235], v[80:83], v[84:87]
    buffer_atomic_add v132, v134, s[40:43], s52 offen sc1
    v_mfma_f32_16x16x32_bf16 v[84:87], a[236:239], v[88:91], v[84:87]
    s_waitcnt lgkmcnt(2)
    v_mfma_f32_16x16x32_bf16 v[84:87], a[192:195], v[96:99], v[84:87]
    ds_read_b128 a[208:211], v29 offset:8192
    v_mfma_f32_16x16x32_bf16 v[84:87], a[196:199], v[104:107], v[84:87]
    v_mfma_f32_16x16x32_bf16 v[148:151], a[196:199], v[168:171], v[148:151]
    v_mfma_f32_16x16x32_bf16 v[148:151], a[192:195], v[160:163], v[148:151]
    ds_read_b128 a[212:215], v30 offset:8192
    v_mfma_f32_16x16x32_bf16 v[212:215], a[192:195], v[224:227], v[212:215]
    v_mfma_f32_16x16x32_bf16 v[212:215], a[196:199], v[232:235], v[212:215]
    s_waitcnt lgkmcnt(2)
    v_mfma_f32_16x16x32_bf16 v[212:215], a[200:203], v[240:243], v[212:215]
    ds_read_b128 a[216:219], v31 offset:8192
    v_mfma_f32_16x16x32_bf16 v[212:215], a[204:207], v[248:251], v[212:215]
    v_mfma_f32_16x16x32_bf16 v[148:151], a[204:207], v[184:187], v[148:151]
    v_mfma_f32_16x16x32_bf16 v[148:151], a[200:203], v[176:179], v[148:151]
    ds_read_b128 a[220:223], v32 offset:8192
    v_mfma_f32_16x16x32_bf16 v[84:87], a[200:203], v[112:115], v[84:87]
    v_mfma_f32_16x16x32_bf16 v[84:87], a[204:207], v[120:123], v[84:87]
    s_waitcnt lgkmcnt(2)
    v_mfma_f32_16x16x32_bf16 v[92:95], a[208:211], v[64:67], v[124:127]
    ds_read_b128 a[224:227], v29 offset:8448
    v_mfma_f32_16x16x32_bf16 v[92:95], a[212:215], v[72:75], v[92:95]
    v_exp_f32 v228, v212
    v_mfma_f32_16x16x32_bf16 v[156:159], a[212:215], v[136:139], v[188:191]
    v_exp_f32 v229, v213
    v_mfma_f32_16x16x32_bf16 v[156:159], a[208:211], v[128:131], v[156:159]
    ds_read_b128 a[228:231], v30 offset:8448
    v_add_f32 v63, v228, v229
    v_mfma_f32_16x16x32_bf16 v[220:223], a[208:211], v[192:195], v[252:255]
    v_exp_f32 v230, v214
    v_mfma_f32_16x16x32_bf16 v[220:223], a[212:215], v[200:203], v[220:223]
    s_waitcnt lgkmcnt(2)
    v_exp_f32 v231, v215
    v_mfma_f32_16x16x32_bf16 v[220:223], a[216:219], v[208:211], v[220:223]
    ds_read_b128 a[232:235], v31 offset:8448
    v_add_f32 v63, v63, v230
    v_mfma_f32_16x16x32_bf16 v[220:223], a[220:223], v[216:219], v[220:223]
    v_exp_f32 v164, v148
    v_mfma_f32_16x16x32_bf16 v[156:159], a[220:223], v[152:155], v[156:159]
    v_exp_f32 v165, v149
    v_mfma_f32_16x16x32_bf16 v[156:159], a[216:219], v[144:147], v[156:159]
    ds_read_b128 a[236:239], v32 offset:8448
    v_add_f32 v62, v164, v165
    v_mfma_f32_16x16x32_bf16 v[92:95], a[216:219], v[80:83], v[92:95]
    v_exp_f32 v166, v150
    v_mfma_f32_16x16x32_bf16 v[92:95], a[220:223], v[88:91], v[92:95]
    s_waitcnt lgkmcnt(2)
    s_waitcnt vmcnt(18)
    s_barrier
    v_mfma_f32_16x16x32_bf16 v[92:95], a[224:227], v[96:99], v[92:95]
    ds_read_b64_tr_b16 a[192:193], v9 offset:32768
    v_add_f32 v62, v62, v166
    v_mfma_f32_16x16x32_bf16 v[92:95], a[228:231], v[104:107], v[92:95]
    ds_read_b64_tr_b16 a[194:195], v9 offset:40960
    v_add_f32 v63, v63, v231
    v_mfma_f32_16x16x32_bf16 v[156:159], a[228:231], v[168:171], v[156:159]
    v_exp_f32 v167, v151
    v_mfma_f32_16x16x32_bf16 v[156:159], a[224:227], v[160:163], v[156:159]
    ds_read_b64_tr_b16 a[196:197], v10 offset:32768
    v_add_f32 v62, v62, v167
    v_mfma_f32_16x16x32_bf16 v[220:223], a[224:227], v[224:227], v[220:223]
    s_add_u32 m0, s28, 81920
    ds_read_b64_tr_b16 a[198:199], v10 offset:40960
    v_mfma_f32_16x16x32_bf16 v[220:223], a[228:231], v[232:235], v[220:223]
    s_waitcnt lgkmcnt(4)
    s_xor_b32 s29, s61, 134144
    v_mfma_f32_16x16x32_bf16 v[220:223], a[232:235], v[240:243], v[220:223]
    ds_read_b64_tr_b16 a[200:201], v11 offset:32768
    buffer_load_dwordx4 v49, s[12:15], s29 offen nt lds
    v_mfma_f32_16x16x32_bf16 v[220:223], a[236:239], v[248:251], v[220:223]
    ds_read_b64_tr_b16 a[202:203], v11 offset:40960
    v_mfma_f32_16x16x32_bf16 v[156:159], a[236:239], v[184:187], v[156:159]
    v_exp_f32 v100, v84
    v_mfma_f32_16x16x32_bf16 v[156:159], a[232:235], v[176:179], v[156:159]
    ds_read_b64_tr_b16 a[204:205], v12 offset:32768
    buffer_load_dwordx4 v50, s[12:15], s29 offen offset:1024 nt lds
    v_mfma_f32_16x16x32_bf16 v[92:95], a[232:235], v[112:115], v[92:95]
    ds_read_b64_tr_b16 a[206:207], v12 offset:40960
    v_mfma_f32_16x16x32_bf16 v[92:95], a[236:239], v[120:123], v[92:95]
    s_waitcnt lgkmcnt(6)
    v_exp_f32 v101, v85
    v_mfma_f32_16x16x32_bf16 a[0:3], a[192:195], v[116:119], a[0:3]
    ds_read_b64_tr_b16 a[208:209], v13 offset:32768
    buffer_load_dwordx4 v51, s[12:15], s29 offen offset:2048 nt lds
    v_mfma_f32_16x16x32_bf16 a[4:7], a[192:195], v[180:183], a[4:7]
    ds_read_b64_tr_b16 a[210:211], v13 offset:40960
    v_add_f32 v61, v100, v101
    v_mfma_f32_16x16x32_bf16 a[8:11], a[192:195], v[244:247], a[8:11]
    s_waitcnt lgkmcnt(6)
    v_exp_f32 v102, v86
    v_mfma_f32_16x16x32_bf16 a[20:23], a[196:199], v[244:247], a[20:23]
    ds_read_b64_tr_b16 a[212:213], v14 offset:32768
    buffer_load_dwordx4 v52, s[12:15], s29 offen offset:3072 nt lds
    v_mfma_f32_16x16x32_bf16 a[16:19], a[196:199], v[180:183], a[16:19]
    ds_read_b64_tr_b16 a[214:215], v14 offset:40960
    v_add_f32 v61, v61, v102
    v_mfma_f32_16x16x32_bf16 a[12:15], a[196:199], v[116:119], a[12:15]
    s_waitcnt lgkmcnt(6)
    v_exp_f32 v103, v87
    v_mfma_f32_16x16x32_bf16 a[24:27], a[200:203], v[116:119], a[24:27]
    ds_read_b64_tr_b16 a[216:217], v15 offset:32768
    v_add_f32 v61, v61, v103
    v_mfma_f32_16x16x32_bf16 a[28:31], a[200:203], v[180:183], a[28:31]
    ds_read_b64_tr_b16 a[218:219], v15 offset:40960
    v_mfma_f32_16x16x32_bf16 a[32:35], a[200:203], v[244:247], a[32:35]
    s_waitcnt lgkmcnt(6)
    v_exp_f32 v236, v220
    v_mfma_f32_16x16x32_bf16 a[44:47], a[204:207], v[244:247], a[44:47]
    ds_read_b64_tr_b16 a[220:221], v16 offset:32768
    v_add_f32 v63, v63, v236
    v_mfma_f32_16x16x32_bf16 a[40:43], a[204:207], v[180:183], a[40:43]
    ds_read_b64_tr_b16 a[222:223], v16 offset:40960
    v_mfma_f32_16x16x32_bf16 a[36:39], a[204:207], v[116:119], a[36:39]
    s_waitcnt lgkmcnt(6)
    v_exp_f32 v237, v221
    v_mfma_f32_16x16x32_bf16 a[48:51], a[208:211], v[116:119], a[48:51]
    ds_read_b64_tr_b16 a[224:225], v9 offset:33024
    v_add_f32 v63, v63, v237
    v_mfma_f32_16x16x32_bf16 a[52:55], a[208:211], v[180:183], a[52:55]
    ds_read_b64_tr_b16 a[226:227], v9 offset:41216
    v_mfma_f32_16x16x32_bf16 a[56:59], a[208:211], v[244:247], a[56:59]
    s_waitcnt lgkmcnt(6)
    v_exp_f32 v238, v222
    v_mfma_f32_16x16x32_bf16 a[68:71], a[212:215], v[244:247], a[68:71]
    ds_read_b64_tr_b16 a[228:229], v10 offset:33024
    v_add_f32 v63, v63, v238
    v_mfma_f32_16x16x32_bf16 a[64:67], a[212:215], v[180:183], a[64:67]
    ds_read_b64_tr_b16 a[230:231], v10 offset:41216
    v_mfma_f32_16x16x32_bf16 a[60:63], a[212:215], v[116:119], a[60:63]
    s_waitcnt lgkmcnt(6)
    v_exp_f32 v239, v223
    v_mfma_f32_16x16x32_bf16 a[72:75], a[216:219], v[116:119], a[72:75]
    ds_read_b64_tr_b16 a[232:233], v11 offset:33024
    v_add_f32 v63, v63, v239
    v_mfma_f32_16x16x32_bf16 a[76:79], a[216:219], v[180:183], a[76:79]
    ds_read_b64_tr_b16 a[234:235], v11 offset:41216
    v_mfma_f32_16x16x32_bf16 a[80:83], a[216:219], v[244:247], a[80:83]
    s_waitcnt lgkmcnt(6)
    v_exp_f32 v172, v156
    v_mfma_f32_16x16x32_bf16 a[92:95], a[220:223], v[244:247], a[92:95]
    ds_read_b64_tr_b16 a[236:237], v12 offset:33024
    v_add_f32 v62, v62, v172
    v_mfma_f32_16x16x32_bf16 a[88:91], a[220:223], v[180:183], a[88:91]
    ds_read_b64_tr_b16 a[238:239], v12 offset:41216
    v_mfma_f32_16x16x32_bf16 a[84:87], a[220:223], v[116:119], a[84:87]
    s_waitcnt lgkmcnt(6)
    v_exp_f32 v173, v157
    v_mfma_f32_16x16x32_bf16 a[96:99], a[224:227], v[116:119], a[96:99]
    ds_read_b64_tr_b16 a[192:193], v13 offset:33024
    v_add_f32 v62, v62, v173
    v_mfma_f32_16x16x32_bf16 a[100:103], a[224:227], v[180:183], a[100:103]
    ds_read_b64_tr_b16 a[194:195], v13 offset:41216
    v_mfma_f32_16x16x32_bf16 a[104:107], a[224:227], v[244:247], a[104:107]
    s_waitcnt lgkmcnt(6)
    v_exp_f32 v174, v158
    v_mfma_f32_16x16x32_bf16 a[116:119], a[228:231], v[244:247], a[116:119]
    ds_read_b64_tr_b16 a[196:197], v14 offset:33024
    v_add_f32 v62, v62, v174
    v_mfma_f32_16x16x32_bf16 a[112:115], a[228:231], v[180:183], a[112:115]
    ds_read_b64_tr_b16 a[198:199], v14 offset:41216
    v_mfma_f32_16x16x32_bf16 a[108:111], a[228:231], v[116:119], a[108:111]
    s_waitcnt lgkmcnt(6)
    v_exp_f32 v175, v159
    v_mfma_f32_16x16x32_bf16 a[120:123], a[232:235], v[116:119], a[120:123]
    ds_read_b64_tr_b16 a[200:201], v15 offset:33024
    v_add_f32 v62, v62, v175
    v_mfma_f32_16x16x32_bf16 a[124:127], a[232:235], v[180:183], a[124:127]
    ds_read_b64_tr_b16 a[202:203], v15 offset:41216
    v_mfma_f32_16x16x32_bf16 a[128:131], a[232:235], v[244:247], a[128:131]
    s_waitcnt lgkmcnt(6)
    v_exp_f32 v108, v92
    v_mfma_f32_16x16x32_bf16 a[140:143], a[236:239], v[244:247], a[140:143]
    ds_read_b64_tr_b16 a[204:205], v16 offset:33024
    v_add_f32 v61, v61, v108
    v_mfma_f32_16x16x32_bf16 a[136:139], a[236:239], v[180:183], a[136:139]
    ds_read_b64_tr_b16 a[206:207], v16 offset:41216
    v_mfma_f32_16x16x32_bf16 a[132:135], a[236:239], v[116:119], a[132:135]
    s_waitcnt lgkmcnt(6)
    s_waitcnt vmcnt(18)
    s_barrier
    v_mfma_f32_16x16x32_bf16 a[144:147], a[192:195], v[116:119], a[144:147]
    ds_read_b128 a[208:211], v33 offset:0
    v_mfma_f32_16x16x32_bf16 a[148:151], a[192:195], v[180:183], a[148:151]
    v_exp_f32 v109, v93
    v_mfma_f32_16x16x32_bf16 a[152:155], a[192:195], v[244:247], a[152:155]
    s_waitcnt lgkmcnt(5)
    v_exp_f32 v110, v94
    v_mfma_f32_16x16x32_bf16 a[164:167], a[196:199], v[244:247], a[164:167]
    ds_read_b128 a[212:215], v34 offset:0
    v_add_f32 v61, v61, v109
    v_mfma_f32_16x16x32_bf16 a[160:163], a[196:199], v[180:183], a[160:163]
    v_exp_f32 v111, v95
    v_mfma_f32_16x16x32_bf16 a[156:159], a[196:199], v[116:119], a[156:159]
    s_waitcnt lgkmcnt(4)
    v_mfma_f32_16x16x32_bf16 a[168:171], a[200:203], v[116:119], a[168:171]
    ds_read_b128 a[216:219], v35 offset:0
    v_add_f32 v61, v61, v110
    v_mfma_f32_16x16x32_bf16 a[172:175], a[200:203], v[180:183], a[172:175]
    v_mfma_f32_16x16x32_bf16 a[176:179], a[200:203], v[244:247], a[176:179]
    s_waitcnt lgkmcnt(3)
    v_mfma_f32_16x16x32_bf16 a[188:191], a[204:207], v[244:247], a[188:191]
    ds_read_b128 a[220:223], v36 offset:0
    v_add_f32 v61, v61, v111
    v_mfma_f32_16x16x32_bf16 a[184:187], a[204:207], v[180:183], a[184:187]
    v_max3_f32 v0, v61, v62, v63
    v_cmp_lt_f32 vcc, s35, v0
    v_mfma_f32_16x16x32_bf16 a[180:183], a[204:207], v[116:119], a[180:183]
    s_cbranch_vccnz L_rare8
L_ret8:
    s_waitcnt lgkmcnt(2)
    v_cvt_pk_bf16_f32 v116, v100, v101
    v_mfma_f32_16x16x32_bf16 v[84:87], a[208:211], v[64:67], v[124:127]
    ds_read_b128 a[224:227], v33 offset:256
    v_cvt_pk_bf16_f32 v117, v102, v103
    v_mfma_f32_16x16x32_bf16 v[84:87], a[212:215], v[72:75], v[84:87]
    v_cvt_pk_bf16_f32 v118, v108, v109
    v_cvt_pk_bf16_f32 v119, v110, v111
    v_mfma_f32_16x16x32_bf16 v[148:151], a[212:215], v[136:139], v[188:191]
    v_cvt_pk_bf16_f32 v180, v164, v165
    v_cvt_pk_bf16_f32 v181, v166, v167
    v_mfma_f32_16x16x32_bf16 v[148:151], a[208:211], v[128:131], v[148:151]
    ds_read_b128 a[228:231], v34 offset:256
    v_cvt_pk_bf16_f32 v182, v172, v173
    v_mfma_f32_16x16x32_bf16 v[212:215], a[208:211], v[192:195], v[252:255]
    v_cvt_pk_bf16_f32 v183, v174, v175
    v_cvt_pk_bf16_f32 v244, v228, v229
    v_mfma_f32_16x16x32_bf16 v[212:215], a[212:215], v[200:203], v[212:215]
    s_waitcnt lgkmcnt(2)
    v_cvt_pk_bf16_f32 v245, v230, v231
    v_cvt_pk_bf16_f32 v246, v236, v237
    v_mfma_f32_16x16x32_bf16 v[212:215], a[216:219], v[208:211], v[212:215]
    ds_read_b128 a[232:235], v35 offset:256
    v_cvt_pk_bf16_f32 v247, v238, v239
    v_mfma_f32_16x16x32_bf16 v[212:215], a[220:223], v[216:219], v[212:215]
    s_add_u32 m0, s28, 0
    v_add_f32 v58, v58, v61
    v_add_f32 v59, v59, v62
    v_mfma_f32_16x16x32_bf16 v[148:151], a[220:223], v[152:155], v[148:151]
    s_xor_b32 s29, s61, 133120
    v_add_f32 v60, v60, v63
    v_mfma_f32_16x16x32_bf16 v[148:151], a[216:219], v[144:147], v[148:151]
    ds_read_b128 a[236:239], v36 offset:256
    buffer_load_dwordx4 v49, s[16:19], s29 offen nt lds
    v_mfma_f32_16x16x32_bf16 v[84:87], a[216:219], v[80:83], v[84:87]
    v_mfma_f32_16x16x32_bf16 v[84:87], a[220:223], v[88:91], v[84:87]
    s_waitcnt lgkmcnt(2)
    v_mfma_f32_16x16x32_bf16 v[84:87], a[224:227], v[96:99], v[84:87]
    ds_read_b128 a[192:195], v33 offset:8192
    buffer_load_dwordx4 v50, s[16:19], s29 offen offset:1024 nt lds
    v_mfma_f32_16x16x32_bf16 v[84:87], a[228:231], v[104:107], v[84:87]
    v_mfma_f32_16x16x32_bf16 v[148:151], a[228:231], v[168:171], v[148:151]
    v_mfma_f32_16x16x32_bf16 v[148:151], a[224:227], v[160:163], v[148:151]
    ds_read_b128 a[196:199], v34 offset:8192
    buffer_load_dwordx4 v51, s[16:19], s29 offen offset:2048 nt lds
    v_mfma_f32_16x16x32_bf16 v[212:215], a[224:227], v[224:227], v[212:215]
    v_mfma_f32_16x16x32_bf16 v[212:215], a[228:231], v[232:235], v[212:215]
    s_waitcnt lgkmcnt(2)
    v_mfma_f32_16x16x32_bf16 v[212:215], a[232:235], v[240:243], v[212:215]
    ds_read_b128 a[200:203], v35 offset:8192
    buffer_load_dwordx4 v52, s[16:19], s29 offen offset:3072 nt lds
    v_mfma_f32_16x16x32_bf16 v[212:215], a[236:239], v[248:251], v[212:215]
    v_mfma_f32_16x16x32_bf16 v[148:151], a[236:239], v[184:187], v[148:151]
    v_mfma_f32_16x16x32_bf16 v[148:151], a[232:235], v[176:179], v[148:151]
    ds_read_b128 a[204:207], v36 offset:8192
    v_mfma_f32_16x16x32_bf16 v[84:87], a[232:235], v[112:115], v[84:87]
    v_mfma_f32_16x16x32_bf16 v[84:87], a[236:239], v[120:123], v[84:87]
    s_waitcnt lgkmcnt(2)
    v_mfma_f32_16x16x32_bf16 v[92:95], a[192:195], v[64:67], v[124:127]
    ds_read_b128 a[208:211], v33 offset:8448
    v_mfma_f32_16x16x32_bf16 v[92:95], a[196:199], v[72:75], v[92:95]
    v_exp_f32 v228, v212
    v_mfma_f32_16x16x32_bf16 v[156:159], a[196:199], v[136:139], v[188:191]
    v_exp_f32 v229, v213
    v_mfma_f32_16x16x32_bf16 v[156:159], a[192:195], v[128:131], v[156:159]
    ds_read_b128 a[212:215], v34 offset:8448
    v_add_f32 v63, v228, v229
    v_mfma_f32_16x16x32_bf16 v[220:223], a[192:195], v[192:195], v[252:255]
    v_exp_f32 v230, v214
    v_mfma_f32_16x16x32_bf16 v[220:223], a[196:199], v[200:203], v[220:223]
    s_waitcnt lgkmcnt(2)
    v_exp_f32 v231, v215
    v_mfma_f32_16x16x32_bf16 v[220:223], a[200:203], v[208:211], v[220:223]
    ds_read_b128 a[216:219], v35 offset:8448
    v_add_f32 v63, v63, v230
    v_mfma_f32_16x16x32_bf16 v[220:223], a[204:207], v[216:219], v[220:223]
    v_exp_f32 v164, v148
    v_mfma_f32_16x16x32_bf16 v[156:159], a[204:207], v[152:155], v[156:159]
    v_exp_f32 v165, v149
    v_mfma_f32_16x16x32_bf16 v[156:159], a[200:203], v[144:147], v[156:159]
    ds_read_b128 a[220:223], v36 offset:8448
    v_add_f32 v62, v164, v165
    v_mfma_f32_16x16x32_bf16 v[92:95], a[200:203], v[80:83], v[92:95]
    v_exp_f32 v166, v150
    v_mfma_f32_16x16x32_bf16 v[92:95], a[204:207], v[88:91], v[92:95]
    s_waitcnt lgkmcnt(2)
    s_waitcnt vmcnt(18)
    s_barrier
    v_mfma_f32_16x16x32_bf16 v[92:95], a[208:211], v[96:99], v[92:95]
    ds_read_b64_tr_b16 a[224:225], v1 offset:16384
    v_add_f32 v62, v62, v166
    v_mfma_f32_16x16x32_bf16 v[92:95], a[212:215], v[104:107], v[92:95]
    ds_read_b64_tr_b16 a[226:227], v1 offset:24576
    v_add_f32 v63, v63, v231
    v_mfma_f32_16x16x32_bf16 v[156:159], a[212:215], v[168:171], v[156:159]
    v_exp_f32 v167, v151
    v_mfma_f32_16x16x32_bf16 v[156:159], a[208:211], v[160:163], v[156:159]
    ds_read_b64_tr_b16 a[228:229], v2 offset:16384
    v_add_f32 v62, v62, v167
    v_mfma_f32_16x16x32_bf16 v[220:223], a[208:211], v[224:227], v[220:223]
    ds_read_b64_tr_b16 a[230:231], v2 offset:24576
    v_mfma_f32_16x16x32_bf16 v[220:223], a[212:215], v[232:235], v[220:223]
    s_waitcnt lgkmcnt(4)
    v_exp_f32 v100, v84
    v_mfma_f32_16x16x32_bf16 v[220:223], a[216:219], v[240:243], v[220:223]
    ds_read_b64_tr_b16 a[232:233], v3 offset:16384
    v_mfma_f32_16x16x32_bf16 v[220:223], a[220:223], v[248:251], v[220:223]
    ds_read_b64_tr_b16 a[234:235], v3 offset:24576
    v_mfma_f32_16x16x32_bf16 v[156:159], a[220:223], v[184:187], v[156:159]
    v_exp_f32 v101, v85
    v_mfma_f32_16x16x32_bf16 v[156:159], a[216:219], v[176:179], v[156:159]
    ds_read_b64_tr_b16 a[236:237], v4 offset:16384
    v_add_f32 v61, v100, v101
    v_mfma_f32_16x16x32_bf16 v[92:95], a[216:219], v[112:115], v[92:95]
    ds_read_b64_tr_b16 a[238:239], v4 offset:24576
    v_mfma_f32_16x16x32_bf16 v[92:95], a[220:223], v[120:123], v[92:95]
    s_waitcnt lgkmcnt(6)
    v_exp_f32 v102, v86
    v_mfma_f32_16x16x32_bf16 a[0:3], a[224:227], v[116:119], a[0:3]
    ds_read_b64_tr_b16 a[192:193], v5 offset:16384
    v_add_f32 v61, v61, v102
    v_mfma_f32_16x16x32_bf16 a[4:7], a[224:227], v[180:183], a[4:7]
    ds_read_b64_tr_b16 a[194:195], v5 offset:24576
    v_mfma_f32_16x16x32_bf16 a[8:11], a[224:227], v[244:247], a[8:11]
    s_waitcnt lgkmcnt(6)
    v_exp_f32 v103, v87
    v_mfma_f32_16x16x32_bf16 a[20:23], a[228:231], v[244:247], a[20:23]
    ds_read_b64_tr_b16 a[196:197], v6 offset:16384
    v_add_f32 v61, v61, v103
    v_mfma_f32_16x16x32_bf16 a[16:19], a[228:231], v[180:183], a[16:19]
    ds_read_b64_tr_b16 a[198:199], v6 offset:24576
    v_mfma_f32_16x16x32_bf16 a[12:15], a[228:231], v[116:119], a[12:15]
    s_waitcnt lgkmcnt(6)
    v_exp_f32 v236, v220
    v_mfma_f32_16x16x32_bf16 a[24:27], a[232:235], v[116:119], a[24:27]
    ds_read_b64_tr_b16 a[200:201], v7 offset:16384
    v_add_f32 v63, v63, v236
    v_mfma_f32_16x16x32_bf16 a[28:31], a[232:235], v[180:183], a[28:31]
    ds_read_b64_tr_b16 a[202:203], v7 offset:24576
    v_mfma_f32_16x16x32_bf16 a[32:35], a[232:235], v[244:247], a[32:35]
    s_waitcnt lgkmcnt(6)
    v_exp_f32 v237, v221
    v_mfma_f32_16x16x32_bf16 a[44:47], a[236:239], v[244:247], a[44:47]
    ds_read_b64_tr_b16 a[204:205], v8 offset:16384
    v_add_f32 v63, v63, v237
    v_mfma_f32_16x16x32_bf16 a[40:43], a[236:239], v[180:183], a[40:43]
    ds_read_b64_tr_b16 a[206:207], v8 offset:24576
    v_mfma_f32_16x16x32_bf16 a[36:39], a[236:239], v[116:119], a[36:39]
    s_waitcnt lgkmcnt(6)
    v_exp_f32 v238, v222
    v_mfma_f32_16x16x32_bf16 a[48:51], a[192:195], v[116:119], a[48:51]
    ds_read_b64_tr_b16 a[208:209], v1 offset:16640
    v_add_f32 v63, v63, v238
    v_mfma_f32_16x16x32_bf16 a[52:55], a[192:195], v[180:183], a[52:55]
    ds_read_b64_tr_b16 a[210:211], v1 offset:24832
    v_mfma_f32_16x16x32_bf16 a[56:59], a[192:195], v[244:247], a[56:59]
    s_waitcnt lgkmcnt(6)
    v_exp_f32 v239, v223
    v_mfma_f32_16x16x32_bf16 a[68:71], a[196:199], v[244:247], a[68:71]
    ds_read_b64_tr_b16 a[212:213], v2 offset:16640
    v_add_f32 v63, v63, v239
    v_mfma_f32_16x16x32_bf16 a[64:67], a[196:199], v[180:183], a[64:67]
    ds_read_b64_tr_b16 a[214:215], v2 offset:24832
    v_mfma_f32_16x16x32_bf16 a[60:63], a[196:199], v[116:119], a[60:63]
    s_waitcnt lgkmcnt(6)
    v_exp_f32 v172, v156
    v_mfma_f32_16x16x32_bf16 a[72:75], a[200:203], v[116:119], a[72:75]
    ds_read_b64_tr_b16 a[216:217], v3 offset:16640
    v_add_f32 v62, v62, v172
    v_mfma_f32_16x16x32_bf16 a[76:79], a[200:203], v[180:183], a[76:79]
    ds_read_b64_tr_b16 a[218:219], v3 offset:24832
    v_mfma_f32_16x16x32_bf16 a[80:83], a[200:203], v[244:247], a[80:83]
    s_waitcnt lgkmcnt(6)
    v_exp_f32 v173, v157
    v_mfma_f32_16x16x32_bf16 a[92:95], a[204:207], v[244:247], a[92:95]
    ds_read_b64_tr_b16 a[220:221], v4 offset:16640
    v_add_f32 v62, v62, v173
    v_mfma_f32_16x16x32_bf16 a[88:91], a[204:207], v[180:183], a[88:91]
    s_add_u32 m0, s28, 147456
    ds_read_b64_tr_b16 a[222:223], v4 offset:24832
    v_mfma_f32_16x16x32_bf16 a[84:87], a[204:207], v[116:119], a[84:87]
    s_waitcnt lgkmcnt(6)
    s_xor_b32 s29, s61, 135168
    v_mfma_f32_16x16x32_bf16 a[96:99], a[208:211], v[116:119], a[96:99]
    ds_read_b64_tr_b16 a[224:225], v5 offset:16640
    buffer_load_dwordx4 v49, s[12:15], s29 offen nt lds
    v_mfma_f32_16x16x32_bf16 a[100:103], a[208:211], v[180:183], a[100:103]
    ds_read_b64_tr_b16 a[226:227], v5 offset:24832
    v_mfma_f32_16x16x32_bf16 a[104:107], a[208:211], v[244:247], a[104:107]
    s_waitcnt lgkmcnt(6)
    v_exp_f32 v174, v158
    v_mfma_f32_16x16x32_bf16 a[116:119], a[212:215], v[244:247], a[116:119]
    ds_read_b64_tr_b16 a[228:229], v6 offset:16640
    buffer_load_dwordx4 v50, s[12:15], s29 offen offset:1024 nt lds
    v_mfma_f32_16x16x32_bf16 a[112:115], a[212:215], v[180:183], a[112:115]
    ds_read_b64_tr_b16 a[230:231], v6 offset:24832
    v_add_f32 v62, v62, v174
    v_mfma_f32_16x16x32_bf16 a[108:111], a[212:215], v[116:119], a[108:111]
    s_waitcnt lgkmcnt(6)
    v_exp_f32 v175, v159
    v_mfma_f32_16x16x32_bf16 a[120:123], a[216:219], v[116:119], a[120:123]
    ds_read_b64_tr_b16 a[232:233], v7 offset:16640
    buffer_load_dwordx4 v51, s[12:15], s29 offen offset:2048 nt lds
    v_mfma_f32_16x16x32_bf16 a[124:127], a[216:219], v[180:183], a[124:127]
    ds_read_b64_tr_b16 a[234:235], v7 offset:24832
    v_add_f32 v62, v62, v175
    v_mfma_f32_16x16x32_bf16 a[128:131], a[216:219], v[244:247], a[128:131]
    s_waitcnt lgkmcnt(6)
    v_exp_f32 v108, v92
    v_mfma_f32_16x16x32_bf16 a[140:143], a[220:223], v[244:247], a[140:143]
    ds_read_b64_tr_b16 a[236:237], v8 offset:16640
    buffer_load_dwordx4 v52, s[12:15], s29 offen offset:3072 nt lds
    v_mfma_f32_16x16x32_bf16 a[136:139], a[220:223], v[180:183], a[136:139]
    ds_read_b64_tr_b16 a[238:239], v8 offset:24832
    v_add_f32 v61, v61, v108
    v_mfma_f32_16x16x32_bf16 a[132:135], a[220:223], v[116:119], a[132:135]
    s_waitcnt lgkmcnt(6)
    s_waitcnt vmcnt(17)
    s_barrier
    v_mfma_f32_16x16x32_bf16 a[144:147], a[224:227], v[116:119], a[144:147]
    ds_read_b128 a[192:195], v25 offset:49152
    v_mfma_f32_16x16x32_bf16 a[148:151], a[224:227], v[180:183], a[148:151]
    v_exp_f32 v109, v93
    v_mfma_f32_16x16x32_bf16 a[152:155], a[224:227], v[244:247], a[152:155]
    s_waitcnt lgkmcnt(5)
    v_exp_f32 v110, v94
    v_mfma_f32_16x16x32_bf16 a[164:167], a[228:231], v[244:247], a[164:167]
    ds_read_b128 a[196:199], v26 offset:49152
    v_add_f32 v61, v61, v109
    v_mfma_f32_16x16x32_bf16 a[160:163], a[228:231], v[180:183], a[160:163]
    v_exp_f32 v111, v95
    v_mfma_f32_16x16x32_bf16 a[156:159], a[228:231], v[116:119], a[156:159]
    s_waitcnt lgkmcnt(4)
    v_mfma_f32_16x16x32_bf16 a[168:171], a[232:235], v[116:119], a[168:171]
    ds_read_b128 a[200:203], v27 offset:49152
    v_add_f32 v61, v61, v110
    v_mfma_f32_16x16x32_bf16 a[172:175], a[232:235], v[180:183], a[172:175]
    v_mfma_f32_16x16x32_bf16 a[176:179], a[232:235], v[244:247], a[176:179]
    s_waitcnt lgkmcnt(3)
    v_mfma_f32_16x16x32_bf16 a[188:191], a[236:239], v[244:247], a[188:191]
    ds_read_b128 a[204:207], v28 offset:49152
    v_add_f32 v61, v61, v111
    v_mfma_f32_16x16x32_bf16 a[184:187], a[236:239], v[180:183], a[184:187]
    v_max3_f32 v0, v61, v62, v63
    v_cmp_lt_f32 vcc, s35, v0
    v_mfma_f32_16x16x32_bf16 a[180:183], a[236:239], v[116:119], a[180:183]
    s_cbranch_vccnz L_rare9
L_ret9:
    s_waitcnt lgkmcnt(2)
    v_cvt_pk_bf16_f32 v116, v100, v101
    v_mfma_f32_16x16x32_bf16 v[84:87], a[192:195], v[64:67], v[124:127]
    ds_read_b128 a[208:211], v25 offset:49408
    v_cvt_pk_bf16_f32 v117, v102, v103
    v_mfma_f32_16x16x32_bf16 v[84:87], a[196:199], v[72:75], v[84:87]
    v_cvt_pk_bf16_f32 v118, v108, v109
    v_cvt_pk_bf16_f32 v119, v110, v111
    v_mfma_f32_16x16x32_bf16 v[148:151], a[196:199], v[136:139], v[188:191]
    v_cvt_pk_bf16_f32 v180, v164, v165
    v_cvt_pk_bf16_f32 v181, v166, v167
    v_mfma_f32_16x16x32_bf16 v[148:151], a[192:195], v[128:131], v[148:151]
    ds_read_b128 a[212:215], v26 offset:49408
    v_cvt_pk_bf16_f32 v182, v172, v173
    v_mfma_f32_16x16x32_bf16 v[212:215], a[192:195], v[192:195], v[252:255]
    v_cvt_pk_bf16_f32 v183, v174, v175
    v_cvt_pk_bf16_f32 v244, v228, v229
    v_mfma_f32_16x16x32_bf16 v[212:215], a[196:199], v[200:203], v[212:215]
    s_waitcnt lgkmcnt(2)
    v_cvt_pk_bf16_f32 v245, v230, v231
    v_cvt_pk_bf16_f32 v246, v236, v237
    v_mfma_f32_16x16x32_bf16 v[212:215], a[200:203], v[208:211], v[212:215]
    ds_read_b128 a[216:219], v27 offset:49408
    v_cvt_pk_bf16_f32 v247, v238, v239
    v_mfma_f32_16x16x32_bf16 v[212:215], a[204:207], v[216:219], v[212:215]
    v_add_f32 v58, v58, v61
    v_add_f32 v59, v59, v62
    v_mfma_f32_16x16x32_bf16 v[148:151], a[204:207], v[152:155], v[148:151]
    v_add_f32 v60, v60, v63
    v_mfma_f32_16x16x32_bf16 v[148:151], a[200:203], v[144:147], v[148:151]
    ds_read_b128 a[220:223], v28 offset:49408
    v_mfma_f32_16x16x32_bf16 v[84:87], a[200:203], v[80:83], v[84:87]
    v_mfma_f32_16x16x32_bf16 v[84:87], a[204:207], v[88:91], v[84:87]
    s_waitcnt lgkmcnt(2)
    v_mfma_f32_16x16x32_bf16 v[84:87], a[208:211], v[96:99], v[84:87]
    ds_read_b128 a[224:227], v25 offset:57344
    v_mov_b32 v134, 0
    v_mfma_f32_16x16x32_bf16 v[84:87], a[212:215], v[104:107], v[84:87]
    buffer_load_dword v135, v134, s[40:43], s85 offen sc1
    v_mfma_f32_16x16x32_bf16 v[148:151], a[212:215], v[168:171], v[148:151]
    v_mfma_f32_16x16x32_bf16 v[148:151], a[208:211], v[160:163], v[148:151]
    ds_read_b128 a[228:231], v26 offset:57344
    v_mfma_f32_16x16x32_bf16 v[212:215], a[208:211], v[224:227], v[212:215]
    v_mfma_f32_16x16x32_bf16 v[212:215], a[212:215], v[232:235], v[212:215]
    s_waitcnt lgkmcnt(2)
    v_mfma_f32_16x16x32_bf16 v[212:215], a[216:219], v[240:243], v[212:215]
    ds_read_b128 a[232:235], v27 offset:57344
    v_mfma_f32_16x16x32_bf16 v[212:215], a[220:223], v[248:251], v[212:215]
    v_mfma_f32_16x16x32_bf16 v[148:151], a[220:223], v[184:187], v[148:151]
    v_mfma_f32_16x16x32_bf16 v[148:151], a[216:219], v[176:179], v[148:151]
    ds_read_b128 a[236:239], v28 offset:57344
    v_mfma_f32_16x16x32_bf16 v[84:87], a[216:219], v[112:115], v[84:87]
    v_mfma_f32_16x16x32_bf16 v[84:87], a[220:223], v[120:123], v[84:87]
    s_waitcnt lgkmcnt(2)
    v_mfma_f32_16x16x32_bf16 v[92:95], a[224:227], v[64:67], v[124:127]
    ds_read_b128 a[192:195], v25 offset:57600
    v_mfma_f32_16x16x32_bf16 v[92:95], a[228:231], v[72:75], v[92:95]
    v_exp_f32 v228, v212
    v_mfma_f32_16x16x32_bf16 v[156:159], a[228:231], v[136:139], v[188:191]
    v_exp_f32 v229, v213
    v_mfma_f32_16x16x32_bf16 v[156:159], a[224:227], v[128:131], v[156:159]
    ds_read_b128 a[196:199], v26 offset:57600
    v_add_f32 v63, v228, v229
    v_mfma_f32_16x16x32_bf16 v[220:223], a[224:227], v[192:195], v[252:255]
    v_exp_f32 v230, v214
    v_mfma_f32_16x16x32_bf16 v[220:223], a[228:231], v[200:203], v[220:223]
    s_waitcnt lgkmcnt(2)
    v_exp_f32 v231, v215
    v_mfma_f32_16x16x32_bf16 v[220:223], a[232:235], v[208:211], v[220:223]
    ds_read_b128 a[200:203], v27 offset:57600
    v_add_f32 v63, v63, v230
    v_mfma_f32_16x16x32_bf16 v[220:223], a[236:239], v[216:219], v[220:223]
    v_exp_f32 v164, v148
    v_mfma_f32_16x16x32_bf16 v[156:159], a[236:239], v[152:155], v[156:159]
    v_exp_f32 v165, v149
    v_mfma_f32_16x16x32_bf16 v[156:159], a[232:235], v[144:147], v[156:159]
    ds_read_b128 a[204:207], v28 offset:57600
    v_add_f32 v62, v164, v165
    v_mfma_f32_16x16x32_bf16 v[92:95], a[232:235], v[80:83], v[92:95]
    v_exp_f32 v166, v150
    v_mfma_f32_16x16x32_bf16 v[92:95], a[236:239], v[88:91], v[92:95]
    s_waitcnt lgkmcnt(2)
    s_waitcnt vmcnt(14)
    s_barrier
    v_mfma_f32_16x16x32_bf16 v[92:95], a[192:195], v[96:99], v[92:95]
    ds_read_b64_tr_b16 a[208:209], v9 offset:49152
    v_add_f32 v62, v62, v166
    v_mfma_f32_16x16x32_bf16 v[92:95], a[196:199], v[104:107], v[92:95]
    s_add_u32 m0, s28, 32768
    ds_read_b64_tr_b16 a[210:211], v9 offset:57344
    v_add_f32 v63, v63, v231
    v_mfma_f32_16x16x32_bf16 v[156:159], a[196:199], v[168:171], v[156:159]
    s_xor_b32 s29, s61, 134144
    v_exp_f32 v167, v151
    v_mfma_f32_16x16x32_bf16 v[156:159], a[192:195], v[160:163], v[156:159]
    ds_read_b64_tr_b16 a[212:213], v10 offset:49152
    buffer_load_dwordx4 v49, s[16:19], s29 offen nt lds
    v_mfma_f32_16x16x32_bf16 v[220:223], a[192:195], v[224:227], v[220:223]
    ds_read_b64_tr_b16 a[214:215], v10 offset:57344
    v_add_f32 v62, v62, v167
    v_mfma_f32_16x16x32_bf16 v[220:223], a[196:199], v[232:235], v[220:223]
    s_waitcnt lgkmcnt(4)
    v_exp_f32 v100, v84
    v_mfma_f32_16x16x32_bf16 v[220:223], a[200:203], v[240:243], v[220:223]
    ds_read_b64_tr_b16 a[216:217], v11 offset:49152
    buffer_load_dwordx4 v50, s[16:19], s29 offen offset:1024 nt lds
    v_mfma_f32_16x16x32_bf16 v[220:223], a[204:207], v[248:251], v[220:223]
    ds_read_b64_tr_b16 a[218:219], v11 offset:57344
    v_mfma_f32_16x16x32_bf16 v[156:159], a[204:207], v[184:187], v[156:159]
    v_exp_f32 v101, v85
    v_mfma_f32_16x16x32_bf16 v[156:159], a[200:203], v[176:179], v[156:159]
    ds_read_b64_tr_b16 a[220:221], v12 offset:49152
    buffer_load_dwordx4 v51, s[16:19], s29 offen offset:2048 nt lds
    v_mfma_f32_16x16x32_bf16 v[92:95], a[200:203], v[112:115], v[92:95]
    ds_read_b64_tr_b16 a[222:223], v12 offset:57344
    v_add_f32 v61, v100, v101
    v_mfma_f32_16x16x32_bf16 v[92:95], a[204:207], v[120:123], v[92:95]
    s_waitcnt lgkmcnt(6)
    v_exp_f32 v102, v86
    v_mfma_f32_16x16x32_bf16 a[0:3], a[208:211], v[116:119], a[0:3]
    ds_read_b64_tr_b16 a[224:225], v13 offset:49152
    buffer_load_dwordx4 v52, s[16:19], s29 offen offset:3072 nt lds
    v_mfma_f32_16x16x32_bf16 a[4:7], a[208:211], v[180:183], a[4:7]
    ds_read_b64_tr_b16 a[226:227], v13 offset:57344
    v_add_f32 v61, v61, v102
    v_mfma_f32_16x16x32_bf16 a[8:11], a[208:211], v[244:247], a[8:11]
    s_waitcnt lgkmcnt(6)
    v_exp_f32 v103, v87
    v_mfma_f32_16x16x32_bf16 a[20:23], a[212:215], v[244:247], a[20:23]
    ds_read_b64_tr_b16 a[228:229], v14 offset:49152
    v_add_f32 v61, v61, v103
    v_mfma_f32_16x16x32_bf16 a[16:19], a[212:215], v[180:183], a[16:19]
    ds_read_b64_tr_b16 a[230:231], v14 offset:57344
    v_mfma_f32_16x16x32_bf16 a[12:15], a[212:215], v[116:119], a[12:15]
    s_waitcnt lgkmcnt(6)
    v_exp_f32 v236, v220
    v_mfma_f32_16x16x32_bf16 a[24:27], a[216:219], v[116:119], a[24:27]
    ds_read_b64_tr_b16 a[232:233], v15 offset:49152
    v_add_f32 v63, v63, v236
    v_mfma_f32_16x16x32_bf16 a[28:31], a[216:219], v[180:183], a[28:31]
    ds_read_b64_tr_b16 a[234:235], v15 offset:57344
    v_mfma_f32_16x16x32_bf16 a[32:35], a[216:219], v[244:247], a[32:35]
    s_waitcnt lgkmcnt(6)
    v_exp_f32 v237, v221
    v_mfma_f32_16x16x32_bf16 a[44:47], a[220:223], v[244:247], a[44:47]
    ds_read_b64_tr_b16 a[236:237], v16 offset:49152
    v_add_f32 v63, v63, v237
    v_mfma_f32_16x16x32_bf16 a[40:43], a[220:223], v[180:183], a[40:43]
    ds_read_b64_tr_b16 a[238:239], v16 offset:57344
    v_mfma_f32_16x16x32_bf16 a[36:39], a[220:223], v[116:119], a[36:39]
    s_waitcnt lgkmcnt(6)
    v_exp_f32 v238, v222
    v_mfma_f32_16x16x32_bf16 a[48:51], a[224:227], v[116:119], a[48:51]
    ds_read_b64_tr_b16 a[192:193], v9 offset:49408
    v_add_f32 v63, v63, v238
    v_mfma_f32_16x16x32_bf16 a[52:55], a[224:227], v[180:183], a[52:55]
    ds_read_b64_tr_b16 a[194:195], v9 offset:57600
    v_mfma_f32_16x16x32_bf16 a[56:59], a[224:227], v[244:247], a[56:59]
    s_waitcnt lgkmcnt(6)
    v_exp_f32 v239, v223
    v_mfma_f32_16x16x32_bf16 a[68:71], a[228:231], v[244:247], a[68:71]
    ds_read_b64_tr_b16 a[196:197], v10 offset:49408
    v_add_f32 v63, v63, v239
    v_mfma_f32_16x16x32_bf16 a[64:67], a[228:231], v[180:183], a[64:67]
    ds_read_b64_tr_b16 a[198:199], v10 offset:57600
    v_mfma_f32_16x16x32_bf16 a[60:63], a[228:231], v[116:119], a[60:63]
    s_waitcnt lgkmcnt(6)
    v_exp_f32 v172, v156
    v_mfma_f32_16x16x32_bf16 a[72:75], a[232:235], v[116:119], a[72:75]
    ds_read_b64_tr_b16 a[200:201], v11 offset:49408
    v_add_f32 v62, v62, v172
    v_mfma_f32_16x16x32_bf16 a[76:79], a[232:235], v[180:183], a[76:79]
    ds_read_b64_tr_b16 a[202:203], v11 offset:57600
    v_mfma_f32_16x16x32_bf16 a[80:83], a[232:235], v[244:247], a[80:83]
    s_waitcnt lgkmcnt(6)
    v_exp_f32 v173, v157
    v_mfma_f32_16x16x32_bf16 a[92:95], a[236:239], v[244:247], a[92:95]
    ds_read_b64_tr_b16 a[204:205], v12 offset:49408
    v_add_f32 v62, v62, v173
    v_mfma_f32_16x16x32_bf16 a[88:91], a[236:239], v[180:183], a[88:91]
    ds_read_b64_tr_b16 a[206:207], v12 offset:57600
    v_mfma_f32_16x16x32_bf16 a[84:87], a[236:239], v[116:119], a[84:87]
    s_waitcnt lgkmcnt(6)
    v_exp_f32 v174, v158
    v_mfma_f32_16x16x32_bf16 a[96:99], a[192:195], v[116:119], a[96:99]
    ds_read_b64_tr_b16 a[208:209], v13 offset:49408
    v_add_f32 v62, v62, v174
    v_mfma_f32_16x16x32_bf16 a[100:103], a[192:195], v[180:183], a[100:103]
    ds_read_b64_tr_b16 a[210:211], v13 offset:57600
    v_mfma_f32_16x16x32_bf16 a[104:107], a[192:195], v[244:247], a[104:107]
    s_waitcnt lgkmcnt(6)
    v_exp_f32 v175, v159
    v_mfma_f32_16x16x32_bf16 a[116:119], a[196:199], v[244:247], a[116:119]
    ds_read_b64_tr_b16 a[212:213], v14 offset:49408
    v_add_f32 v62, v62, v175
    v_mfma_f32_16x16x32_bf16 a[112:115], a[196:199], v[180:183], a[112:115]
    ds_read_b64_tr_b16 a[214:215], v14 offset:57600
    v_mfma_f32_16x16x32_bf16 a[108:111], a[196:199], v[116:119], a[108:111]
    s_waitcnt lgkmcnt(6)
    v_exp_f32 v108, v92
    v_mfma_f32_16x16x32_bf16 a[120:123], a[200:203], v[116:119], a[120:123]
    ds_read_b64_tr_b16 a[216:217], v15 offset:49408
    v_add_f32 v61, v61, v108
    v_mfma_f32_16x16x32_bf16 a[124:127], a[200:203], v[180:183], a[124:127]
    ds_read_b64_tr_b16 a[218:219], v15 offset:57600
    v_mfma_f32_16x16x32_bf16 a[128:131], a[200:203], v[244:247], a[128:131]
    s_waitcnt lgkmcnt(6)
    v_exp_f32 v109, v93
    v_mfma_f32_16x16x32_bf16 a[140:143], a[204:207], v[244:247], a[140:143]
    ds_read_b64_tr_b16 a[220:221], v16 offset:49408
    v_add_f32 v61, v61, v109
    v_mfma_f32_16x16x32_bf16 a[136:139], a[204:207], v[180:183], a[136:139]
    ds_read_b64_tr_b16 a[222:223], v16 offset:57600
    v_mfma_f32_16x16x32_bf16 a[132:135], a[204:207], v[116:119], a[132:135]
    s_waitcnt lgkmcnt(6)
    s_waitcnt vmcnt(13)
    s_barrier
    v_mfma_f32_16x16x32_bf16 a[144:147], a[208:211], v[116:119], a[144:147]
    ds_read_b128 a[224:227], v29 offset:16384
    v_mfma_f32_16x16x32_bf16 a[148:151], a[208:211], v[180:183], a[148:151]
    v_exp_f32 v110, v94
    v_mfma_f32_16x16x32_bf16 a[152:155], a[208:211], v[244:247], a[152:155]
    s_waitcnt lgkmcnt(5)
    v_exp_f32 v111, v95
    v_mfma_f32_16x16x32_bf16 a[164:167], a[212:215], v[244:247], a[164:167]
    ds_read_b128 a[228:231], v30 offset:16384
    v_add_f32 v61, v61, v110
    v_mfma_f32_16x16x32_bf16 a[160:163], a[212:215], v[180:183], a[160:163]
    v_mfma_f32_16x16x32_bf16 a[156:159], a[212:215], v[116:119], a[156:159]
    s_waitcnt lgkmcnt(4)
    v_mfma_f32_16x16x32_bf16 a[168:171], a[216:219], v[116:119], a[168:171]
    ds_read_b128 a[232:235], v31 offset:16384
    v_add_f32 v61, v61, v111
    v_mfma_f32_16x16x32_bf16 a[172:175], a[216:219], v[180:183], a[172:175]
    v_max3_f32 v0, v61, v62, v63
    v_cmp_lt_f32 vcc, s35, v0
    v_mfma_f32_16x16x32_bf16 a[176:179], a[216:219], v[244:247], a[176:179]
    s_waitcnt lgkmcnt(3)
    v_mfma_f32_16x16x32_bf16 a[188:191], a[220:223], v[244:247], a[188:191]
    ds_read_b128 a[236:239], v32 offset:16384
    v_mfma_f32_16x16x32_bf16 a[184:187], a[220:223], v[180:183], a[184:187]
    v_mfma_f32_16x16x32_bf16 a[180:183], a[220:223], v[116:119], a[180:183]
    s_cbranch_vccnz L_rare10
L_ret10:
    s_waitcnt lgkmcnt(2)
    v_cvt_pk_bf16_f32 v116, v100, v101
    v_mfma_f32_16x16x32_bf16 v[84:87], a[224:227], v[64:67], v[124:127]
    ds_read_b128 a[192:195], v29 offset:16640
    v_cvt_pk_bf16_f32 v117, v102, v103
    v_mfma_f32_16x16x32_bf16 v[84:87], a[228:231], v[72:75], v[84:87]
    v_cvt_pk_bf16_f32 v118, v108, v109
    v_cvt_pk_bf16_f32 v119, v110, v111
    v_mfma_f32_16x16x32_bf16 v[148:151], a[228:231], v[136:139], v[188:191]
    v_cvt_pk_bf16_f32 v180, v164, v165
    v_cvt_pk_bf16_f32 v181, v166, v167
    v_mfma_f32_16x16x32_bf16 v[148:151], a[224:227], v[128:131], v[148:151]
    ds_read_b128 a[196:199], v30 offset:16640
    v_cvt_pk_bf16_f32 v182, v172, v173
    v_mfma_f32_16x16x32_bf16 v[212:215], a[224:227], v[192:195], v[252:255]
    s_add_u32 m0, s28, 65536
    v_cvt_pk_bf16_f32 v183, v174, v175
    v_cvt_pk_bf16_f32 v244, v228, v229
    v_mfma_f32_16x16x32_bf16 v[212:215], a[228:231], v[200:203], v[212:215]
    s_waitcnt lgkmcnt(2)
    s_xor_b32 s29, s61, 136192
    v_cvt_pk_bf16_f32 v245, v230, v231
    v_mfma_f32_16x16x32_bf16 v[212:215], a[232:235], v[208:211], v[212:215]
    ds_read_b128 a[200:203], v31 offset:16640
    buffer_load_dwordx4 v49, s[12:15], s29 offen nt lds
    v_mfma_f32_16x16x32_bf16 v[212:215], a[236:239], v[216:219], v[212:215]
    v_cvt_pk_bf16_f32 v246, v236, v237
    v_cvt_pk_bf16_f32 v247, v238, v239
    v_mfma_f32_16x16x32_bf16 v[148:151], a[236:239], v[152:155], v[148:151]
    v_add_f32 v58, v58, v61
    v_add_f32 v59, v59, v62
    v_mfma_f32_16x16x32_bf16 v[148:151], a[232:235], v[144:147], v[148:151]
    s_lshr_b32 s62, s2, 3
    ds_read_b128 a[204:207], v32 offset:16640
    buffer_load_dwordx4 v50, s[12:15], s29 offen offset:1024 nt lds
    v_mfma_f32_16x16x32_bf16 v[84:87], a[232:235], v[80:83], v[84:87]
    s_lshl_b32 s62, s62, 2
    v_add_f32 v60, v60, v63
    v_mfma_f32_16x16x32_bf16 v[84:87], a[236:239], v[88:91], v[84:87]
    s_waitcnt lgkmcnt(2)
    v_mfma_f32_16x16x32_bf16 v[84:87], a[192:195], v[96:99], v[84:87]
    s_add_u32 s62, s62, s58
    ds_read_b128 a[208:211], v29 offset:24576
    buffer_load_dwordx4 v51, s[12:15], s29 offen offset:2048 nt lds
    v_mfma_f32_16x16x32_bf16 v[84:87], a[196:199], v[104:107], v[84:87]
    s_lshl_b32 s62, s62, 7
    v_mfma_f32_16x16x32_bf16 v[148:151], a[196:199], v[168:171], v[148:151]
    s_getpc_b64 s[4:5]
L_pv1:
    s_mov_b32 s6, L_code_end-L_pv1
    v_mfma_f32_16x16x32_bf16 v[148:151], a[192:195], v[160:163], v[148:151]
    ds_read_b128 a[212:215], v30 offset:24576
    buffer_load_dwordx4 v52, s[12:15], s29 offen offset:3072 nt lds
    v_mfma_f32_16x16x32_bf16 v[212:215], a[192:195], v[224:227], v[212:215]
    v_mbcnt_lo_u32_b32 v40, -1, 0
    v_mbcnt_hi_u32_b32 v40, -1, v40
    v_mfma_f32_16x16x32_bf16 v[212:215], a[196:199], v[232:235], v[212:215]
    s_waitcnt lgkmcnt(2)
    v_and_b32 v40, 3, v40
    v_lshlrev_b32 v40, 14, v40
    v_mfma_f32_16x16x32_bf16 v[212:215], a[200:203], v[240:243], v[212:215]
    ds_read_b128 a[216:219], v31 offset:24576
    buffer_load_dword a255, v40, s[4:7], s62 offen
    v_mfma_f32_16x16x32_bf16 v[212:215], a[204:207], v[248:251], v[212:215]
    v_mfma_f32_16x16x32_bf16 v[148:151], a[204:207], v[184:187], v[148:151]
    v_mfma_f32_16x16x32_bf16 v[148:151], a[200:203], v[176:179], v[148:151]
    ds_read_b128 a[220:223], v32 offset:24576
    v_mfma_f32_16x16x32_bf16 v[84:87], a[200:203], v[112:115], v[84:87]
    v_mfma_f32_16x16x32_bf16 v[84:87], a[204:207], v[120:123], v[84:87]
    s_waitcnt lgkmcnt(2)
    v_mfma_f32_16x16x32_bf16 v[92:95], a[208:211], v[64:67], v[124:127]
    ds_read_b128 a[224:227], v29 offset:24832
    v_mfma_f32_16x16x32_bf16 v[92:95], a[212:215], v[72:75], v[92:95]
    v_exp_f32 v228, v212
    v_mfma_f32_16x16x32_bf16 v[156:159], a[212:215], v[136:139], v[188:191]
    v_exp_f32 v229, v213
    v_mfma_f32_16x16x32_bf16 v[156:159], a[208:211], v[128:131], v[156:159]
    ds_read_b128 a[228:231], v30 offset:24832
    v_add_f32 v63, v228, v229
    v_mfma_f32_16x16x32_bf16 v[220:223], a[208:211], v[192:195], v[252:255]
    v_exp_f32 v230, v214
    v_mfma_f32_16x16x32_bf16 v[220:223], a[212:215], v[200:203], v[220:223]
    s_waitcnt lgkmcnt(2)
    v_exp_f32 v231, v215
    v_mfma_f32_16x16x32_bf16 v[220:223], a[216:219], v[208:211], v[220:223]
    ds_read_b128 a[232:235], v31 offset:24832
    v_add_f32 v63, v63, v230
    v_mfma_f32_16x16x32_bf16 v[220:223], a[220:223], v[216:219], v[220:223]
    v_exp_f32 v164, v148
    v_mfma_f32_16x16x32_bf16 v[156:159], a[220:223], v[152:155], v[156:159]
    v_exp_f32 v165, v149
    v_mfma_f32_16x16x32_bf16 v[156:159], a[216:219], v[144:147], v[156:159]
    ds_read_b128 a[236:239], v32 offset:24832
    v_add_f32 v62, v164, v165
    v_mfma_f32_16x16x32_bf16 v[92:95], a[216:219], v[80:83], v[92:95]
    v_exp_f32 v166, v150
    v_mfma_f32_16x16x32_bf16 v[92:95], a[220:223], v[88:91], v[92:95]
    s_waitcnt lgkmcnt(2)
    s_waitcnt vmcnt(14)
    s_barrier
    v_mfma_f32_16x16x32_bf16 v[92:95], a[224:227], v[96:99], v[92:95]
    ds_read_b64_tr_b16 a[192:193], v1 offset:0
    v_add_f32 v62, v62, v166
    v_mfma_f32_16x16x32_bf16 v[92:95], a[228:231], v[104:107], v[92:95]
    ds_read_b64_tr_b16 a[194:195], v1 offset:8192
    v_add_f32 v63, v63, v231
    v_mfma_f32_16x16x32_bf16 v[156:159], a[228:231], v[168:171], v[156:159]
    v_exp_f32 v167, v151
    v_mfma_f32_16x16x32_bf16 v[156:159], a[224:227], v[160:163], v[156:159]
    ds_read_b64_tr_b16 a[196:197], v2 offset:0
    v_add_f32 v62, v62, v167
    v_mfma_f32_16x16x32_bf16 v[220:223], a[224:227], v[224:227], v[220:223]
    ds_read_b64_tr_b16 a[198:199], v2 offset:8192
    v_mfma_f32_16x16x32_bf16 v[220:223], a[228:231], v[232:235], v[220:223]
    s_waitcnt lgkmcnt(4)
    v_exp_f32 v100, v84
    v_mfma_f32_16x16x32_bf16 v[220:223], a[232:235], v[240:243], v[220:223]
    ds_read_b64_tr_b16 a[200:201], v3 offset:0
    v_mfma_f32_16x16x32_bf16 v[220:223], a[236:239], v[248:251], v[220:223]
    ds_read_b64_tr_b16 a[202:203], v3 offset:8192
    v_mfma_f32_16x16x32_bf16 v[156:159], a[236:239], v[184:187], v[156:159]
    v_exp_f32 v101, v85
    v_mfma_f32_16x16x32_bf16 v[156:159], a[232:235], v[176:179], v[156:159]
    ds_read_b64_tr_b16 a[204:205], v4 offset:0
    v_add_f32 v61, v100, v101
    v_mfma_f32_16x16x32_bf16 v[92:95], a[232:235], v[112:115], v[92:95]
    ds_read_b64_tr_b16 a[206:207], v4 offset:8192
    v_mfma_f32_16x16x32_bf16 v[92:95], a[236:239], v[120:123], v[92:95]
    s_waitcnt lgkmcnt(6)
    v_exp_f32 v102, v86
    v_mfma_f32_16x16x32_bf16 a[0:3], a[192:195], v[116:119], a[0:3]
    ds_read_b64_tr_b16 a[208:209], v5 offset:0
    v_add_f32 v61, v61, v102
    v_mfma_f32_16x16x32_bf16 a[4:7], a[192:195], v[180:183], a[4:7]
    ds_read_b64_tr_b16 a[210:211], v5 offset:8192
    v_mfma_f32_16x16x32_bf16 a[8:11], a[192:195], v[244:247], a[8:11]
    s_waitcnt lgkmcnt(6)
    v_exp_f32 v103, v87
    v_mfma_f32_16x16x32_bf16 a[20:23], a[196:199], v[244:247], a[20:23]
    ds_read_b64_tr_b16 a[212:213], v6 offset:0
    v_add_f32 v61, v61, v103
    v_mfma_f32_16x16x32_bf16 a[16:19], a[196:199], v[180:183], a[16:19]
    ds_read_b64_tr_b16 a[214:215], v6 offset:8192
    v_mfma_f32_16x16x32_bf16 a[12:15], a[196:199], v[116:119], a[12:15]
    s_waitcnt lgkmcnt(6)
    v_exp_f32 v236, v220
    v_mfma_f32_16x16x32_bf16 a[24:27], a[200:203], v[116:119], a[24:27]
    ds_read_b64_tr_b16 a[216:217], v7 offset:0
    v_add_f32 v63, v63, v236
    v_mfma_f32_16x16x32_bf16 a[28:31], a[200:203], v[180:183], a[28:31]
    ds_read_b64_tr_b16 a[218:219], v7 offset:8192
    v_mfma_f32_16x16x32_bf16 a[32:35], a[200:203], v[244:247], a[32:35]
    s_waitcnt lgkmcnt(6)
    v_exp_f32 v237, v221
    v_mfma_f32_16x16x32_bf16 a[44:47], a[204:207], v[244:247], a[44:47]
    ds_read_b64_tr_b16 a[220:221], v8 offset:0
    v_add_f32 v63, v63, v237
    v_mfma_f32_16x16x32_bf16 a[40:43], a[204:207], v[180:183], a[40:43]
    ds_read_b64_tr_b16 a[222:223], v8 offset:8192
    v_mfma_f32_16x16x32_bf16 a[36:39], a[204:207], v[116:119], a[36:39]
    s_waitcnt lgkmcnt(6)
    v_exp_f32 v238, v222
    v_mfma_f32_16x16x32_bf16 a[48:51], a[208:211], v[116:119], a[48:51]
    ds_read_b64_tr_b16 a[224:225], v1 offset:256
    v_add_f32 v63, v63, v238
    v_mfma_f32_16x16x32_bf16 a[52:55], a[208:211], v[180:183], a[52:55]
    ds_read_b64_tr_b16 a[226:227], v1 offset:8448
    v_mfma_f32_16x16x32_bf16 a[56:59], a[208:211], v[244:247], a[56:59]
    s_waitcnt lgkmcnt(6)
    v_exp_f32 v239, v223
    v_mfma_f32_16x16x32_bf16 a[68:71], a[212:215], v[244:247], a[68:71]
    ds_read_b64_tr_b16 a[228:229], v2 offset:256
    v_add_f32 v63, v63, v239
    v_mfma_f32_16x16x32_bf16 a[64:67], a[212:215], v[180:183], a[64:67]
    ds_read_b64_tr_b16 a[230:231], v2 offset:8448
    v_mfma_f32_16x16x32_bf16 a[60:63], a[212:215], v[116:119], a[60:63]
    s_waitcnt lgkmcnt(6)
    v_exp_f32 v172, v156
    v_mfma_f32_16x16x32_bf16 a[72:75], a[216:219], v[116:119], a[72:75]
    ds_read_b64_tr_b16 a[232:233], v3 offset:256
    v_add_f32 v62, v62, v172
    v_mfma_f32_16x16x32_bf16 a[76:79], a[216:219], v[180:183], a[76:79]
    s_add_u32 m0, s28, 98304
    ds_read_b64_tr_b16 a[234:235], v3 offset:8448
    v_mfma_f32_16x16x32_bf16 a[80:83], a[216:219], v[244:247], a[80:83]
    s_waitcnt lgkmcnt(6)
    s_xor_b32 s29, s61, 135168
    v_mfma_f32_16x16x32_bf16 a[92:95], a[220:223], v[244:247], a[92:95]
    ds_read_b64_tr_b16 a[236:237], v4 offset:256
    buffer_load_dwordx4 v49, s[16:19], s29 offen nt lds
    v_mfma_f32_16x16x32_bf16 a[88:91], a[220:223], v[180:183], a[88:91]
    ds_read_b64_tr_b16 a[238:239], v4 offset:8448
    v_mfma_f32_16x16x32_bf16 a[84:87], a[220:223], v[116:119], a[84:87]
    s_waitcnt lgkmcnt(6)
    v_exp_f32 v173, v157
    v_mfma_f32_16x16x32_bf16 a[96:99], a[224:227], v[116:119], a[96:99]
    ds_read_b64_tr_b16 a[192:193], v5 offset:256
    buffer_load_dwordx4 v50, s[16:19], s29 offen offset:1024 nt lds
    v_mfma_f32_16x16x32_bf16 a[100:103], a[224:227], v[180:183], a[100:103]
    ds_read_b64_tr_b16 a[194:195], v5 offset:8448
    v_add_f32 v62, v62, v173
    v_mfma_f32_16x16x32_bf16 a[104:107], a[224:227], v[244:247], a[104:107]
    s_waitcnt lgkmcnt(6)
    v_exp_f32 v174, v158
    v_mfma_f32_16x16x32_bf16 a[116:119], a[228:231], v[244:247], a[116:119]
    ds_read_b64_tr_b16 a[196:197], v6 offset:256
    buffer_load_dwordx4 v51, s[16:19], s29 offen offset:2048 nt lds
    v_mfma_f32_16x16x32_bf16 a[112:115], a[228:231], v[180:183], a[112:115]
    ds_read_b64_tr_b16 a[198:199], v6 offset:8448
    v_add_f32 v62, v62, v174
    v_mfma_f32_16x16x32_bf16 a[108:111], a[228:231], v[116:119], a[108:111]
    s_waitcnt lgkmcnt(6)
    v_exp_f32 v175, v159
    v_mfma_f32_16x16x32_bf16 a[120:123], a[232:235], v[116:119], a[120:123]
    ds_read_b64_tr_b16 a[200:201], v7 offset:256
    buffer_load_dwordx4 v52, s[16:19], s29 offen offset:3072 nt lds
    v_mfma_f32_16x16x32_bf16 a[124:127], a[232:235], v[180:183], a[124:127]
    ds_read_b64_tr_b16 a[202:203], v7 offset:8448
    v_add_f32 v62, v62, v175
    v_mfma_f32_16x16x32_bf16 a[128:131], a[232:235], v[244:247], a[128:131]
    s_waitcnt lgkmcnt(6)
    v_exp_f32 v108, v92
    v_mfma_f32_16x16x32_bf16 a[140:143], a[236:239], v[244:247], a[140:143]
    ds_read_b64_tr_b16 a[204:205], v8 offset:256
    v_add_f32 v61, v61, v108
    v_mfma_f32_16x16x32_bf16 a[136:139], a[236:239], v[180:183], a[136:139]
    ds_read_b64_tr_b16 a[206:207], v8 offset:8448
    v_mfma_f32_16x16x32_bf16 a[132:135], a[236:239], v[116:119], a[132:135]
    s_waitcnt lgkmcnt(6)
    s_waitcnt vmcnt(14)
    s_barrier
    v_mfma_f32_16x16x32_bf16 a[144:147], a[192:195], v[116:119], a[144:147]
    ds_read_b128 a[208:211], v33 offset:16384
    v_mfma_f32_16x16x32_bf16 a[148:151], a[192:195], v[180:183], a[148:151]
    v_exp_f32 v109, v93
    v_mfma_f32_16x16x32_bf16 a[152:155], a[192:195], v[244:247], a[152:155]
    s_waitcnt lgkmcnt(5)
    v_exp_f32 v110, v94
    v_mfma_f32_16x16x32_bf16 a[164:167], a[196:199], v[244:247], a[164:167]
    ds_read_b128 a[212:215], v34 offset:16384
    v_add_f32 v61, v61, v109
    v_mfma_f32_16x16x32_bf16 a[160:163], a[196:199], v[180:183], a[160:163]
    v_exp_f32 v111, v95
    v_mfma_f32_16x16x32_bf16 a[156:159], a[196:199], v[116:119], a[156:159]
    s_waitcnt lgkmcnt(4)
    v_mfma_f32_16x16x32_bf16 a[168:171], a[200:203], v[116:119], a[168:171]
    ds_read_b128 a[216:219], v35 offset:16384
    v_add_f32 v61, v61, v110
    v_mfma_f32_16x16x32_bf16 a[172:175], a[200:203], v[180:183], a[172:175]
    v_mfma_f32_16x16x32_bf16 a[176:179], a[200:203], v[244:247], a[176:179]
    s_waitcnt lgkmcnt(3)
    v_mfma_f32_16x16x32_bf16 a[188:191], a[204:207], v[244:247], a[188:191]
    ds_read_b128 a[220:223], v36 offset:16384
    v_add_f32 v61, v61, v111
    v_mfma_f32_16x16x32_bf16 a[184:187], a[204:207], v[180:183], a[184:187]
    v_max3_f32 v0, v61, v62, v63
    v_cmp_lt_f32 vcc, s35, v0
    v_mfma_f32_16x16x32_bf16 a[180:183], a[204:207], v[116:119], a[180:183]
    s_cbranch_vccnz L_rare11
L_ret11:
    s_waitcnt lgkmcnt(2)
    v_cvt_pk_bf16_f32 v116, v100, v101
    v_mfma_f32_16x16x32_bf16 v[84:87], a[208:211], v[64:67], v[124:127]
    ds_read_b128 a[224:227], v33 offset:16640
    v_cvt_pk_bf16_f32 v117, v102, v103
    v_mfma_f32_16x16x32_bf16 v[84:87], a[212:215], v[72:75], v[84:87]
    v_cvt_pk_bf16_f32 v118, v108, v109
    v_cvt_pk_bf16_f32 v119, v110, v111
    v_mfma_f32_16x16x32_bf16 v[148:151], a[212:215], v[136:139], v[188:191]
    v_cvt_pk_bf16_f32 v180, v164, v165
    v_cvt_pk_bf16_f32 v181, v166, v167
    v_mfma_f32_16x16x32_bf16 v[148:151], a[208:211], v[128:131], v[148:151]
    ds_read_b128 a[228:231], v34 offset:16640
    v_cvt_pk_bf16_f32 v182, v172, v173
    v_mfma_f32_16x16x32_bf16 v[212:215], a[208:211], v[192:195], v[252:255]
    v_cvt_pk_bf16_f32 v183, v174, v175
    v_cvt_pk_bf16_f32 v244, v228, v229
    v_mfma_f32_16x16x32_bf16 v[212:215], a[212:215], v[200:203], v[212:215]
    s_waitcnt lgkmcnt(2)
    v_cvt_pk_bf16_f32 v245, v230, v231
    v_cvt_pk_bf16_f32 v246, v236, v237
    v_mfma_f32_16x16x32_bf16 v[212:215], a[216:219], v[208:211], v[212:215]
    ds_read_b128 a[232:235], v35 offset:16640
    v_cvt_pk_bf16_f32 v247, v238, v239
    v_mfma_f32_16x16x32_bf16 v[212:215], a[220:223], v[216:219], v[212:215]
    v_add_f32 v58, v58, v61
    v_add_f32 v59, v59, v62
    v_mfma_f32_16x16x32_bf16 v[148:151], a[220:223], v[152:155], v[148:151]
    v_add_f32 v60, v60, v63
    v_mfma_f32_16x16x32_bf16 v[148:151], a[216:219], v[144:147], v[148:151]
    ds_read_b128 a[236:239], v36 offset:16640
    v_mfma_f32_16x16x32_bf16 v[84:87], a[216:219], v[80:83], v[84:87]
    s_waitcnt vmcnt(13)
    v_cmp_gt_u32 vcc, 32, v135
    v_mfma_f32_16x16x32_bf16 v[84:87], a[220:223], v[88:91], v[84:87]
    s_waitcnt lgkmcnt(2)
    s_cbranch_vccnz L_cnt_spin
L_cnt_ok:
    v_mfma_f32_16x16x32_bf16 v[84:87], a[224:227], v[96:99], v[84:87]
    ds_read_b128 a[192:195], v33 offset:24576
    v_mfma_f32_16x16x32_bf16 v[84:87], a[228:231], v[104:107], v[84:87]
    v_mfma_f32_16x16x32_bf16 v[148:151], a[228:231], v[168:171], v[148:151]
    v_mfma_f32_16x16x32_bf16 v[148:151], a[224:227], v[160:163], v[148:151]
    ds_read_b128 a[196:199], v34 offset:24576
    v_mfma_f32_16x16x32_bf16 v[212:215], a[224:227], v[224:227], v[212:215]
    v_mfma_f32_16x16x32_bf16 v[212:215], a[228:231], v[232:235], v[212:215]
    s_waitcnt lgkmcnt(2)
    v_mfma_f32_16x16x32_bf16 v[212:215], a[232:235], v[240:243], v[212:215]
    ds_read_b128 a[200:203], v35 offset:24576
    v_mfma_f32_16x16x32_bf16 v[212:215], a[236:239], v[248:251], v[212:215]
    v_mfma_f32_16x16x32_bf16 v[148:151], a[236:239], v[184:187], v[148:151]
    v_mfma_f32_16x16x32_bf16 v[148:151], a[232:235], v[176:179], v[148:151]
    ds_read_b128 a[204:207], v36 offset:24576
    v_mfma_f32_16x16x32_bf16 v[84:87], a[232:235], v[112:115], v[84:87]
    v_mfma_f32_16x16x32_bf16 v[84:87], a[236:239], v[120:123], v[84:87]
    s_waitcnt lgkmcnt(2)
    v_mfma_f32_16x16x32_bf16 v[92:95], a[192:195], v[64:67], v[124:127]
    ds_read_b128 a[208:211], v33 offset:24832
    v_mfma_f32_16x16x32_bf16 v[92:95], a[196:199], v[72:75], v[92:95]
    v_exp_f32 v228, v212
    v_mfma_f32_16x16x32_bf16 v[156:159], a[196:199], v[136:139], v[188:191]
    v_exp_f32 v229, v213
    v_mfma_f32_16x16x32_bf16 v[156:159], a[192:195], v[128:131], v[156:159]
    ds_read_b128 a[212:215], v34 offset:24832
    v_add_f32 v63, v228, v229
    v_mfma_f32_16x16x32_bf16 v[220:223], a[192:195], v[192:195], v[252:255]
    v_exp_f32 v230, v214
    v_mfma_f32_16x16x32_bf16 v[220:223], a[196:199], v[200:203], v[220:223]
    s_waitcnt lgkmcnt(2)
    v_exp_f32 v231, v215
    v_mfma_f32_16x16x32_bf16 v[220:223], a[200:203], v[208:211], v[220:223]
    ds_read_b128 a[216:219], v35 offset:24832
    v_add_f32 v63, v63, v230
    v_mfma_f32_16x16x32_bf16 v[220:223], a[204:207], v[216:219], v[220:223]
    v_exp_f32 v164, v148
    v_mfma_f32_16x16x32_bf16 v[156:159], a[204:207], v[152:155], v[156:159]
    v_exp_f32 v165, v149
    v_mfma_f32_16x16x32_bf16 v[156:159], a[200:203], v[144:147], v[156:159]
    ds_read_b128 a[220:223], v36 offset:24832
    v_add_f32 v62, v164, v165
    v_mfma_f32_16x16x32_bf16 v[92:95], a[200:203], v[80:83], v[92:95]
    s_add_u32 m0, s28, 131072
    v_exp_f32 v166, v150
    v_mfma_f32_16x16x32_bf16 v[92:95], a[204:207], v[88:91], v[92:95]
    s_waitcnt lgkmcnt(2)
    s_waitcnt vmcnt(9)
    s_xor_b32 s29, s61, 137216
    s_barrier
    v_mfma_f32_16x16x32_bf16 v[92:95], a[208:211], v[96:99], v[92:95]
    ds_read_b64_tr_b16 a[224:225], v1 offset:32768
    buffer_load_dwordx4 v49, s[12:15], s29 offen nt lds
    v_mfma_f32_16x16x32_bf16 v[92:95], a[212:215], v[104:107], v[92:95]
    ds_read_b64_tr_b16 a[226:227], v1 offset:40960
    v_add_f32 v62, v62, v166
    v_mfma_f32_16x16x32_bf16 v[156:159], a[212:215], v[168:171], v[156:159]
    v_exp_f32 v167, v151
    v_mfma_f32_16x16x32_bf16 v[156:159], a[208:211], v[160:163], v[156:159]
    ds_read_b64_tr_b16 a[228:229], v2 offset:32768
    buffer_load_dwordx4 v50, s[12:15], s29 offen offset:1024 nt lds
    v_mfma_f32_16x16x32_bf16 v[220:223], a[208:211], v[224:227], v[220:223]
    ds_read_b64_tr_b16 a[230:231], v2 offset:40960
    v_add_f32 v62, v62, v167
    v_mfma_f32_16x16x32_bf16 v[220:223], a[212:215], v[232:235], v[220:223]
    s_waitcnt lgkmcnt(4)
    v_exp_f32 v100, v84
    v_mfma_f32_16x16x32_bf16 v[220:223], a[216:219], v[240:243], v[220:223]
    ds_read_b64_tr_b16 a[232:233], v3 offset:32768
    buffer_load_dwordx4 v51, s[12:15], s29 offen offset:2048 nt lds
    v_mfma_f32_16x16x32_bf16 v[220:223], a[220:223], v[248:251], v[220:223]
    ds_read_b64_tr_b16 a[234:235], v3 offset:40960
    v_add_f32 v63, v63, v231
    v_mfma_f32_16x16x32_bf16 v[156:159], a[220:223], v[184:187], v[156:159]
    v_exp_f32 v101, v85
    v_mfma_f32_16x16x32_bf16 v[156:159], a[216:219], v[176:179], v[156:159]
    ds_read_b64_tr_b16 a[236:237], v4 offset:32768
    buffer_load_dwordx4 v52, s[12:15], s29 offen offset:3072 nt lds
    v_mfma_f32_16x16x32_bf16 v[92:95], a[216:219], v[112:115], v[92:95]
    ds_read_b64_tr_b16 a[238:239], v4 offset:40960
    v_add_f32 v61, v100, v101
    v_mfma_f32_16x16x32_bf16 v[92:95], a[220:223], v[120:123], v[92:95]
    s_waitcnt lgkmcnt(6)
    v_exp_f32 v102, v86
    v_mfma_f32_16x16x32_bf16 a[0:3], a[224:227], v[116:119], a[0:3]
    ds_read_b64_tr_b16 a[192:193], v5 offset:32768
    v_add_f32 v61, v61, v102
    v_mfma_f32_16x16x32_bf16 a[4:7], a[224:227], v[180:183], a[4:7]
    ds_read_b64_tr_b16 a[194:195], v5 offset:40960
    v_mfma_f32_16x16x32_bf16 a[8:11], a[224:227], v[244:247], a[8:11]
    s_waitcnt lgkmcnt(6)
    v_exp_f32 v103, v87
    v_mfma_f32_16x16x32_bf16 a[20:23], a[228:231], v[244:247], a[20:23]
    ds_read_b64_tr_b16 a[196:197], v6 offset:32768
    v_add_f32 v61, v61, v103
    v_mfma_f32_16x16x32_bf16 a[16:19], a[228:231], v[180:183], a[16:19]
    ds_read_b64_tr_b16 a[198:199], v6 offset:40960
    v_mfma_f32_16x16x32_bf16 a[12:15], a[228:231], v[116:119], a[12:15]
    s_waitcnt lgkmcnt(6)
    v_exp_f32 v236, v220
    v_mfma_f32_16x16x32_bf16 a[24:27], a[232:235], v[116:119], a[24:27]
    ds_read_b64_tr_b16 a[200:201], v7 offset:32768
    v_add_f32 v63, v63, v236
    v_mfma_f32_16x16x32_bf16 a[28:31], a[232:235], v[180:183], a[28:31]
    ds_read_b64_tr_b16 a[202:203], v7 offset:40960
    v_mfma_f32_16x16x32_bf16 a[32:35], a[232:235], v[244:247], a[32:35]
    s_waitcnt lgkmcnt(6)
    v_exp_f32 v237, v221
    v_mfma_f32_16x16x32_bf16 a[44:47], a[236:239], v[244:247], a[44:47]
    ds_read_b64_tr_b16 a[204:205], v8 offset:32768
    v_add_f32 v63, v63, v237
    v_mfma_f32_16x16x32_bf16 a[40:43], a[236:239], v[180:183], a[40:43]
    ds_read_b64_tr_b16 a[206:207], v8 offset:40960
    v_mfma_f32_16x16x32_bf16 a[36:39], a[236:239], v[116:119], a[36:39]
    s_waitcnt lgkmcnt(6)
    v_exp_f32 v238, v222
    v_mfma_f32_16x16x32_bf16 a[48:51], a[192:195], v[116:119], a[48:51]
    ds_read_b64_tr_b16 a[208:209], v1 offset:33024
    v_add_f32 v63, v63, v238
    v_mfma_f32_16x16x32_bf16 a[52:55], a[192:195], v[180:183], a[52:55]
    ds_read_b64_tr_b16 a[210:211], v1 offset:41216
    v_mfma_f32_16x16x32_bf16 a[56:59], a[192:195], v[244:247], a[56:59]
    s_waitcnt lgkmcnt(6)
    v_exp_f32 v239, v223
    v_mfma_f32_16x16x32_bf16 a[68:71], a[196:199], v[244:247], a[68:71]
    ds_read_b64_tr_b16 a[212:213], v2 offset:33024
    v_add_f32 v63, v63, v239
    v_mfma_f32_16x16x32_bf16 a[64:67], a[196:199], v[180:183], a[64:67]
    ds_read_b64_tr_b16 a[214:215], v2 offset:41216
    v_mfma_f32_16x16x32_bf16 a[60:63], a[196:199], v[116:119], a[60:63]
    s_waitcnt lgkmcnt(6)
    v_exp_f32 v172, v156
    v_mfma_f32_16x16x32_bf16 a[72:75], a[200:203], v[116:119], a[72:75]
    ds_read_b64_tr_b16 a[216:217], v3 offset:33024
    v_add_f32 v62, v62, v172
    v_mfma_f32_16x16x32_bf16 a[76:79], a[200:203], v[180:183], a[76:79]
    ds_read_b64_tr_b16 a[218:219], v3 offset:41216
    v_mfma_f32_16x16x32_bf16 a[80:83], a[200:203], v[244:247], a[80:83]
    s_waitcnt lgkmcnt(6)
    v_exp_f32 v173, v157
    v_mfma_f32_16x16x32_bf16 a[92:95], a[204:207], v[244:247], a[92:95]
    ds_read_b64_tr_b16 a[220:221], v4 offset:33024
    v_add_f32 v62, v62, v173
    v_mfma_f32_16x16x32_bf16 a[88:91], a[204:207], v[180:183], a[88:91]
    ds_read_b64_tr_b16 a[222:223], v4 offset:41216
    v_mfma_f32_16x16x32_bf16 a[84:87], a[204:207], v[116:119], a[84:87]
    s_waitcnt lgkmcnt(6)
    v_exp_f32 v174, v158
    v_mfma_f32_16x16x32_bf16 a[96:99], a[208:211], v[116:119], a[96:99]
    ds_read_b64_tr_b16 a[224:225], v5 offset:33024
    v_add_f32 v62, v62, v174
    v_mfma_f32_16x16x32_bf16 a[100:103], a[208:211], v[180:183], a[100:103]
    ds_read_b64_tr_b16 a[226:227], v5 offset:41216
    v_mfma_f32_16x16x32_bf16 a[104:107], a[208:211], v[244:247], a[104:107]
    s_waitcnt lgkmcnt(6)
    v_exp_f32 v175, v159
    v_mfma_f32_16x16x32_bf16 a[116:119], a[212:215], v[244:247], a[116:119]
    ds_read_b64_tr_b16 a[228:229], v6 offset:33024
    v_add_f32 v62, v62, v175
    v_mfma_f32_16x16x32_bf16 a[112:115], a[212:215], v[180:183], a[112:115]
    ds_read_b64_tr_b16 a[230:231], v6 offset:41216
    v_mfma_f32_16x16x32_bf16 a[108:111], a[212:215], v[116:119], a[108:111]
    s_waitcnt lgkmcnt(6)
    v_exp_f32 v108, v92
    v_mfma_f32_16x16x32_bf16 a[120:123], a[216:219], v[116:119], a[120:123]
    ds_read_b64_tr_b16 a[232:233], v7 offset:33024
    v_add_f32 v61, v61, v108
    v_mfma_f32_16x16x32_bf16 a[124:127], a[216:219], v[180:183], a[124:127]
    ds_read_b64_tr_b16 a[234:235], v7 offset:41216
    v_mfma_f32_16x16x32_bf16 a[128:131], a[216:219], v[244:247], a[128:131]
    s_waitcnt lgkmcnt(6)
    v_exp_f32 v109, v93
    v_mfma_f32_16x16x32_bf16 a[140:143], a[220:223], v[244:247], a[140:143]
    ds_read_b64_tr_b16 a[236:237], v8 offset:33024
    v_add_f32 v61, v61, v109
    v_mfma_f32_16x16x32_bf16 a[136:139], a[220:223], v[180:183], a[136:139]
    ds_read_b64_tr_b16 a[238:239], v8 offset:41216
    v_mfma_f32_16x16x32_bf16 a[132:135], a[220:223], v[116:119], a[132:135]
    s_waitcnt lgkmcnt(6)
    s_waitcnt vmcnt(9)
    s_barrier
    v_mfma_f32_16x16x32_bf16 a[144:147], a[224:227], v[116:119], a[144:147]
    ds_read_b128 a[192:195], v29 offset:0
    v_mfma_f32_16x16x32_bf16 a[148:151], a[224:227], v[180:183], a[148:151]
    v_exp_f32 v110, v94
    v_mfma_f32_16x16x32_bf16 a[152:155], a[224:227], v[244:247], a[152:155]
    s_waitcnt lgkmcnt(5)
    v_exp_f32 v111, v95
    v_mfma_f32_16x16x32_bf16 a[164:167], a[228:231], v[244:247], a[164:167]
    ds_read_b128 a[196:199], v30 offset:0
    v_add_f32 v61, v61, v110
    v_mfma_f32_16x16x32_bf16 a[160:163], a[228:231], v[180:183], a[160:163]
    v_mfma_f32_16x16x32_bf16 a[156:159], a[228:231], v[116:119], a[156:159]
    s_waitcnt lgkmcnt(4)
    v_mfma_f32_16x16x32_bf16 a[168:171], a[232:235], v[116:119], a[168:171]
    ds_read_b128 a[200:203], v31 offset:0
    v_add_f32 v61, v61, v111
    v_mfma_f32_16x16x32_bf16 a[172:175], a[232:235], v[180:183], a[172:175]
    v_max3_f32 v0, v61, v62, v63
    v_cmp_lt_f32 vcc, s35, v0
    v_mfma_f32_16x16x32_bf16 a[176:179], a[232:235], v[244:247], a[176:179]
    s_waitcnt lgkmcnt(3)
    v_mfma_f32_16x16x32_bf16 a[188:191], a[236:239], v[244:247], a[188:191]
    ds_read_b128 a[204:207], v32 offset:0
    v_mfma_f32_16x16x32_bf16 a[184:187], a[236:239], v[180:183], a[184:187]
    v_mfma_f32_16x16x32_bf16 a[180:183], a[236:239], v[116:119], a[180:183]
    s_cbranch_vccnz L_rare12
L_ret12:
    s_waitcnt lgkmcnt(2)
    v_cvt_pk_bf16_f32 v116, v100, v101
    v_mfma_f32_16x16x32_bf16 v[84:87], a[192:195], v[64:67], v[124:127]
    s_lshr_b32 s52, s59, 2
    ds_read_b128 a[208:211], v29 offset:256
    v_cvt_pk_bf16_f32 v117, v102, v103
    v_mfma_f32_16x16x32_bf16 v[84:87], a[196:199], v[72:75], v[84:87]
    s_add_u32 m0, s28, 16384
    v_cvt_pk_bf16_f32 v118, v108, v109
    v_cvt_pk_bf16_f32 v119, v110, v111
    v_mfma_f32_16x16x32_bf16 v[148:151], a[196:199], v[136:139], v[188:191]
    s_xor_b32 s29, s61, 136192
    v_cvt_pk_bf16_f32 v180, v164, v165
    v_cvt_pk_bf16_f32 v181, v166, v167
    v_mfma_f32_16x16x32_bf16 v[148:151], a[192:195], v[128:131], v[148:151]
    s_mul_i32 s96, s52, 917504
    ds_read_b128 a[212:215], v30 offset:256
    buffer_load_dwordx4 v49, s[16:19], s29 offen nt lds
    v_mfma_f32_16x16x32_bf16 v[212:215], a[192:195], v[192:195], v[252:255]
    s_mul_i32 s97, s58, 24576
    v_cvt_pk_bf16_f32 v182, v172, v173
    v_cvt_pk_bf16_f32 v183, v174, v175
    v_mfma_f32_16x16x32_bf16 v[212:215], a[196:199], v[200:203], v[212:215]
    s_waitcnt lgkmcnt(2)
    v_cvt_pk_bf16_f32 v244, v228, v229
    v_cvt_pk_bf16_f32 v245, v230, v231
    v_mfma_f32_16x16x32_bf16 v[212:215], a[200:203], v[208:211], v[212:215]
    s_add_u32 s96, s96, s97
    ds_read_b128 a[216:219], v31 offset:256
    buffer_load_dwordx4 v50, s[16:19], s29 offen offset:1024 nt lds
    v_mfma_f32_16x16x32_bf16 v[212:215], a[204:207], v[216:219], v[212:215]
    v_cvt_pk_bf16_f32 v246, v236, v237
    v_cvt_pk_bf16_f32 v247, v238, v239
    v_mfma_f32_16x16x32_bf16 v[148:151], a[204:207], v[152:155], v[148:151]
    v_add_f32 v58, v58, v61
    v_add_f32 v59, v59, v62
    v_mfma_f32_16x16x32_bf16 v[148:151], a[200:203], v[144:147], v[148:151]
    ds_read_b128 a[220:223], v32 offset:256
    buffer_load_dwordx4 v51, s[16:19], s29 offen offset:2048 nt lds
    v_mfma_f32_16x16x32_bf16 v[84:87], a[200:203], v[80:83], v[84:87]
    v_add_f32 v60, v60, v63
    v_mbcnt_lo_u32_b32 v57, -1, 0
    v_mfma_f32_16x16x32_bf16 v[84:87], a[204:207], v[88:91], v[84:87]
    s_waitcnt lgkmcnt(2)
    v_mbcnt_hi_u32_b32 v57, -1, v57
    v_lshlrev_b32 v48, 4, v57
    v_mfma_f32_16x16x32_bf16 v[84:87], a[208:211], v[96:99], v[84:87]
    ds_read_b128 a[224:227], v29 offset:8192
    buffer_load_dwordx4 v52, s[16:19], s29 offen offset:3072 nt lds
    v_mfma_f32_16x16x32_bf16 v[84:87], a[212:215], v[104:107], v[84:87]
    v_add_u32 v45, s96, v48
    v_lshrrev_b32 v46, 2, v57
    v_mfma_f32_16x16x32_bf16 v[148:151], a[212:215], v[168:171], v[148:151]
    v_lshlrev_b32 v46, 16, v46
    v_and_b32 v47, 3, v57
    v_mfma_f32_16x16x32_bf16 v[148:151], a[208:211], v[160:163], v[148:151]
    ds_read_b128 a[228:231], v30 offset:8192
    v_lshl_add_u32 v46, v47, 10, v46
    v_mfma_f32_16x16x32_bf16 v[212:215], a[208:211], v[224:227], v[212:215]
    v_mfma_f32_16x16x32_bf16 v[212:215], a[212:215], v[232:235], v[212:215]
    s_waitcnt lgkmcnt(2)
    v_mfma_f32_16x16x32_bf16 v[212:215], a[216:219], v[240:243], v[212:215]
    ds_read_b128 a[232:235], v31 offset:8192
    v_mfma_f32_16x16x32_bf16 v[212:215], a[220:223], v[248:251], v[212:215]
    s_add_u32 m0, s28, 49152
    v_mfma_f32_16x16x32_bf16 v[148:151], a[220:223], v[184:187], v[148:151]
    s_add_u32 s29, s88, s93
    v_mfma_f32_16x16x32_bf16 v[148:151], a[216:219], v[176:179], v[148:151]
    ds_read_b128 a[236:239], v32 offset:8192
    buffer_load_dwordx4 v53, s[20:23], s29 offen lds
    v_mfma_f32_16x16x32_bf16 v[84:87], a[216:219], v[112:115], v[84:87]
    v_mfma_f32_16x16x32_bf16 v[84:87], a[220:223], v[120:123], v[84:87]
    s_waitcnt lgkmcnt(2)
    v_mfma_f32_16x16x32_bf16 v[92:95], a[224:227], v[64:67], v[124:127]
    ds_read_b128 a[192:195], v29 offset:8448
    buffer_load_dwordx4 v54, s[20:23], s29 offen offset:1024 lds
    v_mfma_f32_16x16x32_bf16 v[92:95], a[228:231], v[72:75], v[92:95]
    v_exp_f32 v228, v212
    v_mfma_f32_16x16x32_bf16 v[156:159], a[228:231], v[136:139], v[188:191]
    v_exp_f32 v229, v213
    v_mfma_f32_16x16x32_bf16 v[156:159], a[224:227], v[128:131], v[156:159]
    ds_read_b128 a[196:199], v30 offset:8448
    buffer_load_dwordx4 v55, s[20:23], s29 offen offset:2048 lds
    v_mfma_f32_16x16x32_bf16 v[220:223], a[224:227], v[192:195], v[252:255]
    v_exp_f32 v230, v214
    v_mfma_f32_16x16x32_bf16 v[220:223], a[228:231], v[200:203], v[220:223]
    s_waitcnt lgkmcnt(2)
    v_exp_f32 v231, v215
    v_mfma_f32_16x16x32_bf16 v[220:223], a[232:235], v[208:211], v[220:223]
    ds_read_b128 a[200:203], v31 offset:8448
    buffer_load_dwordx4 v56, s[20:23], s29 offen offset:3072 lds
    v_mfma_f32_16x16x32_bf16 v[220:223], a[236:239], v[216:219], v[220:223]
    v_exp_f32 v164, v148
    v_mfma_f32_16x16x32_bf16 v[156:159], a[236:239], v[152:155], v[156:159]
    v_exp_f32 v165, v149
    v_mfma_f32_16x16x32_bf16 v[156:159], a[232:235], v[144:147], v[156:159]
    ds_read_b128 a[204:207], v32 offset:8448
    v_add_f32 v62, v164, v165
    v_mfma_f32_16x16x32_bf16 v[92:95], a[232:235], v[80:83], v[92:95]
    v_exp_f32 v166, v150
    v_mfma_f32_16x16x32_bf16 v[92:95], a[236:239], v[88:91], v[92:95]
    s_waitcnt lgkmcnt(2)
    s_waitcnt vmcnt(12)
    s_barrier
    v_mfma_f32_16x16x32_bf16 v[92:95], a[192:195], v[96:99], v[92:95]
    ds_read_b64_tr_b16 a[208:209], v9 offset:32768
    v_add_f32 v62, v62, v166
    v_mfma_f32_16x16x32_bf16 v[92:95], a[196:199], v[104:107], v[92:95]
    ds_read_b64_tr_b16 a[210:211], v9 offset:40960
    v_add_f32 v63, v228, v229
    v_mfma_f32_16x16x32_bf16 v[156:159], a[196:199], v[168:171], v[156:159]
    v_exp_f32 v167, v151
    v_mfma_f32_16x16x32_bf16 v[156:159], a[192:195], v[160:163], v[156:159]
    ds_read_b64_tr_b16 a[212:213], v10 offset:32768
    v_add_f32 v62, v62, v167
    v_mfma_f32_16x16x32_bf16 v[220:223], a[192:195], v[224:227], v[220:223]
    ds_read_b64_tr_b16 a[214:215], v10 offset:40960
    v_add_f32 v63, v63, v230
    v_mfma_f32_16x16x32_bf16 v[220:223], a[196:199], v[232:235], v[220:223]
    s_waitcnt lgkmcnt(4)
    v_exp_f32 v100, v84
    v_mfma_f32_16x16x32_bf16 v[220:223], a[200:203], v[240:243], v[220:223]
    ds_read_b64_tr_b16 a[216:217], v11 offset:32768
    v_add_f32 v63, v63, v231
    v_mfma_f32_16x16x32_bf16 v[220:223], a[204:207], v[248:251], v[220:223]
    ds_read_b64_tr_b16 a[218:219], v11 offset:40960
    v_mfma_f32_16x16x32_bf16 v[156:159], a[204:207], v[184:187], v[156:159]
    v_exp_f32 v101, v85
    v_mfma_f32_16x16x32_bf16 v[156:159], a[200:203], v[176:179], v[156:159]
    ds_read_b64_tr_b16 a[220:221], v12 offset:32768
    v_add_f32 v61, v100, v101
    v_mfma_f32_16x16x32_bf16 v[92:95], a[200:203], v[112:115], v[92:95]
    ds_read_b64_tr_b16 a[222:223], v12 offset:40960
    v_mfma_f32_16x16x32_bf16 v[92:95], a[204:207], v[120:123], v[92:95]
    s_waitcnt lgkmcnt(6)
    v_exp_f32 v102, v86
    v_mfma_f32_16x16x32_bf16 a[0:3], a[208:211], v[116:119], a[0:3]
    ds_read_b64_tr_b16 a[224:225], v13 offset:32768
    v_add_f32 v61, v61, v102
    v_mfma_f32_16x16x32_bf16 a[4:7], a[208:211], v[180:183], a[4:7]
    ds_read_b64_tr_b16 a[226:227], v13 offset:40960
    v_mfma_f32_16x16x32_bf16 a[8:11], a[208:211], v[244:247], a[8:11]
    s_waitcnt lgkmcnt(6)
    v_exp_f32 v103, v87
    v_mfma_f32_16x16x32_bf16 a[20:23], a[212:215], v[244:247], a[20:23]
    ds_read_b64_tr_b16 a[228:229], v14 offset:32768
    v_add_f32 v61, v61, v103
    v_mfma_f32_16x16x32_bf16 a[16:19], a[212:215], v[180:183], a[16:19]
    ds_read_b64_tr_b16 a[230:231], v14 offset:40960
    v_mfma_f32_16x16x32_bf16 a[12:15], a[212:215], v[116:119], a[12:15]
    s_waitcnt lgkmcnt(6)
    v_exp_f32 v236, v220
    v_mfma_f32_16x16x32_bf16 a[24:27], a[216:219], v[116:119], a[24:27]
    ds_read_b64_tr_b16 a[232:233], v15 offset:32768
    v_add_f32 v63, v63, v236
    v_mfma_f32_16x16x32_bf16 a[28:31], a[216:219], v[180:183], a[28:31]
    ds_read_b64_tr_b16 a[234:235], v15 offset:40960
    v_mfma_f32_16x16x32_bf16 a[32:35], a[216:219], v[244:247], a[32:35]
    s_waitcnt lgkmcnt(6)
    v_exp_f32 v237, v221
    v_mfma_f32_16x16x32_bf16 a[44:47], a[220:223], v[244:247], a[44:47]
    ds_read_b64_tr_b16 a[236:237], v16 offset:32768
    v_add_f32 v63, v63, v237
    v_mfma_f32_16x16x32_bf16 a[40:43], a[220:223], v[180:183], a[40:43]
    ds_read_b64_tr_b16 a[238:239], v16 offset:40960
    v_mfma_f32_16x16x32_bf16 a[36:39], a[220:223], v[116:119], a[36:39]
    s_waitcnt lgkmcnt(6)
    v_exp_f32 v238, v222
    v_mfma_f32_16x16x32_bf16 a[48:51], a[224:227], v[116:119], a[48:51]
    ds_read_b64_tr_b16 a[192:193], v9 offset:33024
    v_add_f32 v63, v63, v238
    v_mfma_f32_16x16x32_bf16 a[52:55], a[224:227], v[180:183], a[52:55]
    ds_read_b64_tr_b16 a[194:195], v9 offset:41216
    v_mfma_f32_16x16x32_bf16 a[56:59], a[224:227], v[244:247], a[56:59]
    s_waitcnt lgkmcnt(6)
    v_exp_f32 v239, v223
    v_mfma_f32_16x16x32_bf16 a[68:71], a[228:231], v[244:247], a[68:71]
    ds_read_b64_tr_b16 a[196:197], v10 offset:33024
    v_add_f32 v63, v63, v239
    v_mfma_f32_16x16x32_bf16 a[64:67], a[228:231], v[180:183], a[64:67]
    s_add_u32 m0, s28, 114688
    ds_read_b64_tr_b16 a[198:199], v10 offset:41216
    v_mfma_f32_16x16x32_bf16 a[60:63], a[228:231], v[116:119], a[60:63]
    s_waitcnt lgkmcnt(6)
    s_xor_b32 s29, s61, 138240
    v_mfma_f32_16x16x32_bf16 a[72:75], a[232:235], v[116:119], a[72:75]
    ds_read_b64_tr_b16 a[200:201], v11 offset:33024
    buffer_load_dwordx4 v49, s[12:15], s29 offen nt lds
    v_mfma_f32_16x16x32_bf16 a[76:79], a[232:235], v[180:183], a[76:79]
    ds_read_b64_tr_b16 a[202:203], v11 offset:41216
    v_mfma_f32_16x16x32_bf16 a[80:83], a[232:235], v[244:247], a[80:83]
    s_waitcnt lgkmcnt(6)
    v_exp_f32 v172, v156
    v_mfma_f32_16x16x32_bf16 a[92:95], a[236:239], v[244:247], a[92:95]
    ds_read_b64_tr_b16 a[204:205], v12 offset:33024
    buffer_load_dwordx4 v50, s[12:15], s29 offen offset:1024 nt lds
    v_mfma_f32_16x16x32_bf16 a[88:91], a[236:239], v[180:183], a[88:91]
    ds_read_b64_tr_b16 a[206:207], v12 offset:41216
    v_add_f32 v62, v62, v172
    v_mfma_f32_16x16x32_bf16 a[84:87], a[236:239], v[116:119], a[84:87]
    s_waitcnt lgkmcnt(6)
    v_exp_f32 v173, v157
    v_mfma_f32_16x16x32_bf16 a[96:99], a[192:195], v[116:119], a[96:99]
    s_mul_i32 s96, s52, 12288
    ds_read_b64_tr_b16 a[208:209], v13 offset:33024
    buffer_load_dwordx4 v51, s[12:15], s29 offen offset:2048 nt lds
    v_mfma_f32_16x16x32_bf16 a[100:103], a[192:195], v[180:183], a[100:103]
    s_lshl_b32 s97, s58, 2
    ds_read_b64_tr_b16 a[210:211], v13 offset:41216
    v_add_f32 v62, v62, v173
    v_mfma_f32_16x16x32_bf16 a[104:107], a[192:195], v[244:247], a[104:107]
    s_waitcnt lgkmcnt(6)
    v_exp_f32 v174, v158
    v_mfma_f32_16x16x32_bf16 a[116:119], a[196:199], v[244:247], a[116:119]
    s_add_u32 s97, s97, s63
    ds_read_b64_tr_b16 a[212:213], v14 offset:33024
    buffer_load_dwordx4 v52, s[12:15], s29 offen offset:3072 nt lds
    v_mfma_f32_16x16x32_bf16 a[112:115], a[196:199], v[180:183], a[112:115]
    s_mul_i32 s97, s97, 49152
    ds_read_b64_tr_b16 a[214:215], v14 offset:41216
    v_add_f32 v62, v62, v174
    v_mfma_f32_16x16x32_bf16 a[108:111], a[196:199], v[116:119], a[108:111]
    s_waitcnt lgkmcnt(6)
    v_exp_f32 v175, v159
    v_mfma_f32_16x16x32_bf16 a[120:123], a[200:203], v[116:119], a[120:123]
    s_add_u32 s96, s96, s97
    ds_read_b64_tr_b16 a[216:217], v15 offset:33024
    v_add_f32 v62, v62, v175
    v_mfma_f32_16x16x32_bf16 a[124:127], a[200:203], v[180:183], a[124:127]
    s_add_u32 s96, s96, 3670016
    ds_read_b64_tr_b16 a[218:219], v15 offset:41216
    v_mfma_f32_16x16x32_bf16 a[128:131], a[200:203], v[244:247], a[128:131]
    s_waitcnt lgkmcnt(6)
    v_exp_f32 v108, v92
    v_mfma_f32_16x16x32_bf16 a[140:143], a[204:207], v[244:247], a[140:143]
    s_mul_i32 s97, s59, 49152
    ds_read_b64_tr_b16 a[220:221], v16 offset:33024
    v_add_f32 v61, v61, v108
    v_mfma_f32_16x16x32_bf16 a[136:139], a[204:207], v[180:183], a[136:139]
    s_add_u32 s97, s97, s28
    ds_read_b64_tr_b16 a[222:223], v16 offset:41216
    v_mfma_f32_16x16x32_bf16 a[132:135], a[204:207], v[116:119], a[132:135]
    s_waitcnt lgkmcnt(6)
    s_waitcnt vmcnt(12)
    s_barrier
    v_mfma_f32_16x16x32_bf16 a[144:147], a[208:211], v[116:119], a[144:147]
    s_add_u32 s97, s97, 3670016
    ds_read_b128 a[224:227], v33 offset:0
    v_mfma_f32_16x16x32_bf16 a[148:151], a[208:211], v[180:183], a[148:151]
    s_add_u32 m0, s28, 81920
    v_exp_f32 v109, v93
    v_mfma_f32_16x16x32_bf16 a[152:155], a[208:211], v[244:247], a[152:155]
    s_waitcnt lgkmcnt(5)
    s_add_u32 s29, s88, s94
    v_add_f32 v61, v61, v109
    v_mfma_f32_16x16x32_bf16 a[164:167], a[212:215], v[244:247], a[164:167]
    s_and_b32 s52, s63, 2
    ds_read_b128 a[228:231], v34 offset:0
    buffer_load_dwordx4 v53, s[20:23], s29 offen lds
    v_mfma_f32_16x16x32_bf16 a[160:163], a[212:215], v[180:183], a[160:163]
    s_lshl_b32 s52, s52, 10
    v_exp_f32 v110, v94
    v_mfma_f32_16x16x32_bf16 a[156:159], a[212:215], v[116:119], a[156:159]
    s_waitcnt lgkmcnt(4)
    v_exp_f32 v111, v95
    v_mfma_f32_16x16x32_bf16 a[168:171], a[216:219], v[116:119], a[168:171]
    s_and_b32 s34, s63, 1
    ds_read_b128 a[232:235], v35 offset:0
    buffer_load_dwordx4 v54, s[20:23], s29 offen offset:1024 lds
    v_mfma_f32_16x16x32_bf16 a[172:175], a[216:219], v[180:183], a[172:175]
    s_add_u32 s52, s52, s34
    v_add_f32 v61, v61, v110
    v_add_f32 v61, v61, v111
    v_mfma_f32_16x16x32_bf16 a[176:179], a[216:219], v[244:247], a[176:179]
    s_waitcnt lgkmcnt(3)
    v_max3_f32 v0, v61, v62, v63
    v_cmp_lt_f32 vcc, s35, v0
    v_mfma_f32_16x16x32_bf16 a[188:191], a[220:223], v[244:247], a[188:191]
    s_and_b32 s34, s2, 7
    ds_read_b128 a[236:239], v36 offset:0
    buffer_load_dwordx4 v55, s[20:23], s29 offen offset:2048 lds
    v_mfma_f32_16x16x32_bf16 a[184:187], a[220:223], v[180:183], a[184:187]
    s_lshl_b32 s34, s34, 1
    v_mfma_f32_16x16x32_bf16 a[180:183], a[220:223], v[116:119], a[180:183]
    s_cbranch_vccnz L_rare13
L_ret13:
    s_waitcnt lgkmcnt(2)
    v_cvt_pk_bf16_f32 v116, v100, v101
    v_mfma_f32_16x16x32_bf16 v[84:87], a[224:227], v[64:67], v[124:127]
    s_add_u32 s52, s52, s34
    ds_read_b128 a[192:195], v33 offset:256
    buffer_load_dwordx4 v56, s[20:23], s29 offen offset:3072 lds
    v_mfma_f32_16x16x32_bf16 v[84:87], a[228:231], v[72:75], v[84:87]
    s_andn2_b32 s63, s48, 1023
    v_cvt_pk_bf16_f32 v117, v102, v103
    v_cvt_pk_bf16_f32 v118, v108, v109
    v_mfma_f32_16x16x32_bf16 v[148:151], a[228:231], v[136:139], v[188:191]
    s_add_u32 s63, s63, 512
    v_cvt_pk_bf16_f32 v119, v110, v111
    v_cvt_pk_bf16_f32 v180, v164, v165
    v_mfma_f32_16x16x32_bf16 v[148:151], a[224:227], v[128:131], v[148:151]
    s_mov_b64 s[84:85], 0
    ds_read_b128 a[196:199], v34 offset:256
    v_cvt_pk_bf16_f32 v181, v166, v167
    v_mfma_f32_16x16x32_bf16 v[212:215], a[224:227], v[192:195], v[252:255]
    s_mov_b64 s[86:87], 0
    v_cvt_pk_bf16_f32 v182, v172, v173
    v_cvt_pk_bf16_f32 v183, v174, v175
    v_mfma_f32_16x16x32_bf16 v[212:215], a[228:231], v[200:203], v[212:215]
    s_waitcnt lgkmcnt(2)
    v_cvt_pk_bf16_f32 v244, v228, v229
    v_cvt_pk_bf16_f32 v245, v230, v231
    v_mfma_f32_16x16x32_bf16 v[212:215], a[232:235], v[208:211], v[212:215]
    ds_read_b128 a[200:203], v35 offset:256
    v_cvt_pk_bf16_f32 v246, v236, v237
    v_mfma_f32_16x16x32_bf16 v[212:215], a[236:239], v[216:219], v[212:215]
    v_cvt_pk_bf16_f32 v247, v238, v239
    v_add_f32 v58, v58, v61
    v_mfma_f32_16x16x32_bf16 v[148:151], a[236:239], v[152:155], v[148:151]
    v_add_f32 v59, v59, v62
    v_add_f32 v60, v60, v63
    v_mfma_f32_16x16x32_bf16 v[148:151], a[232:235], v[144:147], v[148:151]
    ds_read_b128 a[204:207], v36 offset:256
    v_and_b32 v44, 14, v57
    v_mfma_f32_16x16x32_bf16 v[84:87], a[232:235], v[80:83], v[84:87]
    v_lshlrev_b32 v44, 1, v44
    v_and_or_b32 v44, v57, 1, v44
    v_mfma_f32_16x16x32_bf16 v[84:87], a[236:239], v[88:91], v[84:87]
    s_waitcnt lgkmcnt(2)
    v_lshlrev_b32 v44, 10, v44
    v_lshrrev_b32 v43, 4, v57
    v_mfma_f32_16x16x32_bf16 v[84:87], a[192:195], v[96:99], v[84:87]
    ds_read_b128 a[208:211], v33 offset:8192
    v_add_u32 v43, s58, v43
    v_mfma_f32_16x16x32_bf16 v[84:87], a[196:199], v[104:107], v[84:87]
    v_lshl_add_u32 v44, v43, 16, v44
    v_mov_b32 v47, 1
    v_mfma_f32_16x16x32_bf16 v[148:151], a[196:199], v[168:171], v[148:151]
    v_mfma_f32_16x16x32_bf16 v[148:151], a[192:195], v[160:163], v[148:151]
    ds_read_b128 a[212:215], v34 offset:8192
    v_mfma_f32_16x16x32_bf16 v[212:215], a[192:195], v[224:227], v[212:215]
    v_mfma_f32_16x16x32_bf16 v[212:215], a[196:199], v[232:235], v[212:215]
    s_waitcnt lgkmcnt(2)
    v_mfma_f32_16x16x32_bf16 v[212:215], a[200:203], v[240:243], v[212:215]
    ds_read_b128 a[216:219], v35 offset:8192
    v_mfma_f32_16x16x32_bf16 v[212:215], a[204:207], v[248:251], v[212:215]
    v_mfma_f32_16x16x32_bf16 v[148:151], a[204:207], v[184:187], v[148:151]
    v_mfma_f32_16x16x32_bf16 v[148:151], a[200:203], v[176:179], v[148:151]
    ds_read_b128 a[220:223], v36 offset:8192
    v_mfma_f32_16x16x32_bf16 v[84:87], a[200:203], v[112:115], v[84:87]
    v_mfma_f32_16x16x32_bf16 v[84:87], a[204:207], v[120:123], v[84:87]
    s_waitcnt lgkmcnt(2)
    v_mfma_f32_16x16x32_bf16 v[92:95], a[208:211], v[64:67], v[124:127]
    ds_read_b128 a[224:227], v33 offset:8448
    v_mfma_f32_16x16x32_bf16 v[92:95], a[212:215], v[72:75], v[92:95]
    v_exp_f32 v228, v212
    v_mfma_f32_16x16x32_bf16 v[156:159], a[212:215], v[136:139], v[188:191]
    v_exp_f32 v229, v213
    v_mfma_f32_16x16x32_bf16 v[156:159], a[208:211], v[128:131], v[156:159]
    ds_read_b128 a[228:231], v34 offset:8448
    v_add_f32 v63, v228, v229
    v_mfma_f32_16x16x32_bf16 v[220:223], a[208:211], v[192:195], v[252:255]
    v_exp_f32 v230, v214
    v_mfma_f32_16x16x32_bf16 v[220:223], a[212:215], v[200:203], v[220:223]
    s_waitcnt lgkmcnt(2)
    v_exp_f32 v231, v215
    v_mfma_f32_16x16x32_bf16 v[220:223], a[216:219], v[208:211], v[220:223]
    ds_read_b128 a[232:235], v35 offset:8448
    v_add_f32 v63, v63, v230
    v_mfma_f32_16x16x32_bf16 v[220:223], a[220:223], v[216:219], v[220:223]
    s_add_u32 m0, s28, 0
    v_exp_f32 v164, v148
    v_mfma_f32_16x16x32_bf16 v[156:159], a[220:223], v[152:155], v[156:159]
    s_xor_b32 s29, s61, 137216
    v_exp_f32 v165, v149
    v_mfma_f32_16x16x32_bf16 v[156:159], a[216:219], v[144:147], v[156:159]
    ds_read_b128 a[236:239], v36 offset:8448
    buffer_load_dwordx4 v49, s[16:19], s29 offen nt lds
    v_mfma_f32_16x16x32_bf16 v[92:95], a[216:219], v[80:83], v[92:95]
    v_exp_f32 v166, v150
    v_mfma_f32_16x16x32_bf16 v[92:95], a[220:223], v[88:91], v[92:95]
    s_waitcnt lgkmcnt(2)
    s_waitcnt vmcnt(13)
    s_barrier
    v_mfma_f32_16x16x32_bf16 v[92:95], a[224:227], v[96:99], v[92:95]
    ds_read_b64_tr_b16 a[192:193], v1 offset:16384
    buffer_load_dwordx4 v50, s[16:19], s29 offen offset:1024 nt lds
    v_mfma_f32_16x16x32_bf16 v[92:95], a[228:231], v[104:107], v[92:95]
    ds_read_b64_tr_b16 a[194:195], v1 offset:24576
    v_add_f32 v62, v164, v165
    v_mfma_f32_16x16x32_bf16 v[156:159], a[228:231], v[168:171], v[156:159]
    v_exp_f32 v167, v151
    v_mfma_f32_16x16x32_bf16 v[156:159], a[224:227], v[160:163], v[156:159]
    ds_read_b64_tr_b16 a[196:197], v2 offset:16384
    buffer_load_dwordx4 v51, s[16:19], s29 offen offset:2048 nt lds
    v_mfma_f32_16x16x32_bf16 v[220:223], a[224:227], v[224:227], v[220:223]
    ds_read_b64_tr_b16 a[198:199], v2 offset:24576
    v_add_f32 v62, v62, v166
    v_mfma_f32_16x16x32_bf16 v[220:223], a[228:231], v[232:235], v[220:223]
    s_waitcnt lgkmcnt(4)
    v_exp_f32 v100, v84
    v_mfma_f32_16x16x32_bf16 v[220:223], a[232:235], v[240:243], v[220:223]
    ds_read_b64_tr_b16 a[200:201], v3 offset:16384
    buffer_load_dwordx4 v52, s[16:19], s29 offen offset:3072 nt lds
    v_mfma_f32_16x16x32_bf16 v[220:223], a[236:239], v[248:251], v[220:223]
    ds_read_b64_tr_b16 a[202:203], v3 offset:24576
    v_add_f32 v62, v62, v167
    v_mfma_f32_16x16x32_bf16 v[156:159], a[236:239], v[184:187], v[156:159]
    v_exp_f32 v101, v85
    v_mfma_f32_16x16x32_bf16 v[156:159], a[232:235], v[176:179], v[156:159]
    ds_read_b64_tr_b16 a[204:205], v4 offset:16384
    v_add_f32 v61, v100, v101
    v_mfma_f32_16x16x32_bf16 v[92:95], a[232:235], v[112:115], v[92:95]
    ds_read_b64_tr_b16 a[206:207], v4 offset:24576
    v_add_f32 v63, v63, v231
    v_mfma_f32_16x16x32_bf16 v[92:95], a[236:239], v[120:123], v[92:95]
    s_waitcnt lgkmcnt(6)
    v_exp_f32 v102, v86
    v_mfma_f32_16x16x32_bf16 a[0:3], a[192:195], v[116:119], a[0:3]
    ds_read_b64_tr_b16 a[208:209], v5 offset:16384
    v_add_f32 v61, v61, v102
    v_mfma_f32_16x16x32_bf16 a[4:7], a[192:195], v[180:183], a[4:7]
    ds_read_b64_tr_b16 a[210:211], v5 offset:24576
    v_mfma_f32_16x16x32_bf16 a[8:11], a[192:195], v[244:247], a[8:11]
    s_waitcnt lgkmcnt(6)
    v_exp_f32 v103, v87
    v_mfma_f32_16x16x32_bf16 a[20:23], a[196:199], v[244:247], a[20:23]
    ds_read_b64_tr_b16 a[212:213], v6 offset:16384
    v_add_f32 v61, v61, v103
    v_mfma_f32_16x16x32_bf16 a[16:19], a[196:199], v[180:183], a[16:19]
    ds_read_b64_tr_b16 a[214:215], v6 offset:24576
    v_mfma_f32_16x16x32_bf16 a[12:15], a[196:199], v[116:119], a[12:15]
    s_waitcnt lgkmcnt(6)
    v_exp_f32 v236, v220
    v_mfma_f32_16x16x32_bf16 a[24:27], a[200:203], v[116:119], a[24:27]
    ds_read_b64_tr_b16 a[216:217], v7 offset:16384
    v_add_f32 v63, v63, v236
    v_mfma_f32_16x16x32_bf16 a[28:31], a[200:203], v[180:183], a[28:31]
    ds_read_b64_tr_b16 a[218:219], v7 offset:24576
    v_mfma_f32_16x16x32_bf16 a[32:35], a[200:203], v[244:247], a[32:35]
    s_waitcnt lgkmcnt(6)
    v_exp_f32 v237, v221
    v_mfma_f32_16x16x32_bf16 a[44:47], a[204:207], v[244:247], a[44:47]
    ds_read_b64_tr_b16 a[220:221], v8 offset:16384
    v_add_f32 v63, v63, v237
    v_mfma_f32_16x16x32_bf16 a[40:43], a[204:207], v[180:183], a[40:43]
    s_add_u32 m0, s28, 147456
    ds_read_b64_tr_b16 a[222:223], v8 offset:24576
    v_mfma_f32_16x16x32_bf16 a[36:39], a[204:207], v[116:119], a[36:39]
    s_waitcnt lgkmcnt(6)
    s_add_u32 s29, s88, s95
    v_mfma_f32_16x16x32_bf16 a[48:51], a[208:211], v[116:119], a[48:51]
    ds_read_b64_tr_b16 a[224:225], v1 offset:16640
    buffer_load_dwordx4 v53, s[20:23], s29 offen lds
    v_mfma_f32_16x16x32_bf16 a[52:55], a[208:211], v[180:183], a[52:55]
    ds_read_b64_tr_b16 a[226:227], v1 offset:24832
    v_mfma_f32_16x16x32_bf16 a[56:59], a[208:211], v[244:247], a[56:59]
    s_waitcnt lgkmcnt(6)
    v_exp_f32 v238, v222
    v_mfma_f32_16x16x32_bf16 a[68:71], a[212:215], v[244:247], a[68:71]
    ds_read_b64_tr_b16 a[228:229], v2 offset:16640
    buffer_load_dwordx4 v54, s[20:23], s29 offen offset:1024 lds
    v_mfma_f32_16x16x32_bf16 a[64:67], a[212:215], v[180:183], a[64:67]
    ds_read_b64_tr_b16 a[230:231], v2 offset:24832
    v_add_f32 v63, v63, v238
    v_mfma_f32_16x16x32_bf16 a[60:63], a[212:215], v[116:119], a[60:63]
    s_waitcnt lgkmcnt(6)
    v_exp_f32 v239, v223
    v_mfma_f32_16x16x32_bf16 a[72:75], a[216:219], v[116:119], a[72:75]
    ds_read_b64_tr_b16 a[232:233], v3 offset:16640
    buffer_load_dwordx4 v55, s[20:23], s29 offen offset:2048 lds
    v_mfma_f32_16x16x32_bf16 a[76:79], a[216:219], v[180:183], a[76:79]
    ds_read_b64_tr_b16 a[234:235], v3 offset:24832
    v_add_f32 v63, v63, v239
    v_mfma_f32_16x16x32_bf16 a[80:83], a[216:219], v[244:247], a[80:83]
    s_waitcnt lgkmcnt(6)
    v_exp_f32 v172, v156
    v_mfma_f32_16x16x32_bf16 a[92:95], a[220:223], v[244:247], a[92:95]
    ds_read_b64_tr_b16 a[236:237], v4 offset:16640
    buffer_load_dwordx4 v56, s[20:23], s29 offen offset:3072 lds
    v_mfma_f32_16x16x32_bf16 a[88:91], a[220:223], v[180:183], a[88:91]
    ds_read_b64_tr_b16 a[238:239], v4 offset:24832
    v_add_f32 v62, v62, v172
    v_mfma_f32_16x16x32_bf16 a[84:87], a[220:223], v[116:119], a[84:87]
    s_waitcnt lgkmcnt(6)
    v_exp_f32 v173, v157
    v_mfma_f32_16x16x32_bf16 a[96:99], a[224:227], v[116:119], a[96:99]
    ds_read_b64_tr_b16 a[192:193], v5 offset:16640
    v_add_f32 v62, v62, v173
    v_mfma_f32_16x16x32_bf16 a[100:103], a[224:227], v[180:183], a[100:103]
    ds_read_b64_tr_b16 a[194:195], v5 offset:24832
    v_mfma_f32_16x16x32_bf16 a[104:107], a[224:227], v[244:247], a[104:107]
    s_waitcnt lgkmcnt(6)
    v_exp_f32 v174, v158
    v_mfma_f32_16x16x32_bf16 a[116:119], a[228:231], v[244:247], a[116:119]
    ds_read_b64_tr_b16 a[196:197], v6 offset:16640
    v_add_f32 v62, v62, v174
    v_mfma_f32_16x16x32_bf16 a[112:115], a[228:231], v[180:183], a[112:115]
    ds_read_b64_tr_b16 a[198:199], v6 offset:24832
    v_mfma_f32_16x16x32_bf16 a[108:111], a[228:231], v[116:119], a[108:111]
    s_waitcnt lgkmcnt(6)
    v_exp_f32 v175, v159
    v_mfma_f32_16x16x32_bf16 a[120:123], a[232:235], v[116:119], a[120:123]
    ds_read_b64_tr_b16 a[200:201], v7 offset:16640
    v_add_f32 v62, v62, v175
    v_mfma_f32_16x16x32_bf16 a[124:127], a[232:235], v[180:183], a[124:127]
    ds_read_b64_tr_b16 a[202:203], v7 offset:24832
    v_mfma_f32_16x16x32_bf16 a[128:131], a[232:235], v[244:247], a[128:131]
    s_waitcnt lgkmcnt(6)
    v_exp_f32 v108, v92
    v_mfma_f32_16x16x32_bf16 a[140:143], a[236:239], v[244:247], a[140:143]
    ds_read_b64_tr_b16 a[204:205], v8 offset:16640
    v_add_f32 v61, v61, v108
    v_mfma_f32_16x16x32_bf16 a[136:139], a[236:239], v[180:183], a[136:139]
    ds_read_b64_tr_b16 a[206:207], v8 offset:24832
    v_mfma_f32_16x16x32_bf16 a[132:135], a[236:239], v[116:119], a[132:135]
    s_waitcnt lgkmcnt(6)
    s_waitcnt vmcnt(12)
    s_barrier
    v_mfma_f32_16x16x32_bf16 a[144:147], a[192:195], v[116:119], a[144:147]
    ds_read_b128 a[208:211], v29 offset:49152
    v_mfma_f32_16x16x32_bf16 a[148:151], a[192:195], v[180:183], a[148:151]
    v_exp_f32 v109, v93
    v_mfma_f32_16x16x32_bf16 a[152:155], a[192:195], v[244:247], a[152:155]
    s_waitcnt lgkmcnt(5)
    v_exp_f32 v110, v94
    v_mfma_f32_16x16x32_bf16 a[164:167], a[196:199], v[244:247], a[164:167]
    ds_read_b128 a[212:215], v30 offset:49152
    v_add_f32 v61, v61, v109
    v_mfma_f32_16x16x32_bf16 a[160:163], a[196:199], v[180:183], a[160:163]
    v_exp_f32 v111, v95
    v_mfma_f32_16x16x32_bf16 a[156:159], a[196:199], v[116:119], a[156:159]
    s_waitcnt lgkmcnt(4)
    v_mfma_f32_16x16x32_bf16 a[168:171], a[200:203], v[116:119], a[168:171]
    ds_read_b128 a[216:219], v31 offset:49152
    v_add_f32 v61, v61, v110
    v_mfma_f32_16x16x32_bf16 a[172:175], a[200:203], v[180:183], a[172:175]
    v_mfma_f32_16x16x32_bf16 a[176:179], a[200:203], v[244:247], a[176:179]
    s_waitcnt lgkmcnt(3)
    v_mfma_f32_16x16x32_bf16 a[188:191], a[204:207], v[244:247], a[188:191]
    ds_read_b128 a[220:223], v32 offset:49152
    v_add_f32 v61, v61, v111
    v_mfma_f32_16x16x32_bf16 a[184:187], a[204:207], v[180:183], a[184:187]
    s_add_u32 m0, s28, 32768
    v_max3_f32 v0, v61, v62, v63
    v_cmp_lt_f32 vcc, s35, v0
    v_mfma_f32_16x16x32_bf16 a[180:183], a[204:207], v[116:119], a[180:183]
    s_cbranch_vccnz L_rare14
L_ret14:
    s_waitcnt lgkmcnt(2)
    s_xor_b32 s29, s61, 138240
    v_mfma_f32_16x16x32_bf16 v[84:87], a[208:211], v[64:67], v[124:127]
    ds_read_b128 a[224:227], v29 offset:49408
    buffer_load_dwordx4 v49, s[16:19], s29 offen nt lds
    v_mfma_f32_16x16x32_bf16 v[84:87], a[212:215], v[72:75], v[84:87]
    v_cvt_pk_bf16_f32 v116, v100, v101
    v_cvt_pk_bf16_f32 v117, v102, v103
    v_mfma_f32_16x16x32_bf16 v[148:151], a[212:215], v[136:139], v[188:191]
    v_cvt_pk_bf16_f32 v118, v108, v109
    v_cvt_pk_bf16_f32 v119, v110, v111
    v_mfma_f32_16x16x32_bf16 v[148:151], a[208:211], v[128:131], v[148:151]
    ds_read_b128 a[228:231], v30 offset:49408
    buffer_load_dwordx4 v50, s[16:19], s29 offen offset:1024 nt lds
    v_mfma_f32_16x16x32_bf16 v[212:215], a[208:211], v[192:195], v[252:255]
    v_cvt_pk_bf16_f32 v180, v164, v165
    v_cvt_pk_bf16_f32 v181, v166, v167
    v_mfma_f32_16x16x32_bf16 v[212:215], a[212:215], v[200:203], v[212:215]
    s_waitcnt lgkmcnt(2)
    v_cvt_pk_bf16_f32 v182, v172, v173
    v_cvt_pk_bf16_f32 v183, v174, v175
    v_mfma_f32_16x16x32_bf16 v[212:215], a[216:219], v[208:211], v[212:215]
    ds_read_b128 a[232:235], v31 offset:49408
    buffer_load_dwordx4 v51, s[16:19], s29 offen offset:2048 nt lds
    v_mfma_f32_16x16x32_bf16 v[212:215], a[220:223], v[216:219], v[212:215]
    v_cvt_pk_bf16_f32 v244, v228, v229
    v_cvt_pk_bf16_f32 v245, v230, v231
    v_mfma_f32_16x16x32_bf16 v[148:151], a[220:223], v[152:155], v[148:151]
    v_cvt_pk_bf16_f32 v246, v236, v237
    v_cvt_pk_bf16_f32 v247, v238, v239
    v_mfma_f32_16x16x32_bf16 v[148:151], a[216:219], v[144:147], v[148:151]
    ds_read_b128 a[236:239], v32 offset:49408
    buffer_load_dwordx4 v52, s[16:19], s29 offen offset:3072 nt lds
    v_mfma_f32_16x16x32_bf16 v[84:87], a[216:219], v[80:83], v[84:87]
    v_add_f32 v58, v58, v61
    v_add_f32 v59, v59, v62
    v_mfma_f32_16x16x32_bf16 v[84:87], a[220:223], v[88:91], v[84:87]
    s_waitcnt lgkmcnt(2)
    v_add_f32 v60, v60, v63
    buffer_store_byte v47, v44, s[36:39], s52 offen offset:640 sc1
    v_mfma_f32_16x16x32_bf16 v[84:87], a[224:227], v[96:99], v[84:87]
    ds_read_b128 a[192:195], v29 offset:57344
    v_mfma_f32_16x16x32_bf16 v[84:87], a[228:231], v[104:107], v[84:87]
    v_mfma_f32_16x16x32_bf16 v[148:151], a[228:231], v[168:171], v[148:151]
    v_mfma_f32_16x16x32_bf16 v[148:151], a[224:227], v[160:163], v[148:151]
    ds_read_b128 a[196:199], v30 offset:57344
    v_mfma_f32_16x16x32_bf16 v[212:215], a[224:227], v[224:227], v[212:215]
    v_mfma_f32_16x16x32_bf16 v[212:215], a[228:231], v[232:235], v[212:215]
    s_waitcnt lgkmcnt(2)
    v_mfma_f32_16x16x32_bf16 v[212:215], a[232:235], v[240:243], v[212:215]
    ds_read_b128 a[200:203], v31 offset:57344
    v_mfma_f32_16x16x32_bf16 v[212:215], a[236:239], v[248:251], v[212:215]
    v_mfma_f32_16x16x32_bf16 v[148:151], a[236:239], v[184:187], v[148:151]
    v_mfma_f32_16x16x32_bf16 v[148:151], a[232:235], v[176:179], v[148:151]
    ds_read_b128 a[204:207], v32 offset:57344
    v_mfma_f32_16x16x32_bf16 v[84:87], a[232:235], v[112:115], v[84:87]
    s_add_u32 m0, s28, 65536
    v_mfma_f32_16x16x32_bf16 v[84:87], a[236:239], v[120:123], v[84:87]
    s_waitcnt lgkmcnt(2)
    s_add_u32 s29, s88, s0
    v_mfma_f32_16x16x32_bf16 v[92:95], a[192:195], v[64:67], v[124:127]
    ds_read_b128 a[208:211], v29 offset:57600
    buffer_load_dwordx4 v53, s[20:23], s29 offen lds
    v_mfma_f32_16x16x32_bf16 v[92:95], a[196:199], v[72:75], v[92:95]
    v_exp_f32 v228, v212
    v_mfma_f32_16x16x32_bf16 v[156:159], a[196:199], v[136:139], v[188:191]
    v_exp_f32 v229, v213
    v_mfma_f32_16x16x32_bf16 v[156:159], a[192:195], v[128:131], v[156:159]
    ds_read_b128 a[212:215], v30 offset:57600
    buffer_load_dwordx4 v54, s[20:23], s29 offen offset:1024 lds
    v_mfma_f32_16x16x32_bf16 v[220:223], a[192:195], v[192:195], v[252:255]
    v_exp_f32 v230, v214
    v_mfma_f32_16x16x32_bf16 v[220:223], a[196:199], v[200:203], v[220:223]
    s_waitcnt lgkmcnt(2)
    v_exp_f32 v231, v215
    v_mfma_f32_16x16x32_bf16 v[220:223], a[200:203], v[208:211], v[220:223]
    ds_read_b128 a[216:219], v31 offset:57600
    buffer_load_dwordx4 v55, s[20:23], s29 offen offset:2048 lds
    v_mfma_f32_16x16x32_bf16 v[220:223], a[204:207], v[216:219], v[220:223]
    v_exp_f32 v164, v148
    v_mfma_f32_16x16x32_bf16 v[156:159], a[204:207], v[152:155], v[156:159]
    v_exp_f32 v165, v149
    v_mfma_f32_16x16x32_bf16 v[156:159], a[200:203], v[144:147], v[156:159]
    ds_read_b128 a[220:223], v32 offset:57600
    buffer_load_dwordx4 v56, s[20:23], s29 offen offset:3072 lds
    v_mfma_f32_16x16x32_bf16 v[92:95], a[200:203], v[80:83], v[92:95]
    v_exp_f32 v166, v150
    v_mfma_f32_16x16x32_bf16 v[92:95], a[204:207], v[88:91], v[92:95]
    s_waitcnt lgkmcnt(2)
    s_waitcnt vmcnt(13)
    s_barrier
    v_mfma_f32_16x16x32_bf16 v[92:95], a[208:211], v[96:99], v[92:95]
    ds_read_b64_tr_b16 a[224:225], v1 offset:0
    v_add_f32 v62, v164, v165
    v_mfma_f32_16x16x32_bf16 v[92:95], a[212:215], v[104:107], v[92:95]
    ds_read_b64_tr_b16 a[226:227], v1 offset:8192
    v_add_f32 v62, v62, v166
    v_mfma_f32_16x16x32_bf16 v[156:159], a[212:215], v[168:171], v[156:159]
    v_exp_f32 v167, v151
    v_mfma_f32_16x16x32_bf16 v[156:159], a[208:211], v[160:163], v[156:159]
    ds_read_b64_tr_b16 a[228:229], v2 offset:0
    v_add_f32 v62, v62, v167
    v_mfma_f32_16x16x32_bf16 v[220:223], a[208:211], v[224:227], v[220:223]
    ds_read_b64_tr_b16 a[230:231], v2 offset:8192
    v_add_f32 v63, v228, v229
    v_mfma_f32_16x16x32_bf16 v[220:223], a[212:215], v[232:235], v[220:223]
    s_waitcnt lgkmcnt(4)
    v_exp_f32 v100, v84
    v_mfma_f32_16x16x32_bf16 v[220:223], a[216:219], v[240:243], v[220:223]
    ds_read_b64_tr_b16 a[232:233], v3 offset:0
    v_add_f32 v63, v63, v230
    v_mfma_f32_16x16x32_bf16 v[220:223], a[220:223], v[248:251], v[220:223]
    s_add_u32 m0, s28, 98304
    ds_read_b64_tr_b16 a[234:235], v3 offset:8192
    v_add_f32 v63, v63, v231
    v_mfma_f32_16x16x32_bf16 v[156:159], a[220:223], v[184:187], v[156:159]
    s_add_u32 s29, s89, s93
    v_exp_f32 v101, v85
    v_mfma_f32_16x16x32_bf16 v[156:159], a[216:219], v[176:179], v[156:159]
    ds_read_b64_tr_b16 a[236:237], v4 offset:0
    buffer_load_dwordx4 v53, s[20:23], s29 offen lds
    v_mfma_f32_16x16x32_bf16 v[92:95], a[216:219], v[112:115], v[92:95]
    ds_read_b64_tr_b16 a[238:239], v4 offset:8192
    v_add_f32 v61, v100, v101
    v_mfma_f32_16x16x32_bf16 v[92:95], a[220:223], v[120:123], v[92:95]
    s_waitcnt lgkmcnt(6)
    v_exp_f32 v102, v86
    v_mfma_f32_16x16x32_bf16 a[0:3], a[224:227], v[116:119], a[0:3]
    ds_read_b64_tr_b16 a[192:193], v5 offset:0
    buffer_load_dwordx4 v54, s[20:23], s29 offen offset:1024 lds
    v_mfma_f32_16x16x32_bf16 a[4:7], a[224:227], v[180:183], a[4:7]
    ds_read_b64_tr_b16 a[194:195], v5 offset:8192
    v_add_f32 v61, v61, v102
    v_mfma_f32_16x16x32_bf16 a[8:11], a[224:227], v[244:247], a[8:11]
    s_waitcnt lgkmcnt(6)
    v_exp_f32 v103, v87
    v_mfma_f32_16x16x32_bf16 a[20:23], a[228:231], v[244:247], a[20:23]
    ds_read_b64_tr_b16 a[196:197], v6 offset:0
    buffer_load_dwordx4 v55, s[20:23], s29 offen offset:2048 lds
    v_mfma_f32_16x16x32_bf16 a[16:19], a[228:231], v[180:183], a[16:19]
    ds_read_b64_tr_b16 a[198:199], v6 offset:8192
    v_add_f32 v61, v61, v103
    v_mfma_f32_16x16x32_bf16 a[12:15], a[228:231], v[116:119], a[12:15]
    s_waitcnt lgkmcnt(6)
    v_exp_f32 v236, v220
    v_mfma_f32_16x16x32_bf16 a[24:27], a[232:235], v[116:119], a[24:27]
    ds_read_b64_tr_b16 a[200:201], v7 offset:0
    buffer_load_dwordx4 v56, s[20:23], s29 offen offset:3072 lds
    v_mfma_f32_16x16x32_bf16 a[28:31], a[232:235], v[180:183], a[28:31]
    ds_read_b64_tr_b16 a[202:203], v7 offset:8192
    v_add_f32 v63, v63, v236
    v_mfma_f32_16x16x32_bf16 a[32:35], a[232:235], v[244:247], a[32:35]
    s_waitcnt lgkmcnt(6)
    v_exp_f32 v237, v221
    v_mfma_f32_16x16x32_bf16 a[44:47], a[236:239], v[244:247], a[44:47]
    ds_read_b64_tr_b16 a[204:205], v8 offset:0
    v_add_f32 v63, v63, v237
    v_mfma_f32_16x16x32_bf16 a[40:43], a[236:239], v[180:183], a[40:43]
    ds_read_b64_tr_b16 a[206:207], v8 offset:8192
    v_mfma_f32_16x16x32_bf16 a[36:39], a[236:239], v[116:119], a[36:39]
    s_waitcnt lgkmcnt(6)
    v_exp_f32 v238, v222
    v_mfma_f32_16x16x32_bf16 a[48:51], a[192:195], v[116:119], a[48:51]
    ds_read_b64_tr_b16 a[208:209], v1 offset:256
    v_add_f32 v63, v63, v238
    v_mfma_f32_16x16x32_bf16 a[52:55], a[192:195], v[180:183], a[52:55]
    s_add_u32 m0, s28, 131072
    ds_read_b64_tr_b16 a[210:211], v1 offset:8448
    v_mfma_f32_16x16x32_bf16 a[56:59], a[192:195], v[244:247], a[56:59]
    s_waitcnt lgkmcnt(6)
    s_add_u32 s29, s90, s93
    v_mfma_f32_16x16x32_bf16 a[68:71], a[196:199], v[244:247], a[68:71]
    ds_read_b64_tr_b16 a[212:213], v2 offset:256
    buffer_load_dwordx4 v53, s[20:23], s29 offen lds
    v_mfma_f32_16x16x32_bf16 a[64:67], a[196:199], v[180:183], a[64:67]
    ds_read_b64_tr_b16 a[214:215], v2 offset:8448
    v_mfma_f32_16x16x32_bf16 a[60:63], a[196:199], v[116:119], a[60:63]
    s_waitcnt lgkmcnt(6)
    v_exp_f32 v239, v223
    v_mfma_f32_16x16x32_bf16 a[72:75], a[200:203], v[116:119], a[72:75]
    ds_read_b64_tr_b16 a[216:217], v3 offset:256
    buffer_load_dwordx4 v54, s[20:23], s29 offen offset:1024 lds
    v_mfma_f32_16x16x32_bf16 a[76:79], a[200:203], v[180:183], a[76:79]
    ds_read_b64_tr_b16 a[218:219], v3 offset:8448
    v_add_f32 v63, v63, v239
    v_mfma_f32_16x16x32_bf16 a[80:83], a[200:203], v[244:247], a[80:83]
    s_waitcnt lgkmcnt(6)
    v_exp_f32 v172, v156
    v_mfma_f32_16x16x32_bf16 a[92:95], a[204:207], v[244:247], a[92:95]
    ds_read_b64_tr_b16 a[220:221], v4 offset:256
    buffer_load_dwordx4 v55, s[20:23], s29 offen offset:2048 lds
    v_mfma_f32_16x16x32_bf16 a[88:91], a[204:207], v[180:183], a[88:91]
    ds_read_b64_tr_b16 a[222:223], v4 offset:8448
    v_add_f32 v62, v62, v172
    v_mfma_f32_16x16x32_bf16 a[84:87], a[204:207], v[116:119], a[84:87]
    s_waitcnt lgkmcnt(6)
    v_exp_f32 v173, v157
    v_mfma_f32_16x16x32_bf16 a[96:99], a[208:211], v[116:119], a[96:99]
    ds_read_b64_tr_b16 a[224:225], v5 offset:256
    buffer_load_dwordx4 v56, s[20:23], s29 offen offset:3072 lds
    v_mfma_f32_16x16x32_bf16 a[100:103], a[208:211], v[180:183], a[100:103]
    ds_read_b64_tr_b16 a[226:227], v5 offset:8448
    v_add_f32 v62, v62, v173
    v_mfma_f32_16x16x32_bf16 a[104:107], a[208:211], v[244:247], a[104:107]
    s_waitcnt lgkmcnt(6)
    v_exp_f32 v174, v158
    v_mfma_f32_16x16x32_bf16 a[116:119], a[212:215], v[244:247], a[116:119]
    ds_read_b64_tr_b16 a[228:229], v6 offset:256
    v_add_f32 v62, v62, v174
    v_mfma_f32_16x16x32_bf16 a[112:115], a[212:215], v[180:183], a[112:115]
    ds_read_b64_tr_b16 a[230:231], v6 offset:8448
    v_mfma_f32_16x16x32_bf16 a[108:111], a[212:215], v[116:119], a[108:111]
    s_waitcnt lgkmcnt(6)
    v_exp_f32 v175, v159
    v_mfma_f32_16x16x32_bf16 a[120:123], a[216:219], v[116:119], a[120:123]
    s_load_dwordx4 s[84:87], s[36:37], s63 offset:128 glc
    ds_read_b64_tr_b16 a[232:233], v7 offset:256
    v_add_f32 v62, v62, v175
    v_mfma_f32_16x16x32_bf16 a[124:127], a[216:219], v[180:183], a[124:127]
    ds_read_b64_tr_b16 a[234:235], v7 offset:8448
    v_mfma_f32_16x16x32_bf16 a[128:131], a[216:219], v[244:247], a[128:131]
    s_waitcnt lgkmcnt(6)
    v_exp_f32 v108, v92
    v_mfma_f32_16x16x32_bf16 a[140:143], a[220:223], v[244:247], a[140:143]
    ds_read_b64_tr_b16 a[236:237], v8 offset:256
    v_add_f32 v61, v61, v108
    v_mfma_f32_16x16x32_bf16 a[136:139], a[220:223], v[180:183], a[136:139]
    s_add_u32 m0, s28, 16384
    ds_read_b64_tr_b16 a[238:239], v8 offset:8448
    v_mfma_f32_16x16x32_bf16 a[132:135], a[220:223], v[116:119], a[132:135]
    s_waitcnt lgkmcnt(6)
    s_waitcnt vmcnt(13)
    s_add_u32 s29, s92, s93
    s_barrier
    v_mfma_f32_16x16x32_bf16 a[144:147], a[224:227], v[116:119], a[144:147]
    ds_read_b64_tr_b16 a[192:193], v1 offset:32768
    buffer_load_dwordx4 v53, s[20:23], s29 offen lds
    v_mfma_f32_16x16x32_bf16 a[148:151], a[224:227], v[180:183], a[148:151]
    ds_read_b64_tr_b16 a[194:195], v1 offset:40960
    v_mfma_f32_16x16x32_bf16 a[152:155], a[224:227], v[244:247], a[152:155]
    s_waitcnt lgkmcnt(6)
    v_exp_f32 v109, v93
    v_mfma_f32_16x16x32_bf16 a[164:167], a[228:231], v[244:247], a[164:167]
    ds_read_b64_tr_b16 a[196:197], v2 offset:32768
    buffer_load_dwordx4 v54, s[20:23], s29 offen offset:1024 lds
    v_mfma_f32_16x16x32_bf16 a[160:163], a[228:231], v[180:183], a[160:163]
    ds_read_b64_tr_b16 a[198:199], v2 offset:40960
    v_add_f32 v61, v61, v109
    v_mfma_f32_16x16x32_bf16 a[156:159], a[228:231], v[116:119], a[156:159]
    s_waitcnt lgkmcnt(6)
    v_exp_f32 v110, v94
    v_mfma_f32_16x16x32_bf16 a[168:171], a[232:235], v[116:119], a[168:171]
    ds_read_b64_tr_b16 a[200:201], v3 offset:32768
    buffer_load_dwordx4 v55, s[20:23], s29 offen offset:2048 lds
    v_mfma_f32_16x16x32_bf16 a[172:175], a[232:235], v[180:183], a[172:175]
    ds_read_b64_tr_b16 a[202:203], v3 offset:40960
    v_add_f32 v61, v61, v110
    v_mfma_f32_16x16x32_bf16 a[176:179], a[232:235], v[244:247], a[176:179]
    s_waitcnt lgkmcnt(6)
    v_exp_f32 v111, v95
    v_mfma_f32_16x16x32_bf16 a[188:191], a[236:239], v[244:247], a[188:191]
    ds_read_b64_tr_b16 a[204:205], v4 offset:32768
    buffer_load_dwordx4 v56, s[20:23], s29 offen offset:3072 lds
    v_add_f32 v61, v61, v111
    v_mfma_f32_16x16x32_bf16 a[184:187], a[236:239], v[180:183], a[184:187]
    ds_read_b64_tr_b16 a[206:207], v4 offset:40960
    v_max3_f32 v0, v61, v62, v63
    v_cmp_lt_f32 vcc, s35, v0
    v_mfma_f32_16x16x32_bf16 a[180:183], a[236:239], v[116:119], a[180:183]
    s_cbranch_vccnz L_rare15
L_ret15:
    s_waitcnt lgkmcnt(6)
    v_cvt_pk_bf16_f32 v116, v100, v101
    v_cvt_pk_bf16_f32 v117, v102, v103
    v_cvt_pk_bf16_f32 v118, v108, v109
    v_cvt_pk_bf16_f32 v119, v110, v111
    v_cvt_pk_bf16_f32 v180, v164, v165
    v_cvt_pk_bf16_f32 v181, v166, v167
    v_cvt_pk_bf16_f32 v182, v172, v173
    v_cvt_pk_bf16_f32 v183, v174, v175
    v_cvt_pk_bf16_f32 v244, v228, v229
    v_cvt_pk_bf16_f32 v245, v230, v231
    v_cvt_pk_bf16_f32 v246, v236, v237
    v_cvt_pk_bf16_f32 v247, v238, v239
    v_mfma_f32_16x16x32_bf16 a[0:3], a[192:195], v[116:119], a[0:3]
    ds_read_b64_tr_b16 a[208:209], v5 offset:32768
    v_add_f32 v58, v58, v61
    v_mfma_f32_16x16x32_bf16 a[4:7], a[192:195], v[180:183], a[4:7]
    ds_read_b64_tr_b16 a[210:211], v5 offset:40960
    v_add_f32 v59, v59, v62
    v_mfma_f32_16x16x32_bf16 a[8:11], a[192:195], v[244:247], a[8:11]
    s_waitcnt lgkmcnt(6)
    v_add_f32 v60, v60, v63
    v_mov_b32 v61, v58
    v_mfma_f32_16x16x32_bf16 a[20:23], a[196:199], v[244:247], a[20:23]
    ds_read_b64_tr_b16 a[212:213], v6 offset:32768
    v_mov_b32 v62, v59
    v_mfma_f32_16x16x32_bf16 a[16:19], a[196:199], v[180:183], a[16:19]
    ds_read_b64_tr_b16 a[214:215], v6 offset:40960
    v_mov_b32 v63, v60
    v_mfma_f32_16x16x32_bf16 a[12:15], a[196:199], v[116:119], a[12:15]
    s_waitcnt lgkmcnt(6)
    v_permlane32_swap_b32 v58, v61
    v_mfma_f32_16x16x32_bf16 a[24:27], a[200:203], v[116:119], a[24:27]
    ds_read_b64_tr_b16 a[216:217], v7 offset:32768
    v_mfma_f32_16x16x32_bf16 a[28:31], a[200:203], v[180:183], a[28:31]
    ds_read_b64_tr_b16 a[218:219], v7 offset:40960
    v_mfma_f32_16x16x32_bf16 a[32:35], a[200:203], v[244:247], a[32:35]
    s_waitcnt lgkmcnt(6)
    v_permlane32_swap_b32 v59, v62
    v_permlane32_swap_b32 v60, v63
    v_add_f32 v58, v58, v61
    v_add_f32 v59, v59, v62
    v_add_f32 v60, v60, v63
    v_mov_b32 v61, v58
    v_mov_b32 v62, v59
    v_mov_b32 v63, v60
    v_permlane16_swap_b32 v58, v61
    v_permlane16_swap_b32 v59, v62
    v_permlane16_swap_b32 v60, v63
    v_add_f32 v58, v58, v61
    v_add_f32 v59, v59, v62
    v_add_f32 v60, v60, v63
    v_rcp_f32 v58, v58
    v_rcp_f32 v59, v59
    v_rcp_f32 v60, v60
    v_mfma_f32_16x16x32_bf16 a[44:47], a[204:207], v[244:247], a[44:47]
    s_add_u32 m0, s28, 114688
    ds_read_b64_tr_b16 a[220:221], v8 offset:32768
    v_mfma_f32_16x16x32_bf16 a[40:43], a[204:207], v[180:183], a[40:43]
    s_add_u32 s29, s89, s94
    ds_read_b64_tr_b16 a[222:223], v8 offset:40960
    v_mfma_f32_16x16x32_bf16 a[36:39], a[204:207], v[116:119], a[36:39]
    s_waitcnt lgkmcnt(6)
    buffer_load_dwordx4 v53, s[20:23], s29 offen lds
    v_mfma_f32_16x16x32_bf16 a[48:51], a[208:211], v[116:119], a[48:51]
    ds_read_b64_tr_b16 a[224:225], v1 offset:33024
    v_mfma_f32_16x16x32_bf16 a[52:55], a[208:211], v[180:183], a[52:55]
    ds_read_b64_tr_b16 a[226:227], v1 offset:41216
    v_mfma_f32_16x16x32_bf16 a[56:59], a[208:211], v[244:247], a[56:59]
    s_waitcnt lgkmcnt(6)
    buffer_load_dwordx4 v54, s[20:23], s29 offen offset:1024 lds
    v_mfma_f32_16x16x32_bf16 a[68:71], a[212:215], v[244:247], a[68:71]
    ds_read_b64_tr_b16 a[228:229], v2 offset:33024
    v_mfma_f32_16x16x32_bf16 a[64:67], a[212:215], v[180:183], a[64:67]
    ds_read_b64_tr_b16 a[230:231], v2 offset:41216
    v_mfma_f32_16x16x32_bf16 a[60:63], a[212:215], v[116:119], a[60:63]
    s_waitcnt lgkmcnt(6)
    buffer_load_dwordx4 v55, s[20:23], s29 offen offset:2048 lds
    v_accvgpr_read_b32 v36, a0
    v_accvgpr_read_b32 v37, a1
    v_accvgpr_read_b32 v38, a2
    v_accvgpr_read_b32 v39, a3
    v_accvgpr_read_b32 v40, a12
    v_accvgpr_read_b32 v41, a13
    v_accvgpr_read_b32 v42, a14
    v_accvgpr_read_b32 v43, a15
    v_pk_mul_f32 v[36:37], v[36:37], v[58:59] op_sel_hi:[1,0]
    v_pk_mul_f32 v[38:39], v[38:39], v[58:59] op_sel_hi:[1,0]
    v_pk_mul_f32 v[40:41], v[40:41], v[58:59] op_sel_hi:[1,0]
    v_pk_mul_f32 v[42:43], v[42:43], v[58:59] op_sel_hi:[1,0]
    v_cvt_pk_bf16_f32 v64, v36, v37
    v_cvt_pk_bf16_f32 v65, v38, v39
    v_cvt_pk_bf16_f32 v66, v40, v41
    v_cvt_pk_bf16_f32 v67, v42, v43
    s_min_u32 s33, s84, s85
    s_min_u32 s33, s33, s86
    s_min_u32 s33, s33, s87
    s_cmp_eq_u32 s33, 16843009
    s_cbranch_scc0 L_gd_spin
L_gd_ok:
    s_mov_b64 s[84:85], 0
    s_mov_b64 s[86:87], 0
    v_mfma_f32_16x16x32_bf16 a[72:75], a[216:219], v[116:119], a[72:75]
    s_add_u32 s3, s88, 0
    ds_read_b64_tr_b16 a[232:233], v3 offset:33024
    v_accvgpr_read_b32 v28, a4
    v_accvgpr_read_b32 v29, a5
    v_accvgpr_read_b32 v30, a6
    v_accvgpr_read_b32 v31, a7
    v_accvgpr_read_b32 v32, a16
    v_accvgpr_read_b32 v33, a17
    v_accvgpr_read_b32 v34, a18
    v_accvgpr_read_b32 v35, a19
    v_pk_mul_f32 v[28:29], v[28:29], v[58:59] op_sel:[0,1] op_sel_hi:[1,1]
    v_pk_mul_f32 v[30:31], v[30:31], v[58:59] op_sel:[0,1] op_sel_hi:[1,1]
    v_pk_mul_f32 v[32:33], v[32:33], v[58:59] op_sel:[0,1] op_sel_hi:[1,1]
    v_pk_mul_f32 v[34:35], v[34:35], v[58:59] op_sel:[0,1] op_sel_hi:[1,1]
    v_cvt_pk_bf16_f32 v128, v28, v29
    v_cvt_pk_bf16_f32 v129, v30, v31
    v_cvt_pk_bf16_f32 v130, v32, v33
    v_cvt_pk_bf16_f32 v131, v34, v35
    v_mfma_f32_16x16x32_bf16 a[76:79], a[216:219], v[180:183], a[76:79]
    ds_read_b64_tr_b16 a[234:235], v3 offset:41216
    v_accvgpr_read_b32 v36, a8
    v_accvgpr_read_b32 v37, a9
    v_accvgpr_read_b32 v38, a10
    v_accvgpr_read_b32 v39, a11
    v_accvgpr_read_b32 v40, a20
    v_accvgpr_read_b32 v41, a21
    v_accvgpr_read_b32 v42, a22
    v_accvgpr_read_b32 v43, a23
    v_pk_mul_f32 v[36:37], v[36:37], v[60:61] op_sel_hi:[1,0]
    v_pk_mul_f32 v[38:39], v[38:39], v[60:61] op_sel_hi:[1,0]
    v_pk_mul_f32 v[40:41], v[40:41], v[60:61] op_sel_hi:[1,0]
    v_pk_mul_f32 v[42:43], v[42:43], v[60:61] op_sel_hi:[1,0]
    v_cvt_pk_bf16_f32 v192, v36, v37
    v_cvt_pk_bf16_f32 v193, v38, v39
    v_cvt_pk_bf16_f32 v194, v40, v41
    v_cvt_pk_bf16_f32 v195, v42, v43
    v_mfma_f32_16x16x32_bf16 a[80:83], a[216:219], v[244:247], a[80:83]
    s_waitcnt lgkmcnt(6)
    buffer_load_dwordx4 v56, s[20:23], s29 offen offset:3072 lds
    buffer_store_dwordx4 v[64:67], v45, s[24:27], s3 offen sc1
    v_mfma_f32_16x16x32_bf16 a[92:95], a[220:223], v[244:247], a[92:95]
    ds_read_b64_tr_b16 a[236:237], v4 offset:33024
    buffer_store_dwordx4 v[128:131], v45, s[24:27], s3 offen offset:1024 sc1
    v_mfma_f32_16x16x32_bf16 a[88:91], a[220:223], v[180:183], a[88:91]
    ds_read_b64_tr_b16 a[238:239], v4 offset:41216
    buffer_store_dwordx4 v[192:195], v45, s[24:27], s3 offen offset:2048 sc1
    v_mfma_f32_16x16x32_bf16 a[84:87], a[220:223], v[116:119], a[84:87]
    s_waitcnt lgkmcnt(6)
    v_mfma_f32_16x16x32_bf16 a[96:99], a[224:227], v[116:119], a[96:99]
    ds_read_b64_tr_b16 a[192:193], v5 offset:33024
    v_mfma_f32_16x16x32_bf16 a[100:103], a[224:227], v[180:183], a[100:103]
    ds_read_b64_tr_b16 a[194:195], v5 offset:41216
    v_mfma_f32_16x16x32_bf16 a[104:107], a[224:227], v[244:247], a[104:107]
    s_waitcnt lgkmcnt(6)
    v_mfma_f32_16x16x32_bf16 a[116:119], a[228:231], v[244:247], a[116:119]
    ds_read_b64_tr_b16 a[196:197], v6 offset:33024
    v_accvgpr_read_b32 v28, a24
    v_accvgpr_read_b32 v29, a25
    v_accvgpr_read_b32 v30, a26
    v_accvgpr_read_b32 v31, a27
    v_accvgpr_read_b32 v32, a36
    v_accvgpr_read_b32 v33, a37
    v_accvgpr_read_b32 v34, a38
    v_accvgpr_read_b32 v35, a39
    v_pk_mul_f32 v[28:29], v[28:29], v[58:59] op_sel_hi:[1,0]
    v_pk_mul_f32 v[30:31], v[30:31], v[58:59] op_sel_hi:[1,0]
    v_pk_mul_f32 v[32:33], v[32:33], v[58:59] op_sel_hi:[1,0]
    v_pk_mul_f32 v[34:35], v[34:35], v[58:59] op_sel_hi:[1,0]
    v_cvt_pk_bf16_f32 v72, v28, v29
    v_cvt_pk_bf16_f32 v73, v30, v31
    v_cvt_pk_bf16_f32 v74, v32, v33
    v_cvt_pk_bf16_f32 v75, v34, v35
    v_mfma_f32_16x16x32_bf16 a[112:115], a[228:231], v[180:183], a[112:115]
    s_add_u32 s3, s88, 3072
    ds_read_b64_tr_b16 a[198:199], v6 offset:41216
    v_accvgpr_read_b32 v36, a28
    v_accvgpr_read_b32 v37, a29
    v_accvgpr_read_b32 v38, a30
    v_accvgpr_read_b32 v39, a31
    v_accvgpr_read_b32 v40, a40
    v_accvgpr_read_b32 v41, a41
    v_accvgpr_read_b32 v42, a42
    v_accvgpr_read_b32 v43, a43
    v_pk_mul_f32 v[36:37], v[36:37], v[58:59] op_sel:[0,1] op_sel_hi:[1,1]
    v_pk_mul_f32 v[38:39], v[38:39], v[58:59] op_sel:[0,1] op_sel_hi:[1,1]
    v_pk_mul_f32 v[40:41], v[40:41], v[58:59] op_sel:[0,1] op_sel_hi:[1,1]
    v_pk_mul_f32 v[42:43], v[42:43], v[58:59] op_sel:[0,1] op_sel_hi:[1,1]
    v_cvt_pk_bf16_f32 v136, v36, v37
    v_cvt_pk_bf16_f32 v137, v38, v39
    v_cvt_pk_bf16_f32 v138, v40, v41
    v_cvt_pk_bf16_f32 v139, v42, v43
    v_mfma_f32_16x16x32_bf16 a[108:111], a[228:231], v[116:119], a[108:111]
    s_waitcnt lgkmcnt(6)
    v_accvgpr_read_b32 v28, a32
    v_accvgpr_read_b32 v29, a33
    v_accvgpr_read_b32 v30, a34
    v_accvgpr_read_b32 v31, a35
    v_accvgpr_read_b32 v32, a44
    v_accvgpr_read_b32 v33, a45
    v_accvgpr_read_b32 v34, a46
    v_accvgpr_read_b32 v35, a47
    v_pk_mul_f32 v[28:29], v[28:29], v[60:61] op_sel_hi:[1,0]
    v_pk_mul_f32 v[30:31], v[30:31], v[60:61] op_sel_hi:[1,0]
    v_pk_mul_f32 v[32:33], v[32:33], v[60:61] op_sel_hi:[1,0]
    v_pk_mul_f32 v[34:35], v[34:35], v[60:61] op_sel_hi:[1,0]
    v_cvt_pk_bf16_f32 v200, v28, v29
    v_cvt_pk_bf16_f32 v201, v30, v31
    v_cvt_pk_bf16_f32 v202, v32, v33
    v_cvt_pk_bf16_f32 v203, v34, v35
    v_mfma_f32_16x16x32_bf16 a[120:123], a[232:235], v[116:119], a[120:123]
    ds_read_b64_tr_b16 a[200:201], v7 offset:33024
    v_accvgpr_read_b32 v36, a48
    buffer_store_dwordx4 v[72:75], v45, s[24:27], s3 offen sc1
    v_mfma_f32_16x16x32_bf16 a[124:127], a[232:235], v[180:183], a[124:127]
    ds_read_b64_tr_b16 a[202:203], v7 offset:41216
    v_accvgpr_read_b32 v37, a49
    v_mfma_f32_16x16x32_bf16 a[128:131], a[232:235], v[244:247], a[128:131]
    s_waitcnt lgkmcnt(6)
    v_accvgpr_read_b32 v38, a50
    v_accvgpr_read_b32 v39, a51
    buffer_store_dwordx4 v[136:139], v45, s[24:27], s3 offen offset:1024 sc1
    v_mfma_f32_16x16x32_bf16 a[140:143], a[236:239], v[244:247], a[140:143]
    ds_read_b64_tr_b16 a[204:205], v8 offset:33024
    v_accvgpr_read_b32 v40, a60
    v_mfma_f32_16x16x32_bf16 a[136:139], a[236:239], v[180:183], a[136:139]
    ds_read_b64_tr_b16 a[206:207], v8 offset:41216
    v_accvgpr_read_b32 v41, a61
    buffer_store_dwordx4 v[200:203], v45, s[24:27], s3 offen offset:2048 sc1
    v_mfma_f32_16x16x32_bf16 a[132:135], a[236:239], v[116:119], a[132:135]
    s_waitcnt lgkmcnt(6)
    s_waitcnt vmcnt(47)
    s_barrier
    v_mfma_f32_16x16x32_bf16 a[144:147], a[192:195], v[116:119], a[144:147]
    ds_read_b64_tr_b16 a[208:209], v1 offset:49152
    v_accvgpr_read_b32 v42, a62
    v_mfma_f32_16x16x32_bf16 a[148:151], a[192:195], v[180:183], a[148:151]
    ds_read_b64_tr_b16 a[210:211], v1 offset:57344
    v_accvgpr_read_b32 v43, a63
    v_mfma_f32_16x16x32_bf16 a[152:155], a[192:195], v[244:247], a[152:155]
    s_waitcnt lgkmcnt(6)
    v_mul_f32 v36, v58, v36
    v_mul_f32 v37, v58, v37
    v_mfma_f32_16x16x32_bf16 a[164:167], a[196:199], v[244:247], a[164:167]
    ds_read_b64_tr_b16 a[212:213], v1 offset:49408
    v_mul_f32 v38, v58, v38
    v_mfma_f32_16x16x32_bf16 a[160:163], a[196:199], v[180:183], a[160:163]
    ds_read_b64_tr_b16 a[214:215], v1 offset:57600
    v_mul_f32 v39, v58, v39
    v_mfma_f32_16x16x32_bf16 a[156:159], a[196:199], v[116:119], a[156:159]
    s_waitcnt lgkmcnt(6)
    v_mul_f32 v40, v58, v40
    v_mul_f32 v41, v58, v41
    v_mfma_f32_16x16x32_bf16 a[168:171], a[200:203], v[116:119], a[168:171]
    s_add_u32 m0, s28, 0
    ds_read_b64_tr_b16 a[216:217], v2 offset:49152
    v_mul_f32 v42, v58, v42
    v_mfma_f32_16x16x32_bf16 a[172:175], a[200:203], v[180:183], a[172:175]
    s_add_u32 s29, s90, s94
    ds_read_b64_tr_b16 a[218:219], v2 offset:57344
    v_mul_f32 v43, v58, v43
    v_mfma_f32_16x16x32_bf16 a[176:179], a[200:203], v[244:247], a[176:179]
    s_waitcnt lgkmcnt(6)
    buffer_load_dwordx4 v53, s[20:23], s29 offen lds
    v_cvt_pk_bf16_f32 v80, v36, v37
    v_mfma_f32_16x16x32_bf16 a[188:191], a[204:207], v[244:247], a[188:191]
    ds_read_b64_tr_b16 a[220:221], v2 offset:49408
    v_cvt_pk_bf16_f32 v81, v38, v39
    v_mfma_f32_16x16x32_bf16 a[184:187], a[204:207], v[180:183], a[184:187]
    ds_read_b64_tr_b16 a[222:223], v2 offset:57600
    v_cvt_pk_bf16_f32 v82, v40, v41
    v_mfma_f32_16x16x32_bf16 a[180:183], a[204:207], v[116:119], a[180:183]
    s_waitcnt lgkmcnt(4)
    buffer_load_dwordx4 v54, s[20:23], s29 offen offset:1024 lds
    v_cvt_pk_bf16_f32 v83, v42, v43
    v_mfma_f32_16x16x32_bf16 v[68:71], a[208:211], v[64:67], 0
    ds_read_b64_tr_b16 a[224:225], v3 offset:49152
    v_accvgpr_read_b32 v28, a52
    v_mfma_f32_16x16x32_bf16 v[68:71], a[212:215], v[72:75], v[68:71]
    ds_read_b64_tr_b16 a[226:227], v3 offset:57344
    v_accvgpr_read_b32 v29, a53
    v_mfma_f32_16x16x32_bf16 v[132:135], a[212:215], v[136:139], 0
    buffer_load_dwordx4 v55, s[20:23], s29 offen offset:2048 lds
    v_accvgpr_read_b32 v30, a54
    v_mfma_f32_16x16x32_bf16 v[132:135], a[208:211], v[128:131], v[132:135]
    ds_read_b64_tr_b16 a[228:229], v3 offset:49408
    v_accvgpr_read_b32 v31, a55
    v_mfma_f32_16x16x32_bf16 v[196:199], a[208:211], v[192:195], 0
    ds_read_b64_tr_b16 a[230:231], v3 offset:57600
    v_accvgpr_read_b32 v32, a64
    v_mfma_f32_16x16x32_bf16 v[196:199], a[212:215], v[200:203], v[196:199]
    s_waitcnt lgkmcnt(4)
    buffer_load_dwordx4 v56, s[20:23], s29 offen offset:3072 lds
    v_accvgpr_read_b32 v33, a65
    v_mfma_f32_16x16x32_bf16 v[204:207], a[216:219], v[192:195], 0
    ds_read_b64_tr_b16 a[232:233], v4 offset:49152
    v_accvgpr_read_b32 v34, a66
    v_mfma_f32_16x16x32_bf16 v[204:207], a[220:223], v[200:203], v[204:207]
    ds_read_b64_tr_b16 a[234:235], v4 offset:57344
    v_accvgpr_read_b32 v35, a67
    v_mfma_f32_16x16x32_bf16 v[140:143], a[220:223], v[136:139], 0
    v_mul_f32 v28, v59, v28
    v_mul_f32 v29, v59, v29
    v_mfma_f32_16x16x32_bf16 v[140:143], a[216:219], v[128:131], v[140:143]
    ds_read_b64_tr_b16 a[236:237], v4 offset:49408
    v_mul_f32 v30, v59, v30
    v_mfma_f32_16x16x32_bf16 v[76:79], a[216:219], v[64:67], 0
    ds_read_b64_tr_b16 a[238:239], v4 offset:57600
    v_mul_f32 v31, v59, v31
    v_mfma_f32_16x16x32_bf16 v[76:79], a[220:223], v[72:75], v[76:79]
    s_waitcnt lgkmcnt(4)
    v_mul_f32 v32, v59, v32
    v_mul_f32 v33, v59, v33
    v_mfma_f32_16x16x32_bf16 v[84:87], a[224:227], v[64:67], 0
    ds_read_b64_tr_b16 a[192:193], v5 offset:49152
    v_mul_f32 v34, v59, v34
    v_mfma_f32_16x16x32_bf16 v[84:87], a[228:231], v[72:75], v[84:87]
    ds_read_b64_tr_b16 a[194:195], v5 offset:57344
    v_mul_f32 v35, v59, v35
    v_mfma_f32_16x16x32_bf16 v[148:151], a[228:231], v[136:139], 0
    v_cvt_pk_bf16_f32 v144, v28, v29
    v_cvt_pk_bf16_f32 v145, v30, v31
    v_mfma_f32_16x16x32_bf16 v[148:151], a[224:227], v[128:131], v[148:151]
    ds_read_b64_tr_b16 a[196:197], v5 offset:49408
    v_cvt_pk_bf16_f32 v146, v32, v33
    v_cvt_pk_bf16_f32 v147, v34, v35
    v_mfma_f32_16x16x32_bf16 v[212:215], a[224:227], v[192:195], 0
    s_add_u32 s3, s88, 6144
    ds_read_b64_tr_b16 a[198:199], v5 offset:57600
    v_accvgpr_read_b32 v36, a56
    v_accvgpr_read_b32 v37, a57
    v_accvgpr_read_b32 v38, a58
    v_accvgpr_read_b32 v39, a59
    v_accvgpr_read_b32 v40, a68
    v_accvgpr_read_b32 v41, a69
    v_accvgpr_read_b32 v42, a70
    v_accvgpr_read_b32 v43, a71
    v_pk_mul_f32 v[36:37], v[36:37], v[60:61] op_sel_hi:[1,0]
    v_pk_mul_f32 v[38:39], v[38:39], v[60:61] op_sel_hi:[1,0]
    v_pk_mul_f32 v[40:41], v[40:41], v[60:61] op_sel_hi:[1,0]
    v_pk_mul_f32 v[42:43], v[42:43], v[60:61] op_sel_hi:[1,0]
    v_cvt_pk_bf16_f32 v208, v36, v37
    v_cvt_pk_bf16_f32 v209, v38, v39
    v_cvt_pk_bf16_f32 v210, v40, v41
    v_cvt_pk_bf16_f32 v211, v42, v43
    v_mfma_f32_16x16x32_bf16 v[212:215], a[228:231], v[200:203], v[212:215]
    s_waitcnt lgkmcnt(4)
    v_accvgpr_read_b32 v28, a72
    v_accvgpr_read_b32 v29, a73
    v_mfma_f32_16x16x32_bf16 v[220:223], a[232:235], v[192:195], 0
    ds_read_b64_tr_b16 a[200:201], v6 offset:49152
    v_accvgpr_read_b32 v30, a74
    buffer_store_dwordx4 v[80:83], v45, s[24:27], s3 offen sc1
    v_mfma_f32_16x16x32_bf16 v[220:223], a[236:239], v[200:203], v[220:223]
    ds_read_b64_tr_b16 a[202:203], v6 offset:57344
    v_accvgpr_read_b32 v31, a75
    v_mfma_f32_16x16x32_bf16 v[156:159], a[236:239], v[136:139], 0
    v_accvgpr_read_b32 v32, a84
    v_accvgpr_read_b32 v33, a85
    v_mfma_f32_16x16x32_bf16 v[156:159], a[232:235], v[128:131], v[156:159]
    s_waitcnt vmcnt(5)
    ds_read_b64_tr_b16 a[204:205], v6 offset:49408
    v_accvgpr_read_b32 v34, a86
    v_mfma_f32_16x16x32_bf16 v[92:95], a[232:235], v[64:67], 0
    ds_read_b64_tr_b16 a[206:207], v6 offset:57600
    v_accvgpr_read_b32 v35, a87
    v_mfma_f32_16x16x32_bf16 v[92:95], a[236:239], v[72:75], v[92:95]
    s_waitcnt lgkmcnt(4)
    v_mul_f32 v28, v58, v28
    v_mul_f32 v29, v58, v29
    v_mfma_f32_16x16x32_bf16 v[100:103], a[192:195], v[64:67], 0
    ds_read_b64_tr_b16 a[208:209], v7 offset:49152
    v_mul_f32 v30, v58, v30
    v_mov_b32 v47, 1
    buffer_store_dword v47, v46, s[36:39], s1 offen sc1
    v_mfma_f32_16x16x32_bf16 v[100:103], a[196:199], v[72:75], v[100:103]
    ds_read_b64_tr_b16 a[210:211], v7 offset:57344
    v_mul_f32 v31, v58, v31
    v_mfma_f32_16x16x32_bf16 v[164:167], a[196:199], v[136:139], 0
    v_mul_f32 v32, v58, v32
    v_mul_f32 v33, v58, v33
    buffer_store_dwordx4 v[144:147], v45, s[24:27], s3 offen offset:1024 sc1
    v_mfma_f32_16x16x32_bf16 v[164:167], a[192:195], v[128:131], v[164:167]
    ds_read_b64_tr_b16 a[212:213], v7 offset:49408
    v_mul_f32 v34, v58, v34
    v_mfma_f32_16x16x32_bf16 v[228:231], a[192:195], v[192:195], 0
    ds_read_b64_tr_b16 a[214:215], v7 offset:57600
    v_mul_f32 v35, v58, v35
    v_mfma_f32_16x16x32_bf16 v[228:231], a[196:199], v[200:203], v[228:231]
    s_waitcnt lgkmcnt(4)
    s_waitcnt vmcnt(46)
    v_cvt_pk_bf16_f32 v88, v28, v29
    v_cvt_pk_bf16_f32 v89, v30, v31
    v_cvt_pk_bf16_f32 v90, v32, v33
    v_cvt_pk_bf16_f32 v91, v34, v35
    s_barrier
    v_mfma_f32_16x16x32_bf16 v[236:239], a[200:203], v[192:195], 0
    s_add_u32 m0, s28, 32768
    ds_read_b64_tr_b16 a[216:217], v9 offset:16384
    v_accvgpr_read_b32 v36, a76
    v_accvgpr_read_b32 v37, a77
    v_accvgpr_read_b32 v38, a78
    v_accvgpr_read_b32 v39, a79
    v_accvgpr_read_b32 v40, a88
    v_accvgpr_read_b32 v41, a89
    v_accvgpr_read_b32 v42, a90
    v_accvgpr_read_b32 v43, a91
    v_pk_mul_f32 v[36:37], v[36:37], v[58:59] op_sel:[0,1] op_sel_hi:[1,1]
    v_pk_mul_f32 v[38:39], v[38:39], v[58:59] op_sel:[0,1] op_sel_hi:[1,1]
    v_pk_mul_f32 v[40:41], v[40:41], v[58:59] op_sel:[0,1] op_sel_hi:[1,1]
    v_pk_mul_f32 v[42:43], v[42:43], v[58:59] op_sel:[0,1] op_sel_hi:[1,1]
    v_cvt_pk_bf16_f32 v152, v36, v37
    v_cvt_pk_bf16_f32 v153, v38, v39
    v_cvt_pk_bf16_f32 v154, v40, v41
    v_cvt_pk_bf16_f32 v155, v42, v43
    v_mfma_f32_16x16x32_bf16 v[236:239], a[204:207], v[200:203], v[236:239]
    s_add_u32 s29, s92, s94
    ds_read_b64_tr_b16 a[218:219], v9 offset:24576
    v_accvgpr_read_b32 v28, a80
    v_accvgpr_read_b32 v29, a81
    v_accvgpr_read_b32 v30, a82
    v_accvgpr_read_b32 v31, a83
    v_accvgpr_read_b32 v32, a92
    v_accvgpr_read_b32 v33, a93
    v_accvgpr_read_b32 v34, a94
    v_accvgpr_read_b32 v35, a95
    v_pk_mul_f32 v[28:29], v[28:29], v[60:61] op_sel_hi:[1,0]
    v_pk_mul_f32 v[30:31], v[30:31], v[60:61] op_sel_hi:[1,0]
    v_pk_mul_f32 v[32:33], v[32:33], v[60:61] op_sel_hi:[1,0]
    v_pk_mul_f32 v[34:35], v[34:35], v[60:61] op_sel_hi:[1,0]
    v_cvt_pk_bf16_f32 v216, v28, v29
    v_cvt_pk_bf16_f32 v217, v30, v31
    v_cvt_pk_bf16_f32 v218, v32, v33
    v_cvt_pk_bf16_f32 v219, v34, v35
    v_mfma_f32_16x16x32_bf16 v[172:175], a[204:207], v[136:139], 0
    buffer_load_dwordx4 v53, s[20:23], s29 offen lds
    v_accvgpr_read_b32 v36, a96
    v_mfma_f32_16x16x32_bf16 v[172:175], a[200:203], v[128:131], v[172:175]
    ds_read_b64_tr_b16 a[220:221], v9 offset:16640
    v_accvgpr_read_b32 v37, a97
    v_mfma_f32_16x16x32_bf16 v[108:111], a[200:203], v[64:67], 0
    ds_read_b64_tr_b16 a[222:223], v9 offset:24832
    v_accvgpr_read_b32 v38, a98
    buffer_store_dwordx4 v[208:211], v45, s[24:27], s3 offen offset:2048 sc1
    v_mfma_f32_16x16x32_bf16 v[108:111], a[204:207], v[72:75], v[108:111]
    s_waitcnt lgkmcnt(4)
    buffer_load_dwordx4 v54, s[20:23], s29 offen offset:1024 lds
    v_accvgpr_read_b32 v39, a99
    v_mfma_f32_16x16x32_bf16 v[116:119], a[208:211], v[64:67], 0
    ds_read_b64_tr_b16 a[224:225], v10 offset:16384
    v_accvgpr_read_b32 v40, a108
    v_mfma_f32_16x16x32_bf16 v[116:119], a[212:215], v[72:75], v[116:119]
    ds_read_b64_tr_b16 a[226:227], v10 offset:24576
    v_accvgpr_read_b32 v41, a109
    v_mfma_f32_16x16x32_bf16 v[180:183], a[212:215], v[136:139], 0
    buffer_load_dwordx4 v55, s[20:23], s29 offen offset:2048 lds
    v_accvgpr_read_b32 v42, a110
    v_mfma_f32_16x16x32_bf16 v[180:183], a[208:211], v[128:131], v[180:183]
    ds_read_b64_tr_b16 a[228:229], v10 offset:16640
    v_accvgpr_read_b32 v43, a111
    v_mfma_f32_16x16x32_bf16 v[244:247], a[208:211], v[192:195], 0
    ds_read_b64_tr_b16 a[230:231], v10 offset:24832
    v_mul_f32 v36, v58, v36
    v_mfma_f32_16x16x32_bf16 v[244:247], a[212:215], v[200:203], v[244:247]
    s_waitcnt lgkmcnt(4)
    s_add_u32 s3, s88, 9216
    buffer_load_dwordx4 v56, s[20:23], s29 offen offset:3072 lds
    v_mul_f32 v37, v58, v37
    v_mfma_f32_16x16x32_bf16 v[196:199], a[216:219], v[208:211], v[196:199]
    ds_read_b64_tr_b16 a[232:233], v11 offset:16384
    v_mul_f32 v38, v58, v38
    v_mfma_f32_16x16x32_bf16 v[196:199], a[220:223], v[216:219], v[196:199]
    ds_read_b64_tr_b16 a[234:235], v11 offset:24576
    v_mul_f32 v39, v58, v39
    buffer_store_dwordx4 v[88:91], v45, s[24:27], s3 offen sc1
    v_mfma_f32_16x16x32_bf16 v[132:135], a[220:223], v[152:155], v[132:135]
    v_mul_f32 v40, v58, v40
    v_mul_f32 v41, v58, v41
    v_mfma_f32_16x16x32_bf16 v[132:135], a[216:219], v[144:147], v[132:135]
    ds_read_b64_tr_b16 a[236:237], v11 offset:16640
    v_mul_f32 v42, v58, v42
    v_mfma_f32_16x16x32_bf16 v[68:71], a[216:219], v[80:83], v[68:71]
    ds_read_b64_tr_b16 a[238:239], v11 offset:24832
    v_mul_f32 v43, v58, v43
    v_mfma_f32_16x16x32_bf16 v[68:71], a[220:223], v[88:91], v[68:71]
    s_waitcnt lgkmcnt(4)
    v_cvt_pk_bf16_f32 v96, v36, v37
    v_cvt_pk_bf16_f32 v97, v38, v39
    v_mfma_f32_16x16x32_bf16 v[76:79], a[224:227], v[80:83], v[76:79]
    ds_read_b64_tr_b16 a[192:193], v12 offset:16384
    v_cvt_pk_bf16_f32 v98, v40, v41
    v_mfma_f32_16x16x32_bf16 v[76:79], a[228:231], v[88:91], v[76:79]
    ds_read_b64_tr_b16 a[194:195], v12 offset:24576
    v_cvt_pk_bf16_f32 v99, v42, v43
    v_mfma_f32_16x16x32_bf16 v[140:143], a[228:231], v[152:155], v[140:143]
    v_accvgpr_read_b32 v28, a100
    v_accvgpr_read_b32 v29, a101
    v_mfma_f32_16x16x32_bf16 v[140:143], a[224:227], v[144:147], v[140:143]
    ds_read_b64_tr_b16 a[196:197], v12 offset:16640
    v_accvgpr_read_b32 v30, a102
    buffer_store_dwordx4 v[152:155], v45, s[24:27], s3 offen offset:1024 sc1
    v_mfma_f32_16x16x32_bf16 v[204:207], a[224:227], v[208:211], v[204:207]
    ds_read_b64_tr_b16 a[198:199], v12 offset:24832
    v_accvgpr_read_b32 v31, a103
    v_mfma_f32_16x16x32_bf16 v[204:207], a[228:231], v[216:219], v[204:207]
    s_waitcnt lgkmcnt(4)
    v_accvgpr_read_b32 v32, a112
    v_accvgpr_read_b32 v33, a113
    v_mfma_f32_16x16x32_bf16 v[212:215], a[232:235], v[208:211], v[212:215]
    ds_read_b64_tr_b16 a[200:201], v13 offset:16384
    v_accvgpr_read_b32 v34, a114
    v_mfma_f32_16x16x32_bf16 v[212:215], a[236:239], v[216:219], v[212:215]
    ds_read_b64_tr_b16 a[202:203], v13 offset:24576
    v_accvgpr_read_b32 v35, a115
    v_mfma_f32_16x16x32_bf16 v[148:151], a[236:239], v[152:155], v[148:151]
    v_mul_f32 v28, v59, v28
    v_mul_f32 v29, v59, v29
    v_mfma_f32_16x16x32_bf16 v[148:151], a[232:235], v[144:147], v[148:151]
    ds_read_b64_tr_b16 a[204:205], v13 offset:16640
    v_mul_f32 v30, v59, v30
    v_mfma_f32_16x16x32_bf16 v[84:87], a[232:235], v[80:83], v[84:87]
    ds_read_b64_tr_b16 a[206:207], v13 offset:24832
    v_mul_f32 v31, v59, v31
    v_mfma_f32_16x16x32_bf16 v[84:87], a[236:239], v[88:91], v[84:87]
    s_waitcnt lgkmcnt(4)
    v_mul_f32 v32, v59, v32
    v_mul_f32 v33, v59, v33
    buffer_store_dwordx4 v[216:219], v45, s[24:27], s3 offen offset:2048 sc1
    v_mfma_f32_16x16x32_bf16 v[92:95], a[192:195], v[80:83], v[92:95]
    ds_read_b64_tr_b16 a[208:209], v14 offset:16384
    v_mul_f32 v34, v59, v34
    v_mfma_f32_16x16x32_bf16 v[92:95], a[196:199], v[88:91], v[92:95]
    ds_read_b64_tr_b16 a[210:211], v14 offset:24576
    v_mul_f32 v35, v59, v35
    v_mfma_f32_16x16x32_bf16 v[156:159], a[196:199], v[152:155], v[156:159]
    v_cvt_pk_bf16_f32 v160, v28, v29
    v_cvt_pk_bf16_f32 v161, v30, v31
    v_mfma_f32_16x16x32_bf16 v[156:159], a[192:195], v[144:147], v[156:159]
    ds_read_b64_tr_b16 a[212:213], v14 offset:16640
    v_cvt_pk_bf16_f32 v162, v32, v33
    v_mfma_f32_16x16x32_bf16 v[220:223], a[192:195], v[208:211], v[220:223]
    ds_read_b64_tr_b16 a[214:215], v14 offset:24832
    v_cvt_pk_bf16_f32 v163, v34, v35
    v_mfma_f32_16x16x32_bf16 v[220:223], a[196:199], v[216:219], v[220:223]
    s_waitcnt lgkmcnt(4)
    v_accvgpr_read_b32 v36, a104
    v_accvgpr_read_b32 v37, a105
    v_mfma_f32_16x16x32_bf16 v[228:231], a[200:203], v[208:211], v[228:231]
    ds_read_b64_tr_b16 a[216:217], v15 offset:16384
    v_accvgpr_read_b32 v38, a106
    v_mfma_f32_16x16x32_bf16 v[228:231], a[204:207], v[216:219], v[228:231]
    ds_read_b64_tr_b16 a[218:219], v15 offset:24576
    v_accvgpr_read_b32 v39, a107
    v_mfma_f32_16x16x32_bf16 v[164:167], a[204:207], v[152:155], v[164:167]
    v_accvgpr_read_b32 v40, a116
    v_accvgpr_read_b32 v41, a117
    v_mfma_f32_16x16x32_bf16 v[164:167], a[200:203], v[144:147], v[164:167]
    ds_read_b64_tr_b16 a[220:221], v15 offset:16640
    v_accvgpr_read_b32 v42, a118
    v_mfma_f32_16x16x32_bf16 v[100:103], a[200:203], v[80:83], v[100:103]
    ds_read_b64_tr_b16 a[222:223], v15 offset:24832
    v_accvgpr_read_b32 v43, a119
    v_mfma_f32_16x16x32_bf16 v[100:103], a[204:207], v[88:91], v[100:103]
    s_waitcnt lgkmcnt(4)
    s_waitcnt vmcnt(37)
    s_barrier
    v_mfma_f32_16x16x32_bf16 v[108:111], a[208:211], v[80:83], v[108:111]
    s_add_u32 m0, s28, 49152
    ds_read_b64_tr_b16 a[224:225], v17 offset:16384
    v_mul_f32 v36, v60, v36
    v_mfma_f32_16x16x32_bf16 v[108:111], a[212:215], v[88:91], v[108:111]
    s_add_u32 s29, s89, s95
    ds_read_b64_tr_b16 a[226:227], v17 offset:24576
    v_mul_f32 v37, v60, v37
    v_mfma_f32_16x16x32_bf16 v[172:175], a[212:215], v[152:155], v[172:175]
    buffer_load_dwordx4 v53, s[20:23], s29 offen lds
    v_mul_f32 v38, v60, v38
    v_mfma_f32_16x16x32_bf16 v[172:175], a[208:211], v[144:147], v[172:175]
    s_load_dwordx4 s[84:87], s[36:37], s48 offset:0 glc
    ds_read_b64_tr_b16 a[228:229], v17 offset:16640
    v_mul_f32 v39, v60, v39
    v_mfma_f32_16x16x32_bf16 v[236:239], a[208:211], v[208:211], v[236:239]
    ds_read_b64_tr_b16 a[230:231], v17 offset:24832
    v_mul_f32 v40, v60, v40
    v_mfma_f32_16x16x32_bf16 v[236:239], a[212:215], v[216:219], v[236:239]
    s_waitcnt lgkmcnt(4)
    buffer_load_dwordx4 v54, s[20:23], s29 offen offset:1024 lds
    v_mul_f32 v41, v60, v41
    v_mfma_f32_16x16x32_bf16 v[244:247], a[216:219], v[208:211], v[244:247]
    ds_read_b64_tr_b16 a[232:233], v18 offset:16384
    v_mul_f32 v42, v60, v42
    v_mfma_f32_16x16x32_bf16 v[244:247], a[220:223], v[216:219], v[244:247]
    ds_read_b64_tr_b16 a[234:235], v18 offset:24576
    v_mul_f32 v43, v60, v43
    v_mfma_f32_16x16x32_bf16 v[180:183], a[220:223], v[152:155], v[180:183]
    buffer_load_dwordx4 v55, s[20:23], s29 offen offset:2048 lds
    v_cvt_pk_bf16_f32 v224, v36, v37
    v_mfma_f32_16x16x32_bf16 v[180:183], a[216:219], v[144:147], v[180:183]
    ds_read_b64_tr_b16 a[236:237], v18 offset:16640
    v_cvt_pk_bf16_f32 v225, v38, v39
    v_mfma_f32_16x16x32_bf16 v[116:119], a[216:219], v[80:83], v[116:119]
    ds_read_b64_tr_b16 a[238:239], v18 offset:24832
    v_cvt_pk_bf16_f32 v226, v40, v41
    v_mfma_f32_16x16x32_bf16 v[116:119], a[220:223], v[88:91], v[116:119]
    s_waitcnt lgkmcnt(4)
    buffer_load_dwordx4 v56, s[20:23], s29 offen offset:3072 lds
    v_cvt_pk_bf16_f32 v227, v42, v43
    v_mfma_f32_16x16x32_bf16 v[68:71], a[224:227], v[96:99], v[68:71]
    ds_read_b64_tr_b16 a[192:193], v19 offset:16384
    v_accvgpr_read_b32 v28, a120
    v_accvgpr_read_b32 v29, a121
    v_accvgpr_read_b32 v30, a122
    v_accvgpr_read_b32 v31, a123
    v_accvgpr_read_b32 v32, a132
    v_accvgpr_read_b32 v33, a133
    v_accvgpr_read_b32 v34, a134
    v_accvgpr_read_b32 v35, a135
    v_pk_mul_f32 v[28:29], v[28:29], v[58:59] op_sel_hi:[1,0]
    v_pk_mul_f32 v[30:31], v[30:31], v[58:59] op_sel_hi:[1,0]
    v_pk_mul_f32 v[32:33], v[32:33], v[58:59] op_sel_hi:[1,0]
    v_pk_mul_f32 v[34:35], v[34:35], v[58:59] op_sel_hi:[1,0]
    v_cvt_pk_bf16_f32 v104, v28, v29
    v_cvt_pk_bf16_f32 v105, v30, v31
    v_cvt_pk_bf16_f32 v106, v32, v33
    v_cvt_pk_bf16_f32 v107, v34, v35
    s_nop 1
    v_mfma_f32_16x16x32_bf16 v[68:71], a[228:231], v[104:107], v[68:71]
    ds_read_b64_tr_b16 a[194:195], v19 offset:24576
    v_accvgpr_read_b32 v36, a124
    v_accvgpr_read_b32 v37, a125
    v_accvgpr_read_b32 v38, a126
    v_accvgpr_read_b32 v39, a127
    v_accvgpr_read_b32 v40, a136
    v_accvgpr_read_b32 v41, a137
    v_accvgpr_read_b32 v42, a138
    v_accvgpr_read_b32 v43, a139
    v_pk_mul_f32 v[36:37], v[36:37], v[58:59] op_sel:[0,1] op_sel_hi:[1,1]
    v_pk_mul_f32 v[38:39], v[38:39], v[58:59] op_sel:[0,1] op_sel_hi:[1,1]
    v_pk_mul_f32 v[40:41], v[40:41], v[58:59] op_sel:[0,1] op_sel_hi:[1,1]
    v_pk_mul_f32 v[42:43], v[42:43], v[58:59] op_sel:[0,1] op_sel_hi:[1,1]
    v_cvt_pk_bf16_f32 v168, v36, v37
    v_cvt_pk_bf16_f32 v169, v38, v39
    v_cvt_pk_bf16_f32 v170, v40, v41
    v_cvt_pk_bf16_f32 v171, v42, v43
    s_nop 1
    v_mfma_f32_16x16x32_bf16 v[132:135], a[228:231], v[168:171], v[132:135]
    v_mfma_f32_16x16x32_bf16 v[132:135], a[224:227], v[160:163], v[132:135]
    ds_read_b64_tr_b16 a[196:197], v19 offset:16640
    v_mfma_f32_16x16x32_bf16 v[196:199], a[224:227], v[224:227], v[196:199]
    ds_read_b64_tr_b16 a[198:199], v19 offset:24832
    v_accvgpr_read_b32 v28, a128
    v_accvgpr_read_b32 v29, a129
    v_accvgpr_read_b32 v30, a130
    v_accvgpr_read_b32 v31, a131
    v_accvgpr_read_b32 v32, a140
    v_accvgpr_read_b32 v33, a141
    v_accvgpr_read_b32 v34, a142
    v_accvgpr_read_b32 v35, a143
    v_pk_mul_f32 v[28:29], v[28:29], v[60:61] op_sel_hi:[1,0]
    v_pk_mul_f32 v[30:31], v[30:31], v[60:61] op_sel_hi:[1,0]
    v_pk_mul_f32 v[32:33], v[32:33], v[60:61] op_sel_hi:[1,0]
    v_pk_mul_f32 v[34:35], v[34:35], v[60:61] op_sel_hi:[1,0]
    v_cvt_pk_bf16_f32 v232, v28, v29
    v_cvt_pk_bf16_f32 v233, v30, v31
    v_cvt_pk_bf16_f32 v234, v32, v33
    v_cvt_pk_bf16_f32 v235, v34, v35
    s_nop 1
    v_mfma_f32_16x16x32_bf16 v[196:199], a[228:231], v[232:235], v[196:199]
    s_waitcnt lgkmcnt(4)
    v_accvgpr_read_b32 v36, a144
    v_accvgpr_read_b32 v37, a145
    v_mfma_f32_16x16x32_bf16 v[204:207], a[232:235], v[224:227], v[204:207]
    ds_read_b64_tr_b16 a[200:201], v20 offset:16384
    v_accvgpr_read_b32 v38, a146
    v_mfma_f32_16x16x32_bf16 v[204:207], a[236:239], v[232:235], v[204:207]
    ds_read_b64_tr_b16 a[202:203], v20 offset:24576
    v_accvgpr_read_b32 v39, a147
    v_mfma_f32_16x16x32_bf16 v[140:143], a[236:239], v[168:171], v[140:143]
    v_accvgpr_read_b32 v40, a156
    v_accvgpr_read_b32 v41, a157
    v_mfma_f32_16x16x32_bf16 v[140:143], a[232:235], v[160:163], v[140:143]
    ds_read_b64_tr_b16 a[204:205], v20 offset:16640
    v_accvgpr_read_b32 v42, a158
    v_mfma_f32_16x16x32_bf16 v[76:79], a[232:235], v[96:99], v[76:79]
    ds_read_b64_tr_b16 a[206:207], v20 offset:24832
    v_accvgpr_read_b32 v43, a159
    v_mfma_f32_16x16x32_bf16 v[76:79], a[236:239], v[104:107], v[76:79]
    s_waitcnt lgkmcnt(4)
    v_mul_f32 v36, v58, v36
    v_mul_f32 v37, v58, v37
    v_mfma_f32_16x16x32_bf16 v[84:87], a[192:195], v[96:99], v[84:87]
    ds_read_b64_tr_b16 a[208:209], v21 offset:16384
    v_mul_f32 v38, v58, v38
    v_mfma_f32_16x16x32_bf16 v[84:87], a[196:199], v[104:107], v[84:87]
    ds_read_b64_tr_b16 a[210:211], v21 offset:24576
    v_mul_f32 v39, v58, v39
    v_mfma_f32_16x16x32_bf16 v[148:151], a[196:199], v[168:171], v[148:151]
    v_mul_f32 v40, v58, v40
    v_mul_f32 v41, v58, v41
    v_mfma_f32_16x16x32_bf16 v[148:151], a[192:195], v[160:163], v[148:151]
    ds_read_b64_tr_b16 a[212:213], v21 offset:16640
    v_mul_f32 v42, v58, v42
    v_mfma_f32_16x16x32_bf16 v[212:215], a[192:195], v[224:227], v[212:215]
    ds_read_b64_tr_b16 a[214:215], v21 offset:24832
    v_mul_f32 v43, v58, v43
    v_mfma_f32_16x16x32_bf16 v[212:215], a[196:199], v[232:235], v[212:215]
    s_waitcnt lgkmcnt(4)
    v_cvt_pk_bf16_f32 v112, v36, v37
    v_cvt_pk_bf16_f32 v113, v38, v39
    v_mfma_f32_16x16x32_bf16 v[220:223], a[200:203], v[224:227], v[220:223]
    ds_read_b64_tr_b16 a[216:217], v22 offset:16384
    v_cvt_pk_bf16_f32 v114, v40, v41
    v_mfma_f32_16x16x32_bf16 v[220:223], a[204:207], v[232:235], v[220:223]
    ds_read_b64_tr_b16 a[218:219], v22 offset:24576
    v_cvt_pk_bf16_f32 v115, v42, v43
    v_mfma_f32_16x16x32_bf16 v[156:159], a[204:207], v[168:171], v[156:159]
    s_waitcnt vmcnt(4)
    v_accvgpr_read_b32 v28, a148
    v_accvgpr_read_b32 v29, a149
    v_mfma_f32_16x16x32_bf16 v[156:159], a[200:203], v[160:163], v[156:159]
    ds_read_b64_tr_b16 a[220:221], v22 offset:16640
    v_accvgpr_read_b32 v30, a150
    s_min_u32 s33, s84, s85
    s_min_u32 s33, s33, s86
    s_min_u32 s33, s33, s87
    s_cmp_lt_u32 s33, 1
    s_cbranch_scc1 L_q0_spin
L_q0_ok:
    v_mfma_f32_16x16x32_bf16 v[92:95], a[200:203], v[96:99], v[92:95]
    s_add_u32 s52, s89, 0
    ds_read_b64_tr_b16 a[222:223], v22 offset:24832
    v_accvgpr_read_b32 v31, a151
    v_mfma_f32_16x16x32_bf16 v[92:95], a[204:207], v[104:107], v[92:95]
    s_waitcnt lgkmcnt(4)
    v_accvgpr_read_b32 v32, a160
    v_accvgpr_read_b32 v33, a161
    v_mov_b32 v47, 2
    buffer_store_dword v47, v46, s[36:39], s1 offen sc1
    buffer_load_dwordx4 a[0:3], v45, s[24:27], s52 offen sc1
    v_mfma_f32_16x16x32_bf16 v[100:103], a[208:211], v[96:99], v[100:103]
    ds_read_b64_tr_b16 a[224:225], v23 offset:16384
    v_accvgpr_read_b32 v34, a162
    v_mfma_f32_16x16x32_bf16 v[100:103], a[212:215], v[104:107], v[100:103]
    ds_read_b64_tr_b16 a[226:227], v23 offset:24576
    v_accvgpr_read_b32 v35, a163
    v_mfma_f32_16x16x32_bf16 v[164:167], a[212:215], v[168:171], v[164:167]
    v_mul_f32 v28, v59, v28
    v_mul_f32 v29, v59, v29
    v_mfma_f32_16x16x32_bf16 v[164:167], a[208:211], v[160:163], v[164:167]
    ds_read_b64_tr_b16 a[228:229], v23 offset:16640
    v_mul_f32 v30, v59, v30
    v_mfma_f32_16x16x32_bf16 v[228:231], a[208:211], v[224:227], v[228:231]
    ds_read_b64_tr_b16 a[230:231], v23 offset:24832
    v_mul_f32 v31, v59, v31
    v_mfma_f32_16x16x32_bf16 v[228:231], a[212:215], v[232:235], v[228:231]
    s_waitcnt lgkmcnt(4)
    v_mul_f32 v32, v59, v32
    v_mul_f32 v33, v59, v33
    v_mfma_f32_16x16x32_bf16 v[236:239], a[216:219], v[224:227], v[236:239]
    ds_read_b64_tr_b16 a[232:233], v9 offset:0
    v_mul_f32 v34, v59, v34
    buffer_load_dwordx4 a[4:7], v45, s[24:27], s52 offen offset:1024 sc1
    v_mfma_f32_16x16x32_bf16 v[236:239], a[220:223], v[232:235], v[236:239]
    ds_read_b64_tr_b16 a[234:235], v9 offset:8192
    v_mul_f32 v35, v59, v35
    v_mfma_f32_16x16x32_bf16 v[172:175], a[220:223], v[168:171], v[172:175]
    v_cvt_pk_bf16_f32 v176, v28, v29
    v_cvt_pk_bf16_f32 v177, v30, v31
    v_mfma_f32_16x16x32_bf16 v[172:175], a[216:219], v[160:163], v[172:175]
    ds_read_b64_tr_b16 a[236:237], v9 offset:256
    v_cvt_pk_bf16_f32 v178, v32, v33
    v_mfma_f32_16x16x32_bf16 v[108:111], a[216:219], v[96:99], v[108:111]
    ds_read_b64_tr_b16 a[238:239], v9 offset:8448
    v_cvt_pk_bf16_f32 v179, v34, v35
    v_mfma_f32_16x16x32_bf16 v[108:111], a[220:223], v[104:107], v[108:111]
    s_waitcnt lgkmcnt(4)
    v_mfma_f32_16x16x32_bf16 v[116:119], a[224:227], v[96:99], v[116:119]
    ds_read_b64_tr_b16 a[192:193], v10 offset:0
    buffer_load_dwordx4 a[8:11], v45, s[24:27], s52 offen offset:2048 sc1
    v_mfma_f32_16x16x32_bf16 v[116:119], a[228:231], v[104:107], v[116:119]
    ds_read_b64_tr_b16 a[194:195], v10 offset:8192
    v_mfma_f32_16x16x32_bf16 v[180:183], a[228:231], v[168:171], v[180:183]
    v_mfma_f32_16x16x32_bf16 v[180:183], a[224:227], v[160:163], v[180:183]
    ds_read_b64_tr_b16 a[196:197], v10 offset:256
    v_mfma_f32_16x16x32_bf16 v[244:247], a[224:227], v[224:227], v[244:247]
    ds_read_b64_tr_b16 a[198:199], v10 offset:8448
    v_mfma_f32_16x16x32_bf16 v[244:247], a[228:231], v[232:235], v[244:247]
    s_waitcnt lgkmcnt(4)
    v_accvgpr_read_b32 v36, a152
    v_accvgpr_read_b32 v37, a153
    v_accvgpr_read_b32 v38, a154
    v_accvgpr_read_b32 v39, a155
    v_accvgpr_read_b32 v40, a164
    v_accvgpr_read_b32 v41, a165
    v_accvgpr_read_b32 v42, a166
    v_accvgpr_read_b32 v43, a167
    v_pk_mul_f32 v[36:37], v[36:37], v[60:61] op_sel_hi:[1,0]
    v_pk_mul_f32 v[38:39], v[38:39], v[60:61] op_sel_hi:[1,0]
    v_pk_mul_f32 v[40:41], v[40:41], v[60:61] op_sel_hi:[1,0]
    v_pk_mul_f32 v[42:43], v[42:43], v[60:61] op_sel_hi:[1,0]
    v_cvt_pk_bf16_f32 v240, v36, v37
    v_cvt_pk_bf16_f32 v241, v38, v39
    v_cvt_pk_bf16_f32 v242, v40, v41
    v_cvt_pk_bf16_f32 v243, v42, v43
    s_nop 1
    v_mfma_f32_16x16x32_bf16 v[196:199], a[232:235], v[240:243], v[196:199]
    s_add_u32 s52, s89, 3072
    ds_read_b64_tr_b16 a[200:201], v11 offset:0
    v_accvgpr_read_b32 v28, a168
    v_accvgpr_read_b32 v29, a169
    v_accvgpr_read_b32 v30, a170
    v_accvgpr_read_b32 v31, a171
    v_accvgpr_read_b32 v32, a180
    v_accvgpr_read_b32 v33, a181
    v_accvgpr_read_b32 v34, a182
    v_accvgpr_read_b32 v35, a183
    v_pk_mul_f32 v[28:29], v[28:29], v[58:59] op_sel_hi:[1,0]
    v_pk_mul_f32 v[30:31], v[30:31], v[58:59] op_sel_hi:[1,0]
    v_pk_mul_f32 v[32:33], v[32:33], v[58:59] op_sel_hi:[1,0]
    v_pk_mul_f32 v[34:35], v[34:35], v[58:59] op_sel_hi:[1,0]
    v_cvt_pk_bf16_f32 v120, v28, v29
    v_cvt_pk_bf16_f32 v121, v30, v31
    v_cvt_pk_bf16_f32 v122, v32, v33
    v_cvt_pk_bf16_f32 v123, v34, v35
    v_accvgpr_read_b32 v36, a172
    v_accvgpr_read_b32 v37, a173
    v_accvgpr_read_b32 v38, a174
    v_accvgpr_read_b32 v39, a175
    v_accvgpr_read_b32 v40, a184
    v_accvgpr_read_b32 v41, a185
    v_accvgpr_read_b32 v42, a186
    v_accvgpr_read_b32 v43, a187
    v_pk_mul_f32 v[36:37], v[36:37], v[58:59] op_sel:[0,1] op_sel_hi:[1,1]
    v_pk_mul_f32 v[38:39], v[38:39], v[58:59] op_sel:[0,1] op_sel_hi:[1,1]
    v_pk_mul_f32 v[40:41], v[40:41], v[58:59] op_sel:[0,1] op_sel_hi:[1,1]
    v_pk_mul_f32 v[42:43], v[42:43], v[58:59] op_sel:[0,1] op_sel_hi:[1,1]
    v_cvt_pk_bf16_f32 v184, v36, v37
    v_cvt_pk_bf16_f32 v185, v38, v39
    v_cvt_pk_bf16_f32 v186, v40, v41
    v_cvt_pk_bf16_f32 v187, v42, v43
    v_accvgpr_read_b32 v28, a176
    v_accvgpr_read_b32 v29, a177
    v_accvgpr_read_b32 v30, a178
    v_accvgpr_read_b32 v31, a179
    v_accvgpr_read_b32 v32, a188
    v_accvgpr_read_b32 v33, a189
    v_accvgpr_read_b32 v34, a190
    v_accvgpr_read_b32 v35, a191
    v_pk_mul_f32 v[28:29], v[28:29], v[60:61] op_sel_hi:[1,0]
    v_pk_mul_f32 v[30:31], v[30:31], v[60:61] op_sel_hi:[1,0]
    v_pk_mul_f32 v[32:33], v[32:33], v[60:61] op_sel_hi:[1,0]
    v_pk_mul_f32 v[34:35], v[34:35], v[60:61] op_sel_hi:[1,0]
    v_cvt_pk_bf16_f32 v248, v28, v29
    v_cvt_pk_bf16_f32 v249, v30, v31
    v_cvt_pk_bf16_f32 v250, v32, v33
    v_cvt_pk_bf16_f32 v251, v34, v35
    s_nop 1
    v_mfma_f32_16x16x32_bf16 v[196:199], a[236:239], v[248:251], v[196:199]
    ds_read_b64_tr_b16 a[202:203], v11 offset:8192
    buffer_load_dwordx4 a[12:15], v45, s[24:27], s52 offen sc1
    v_mfma_f32_16x16x32_bf16 v[132:135], a[236:239], v[184:187], v[132:135]
    v_mfma_f32_16x16x32_bf16 v[132:135], a[232:235], v[176:179], v[132:135]
    ds_read_b64_tr_b16 a[204:205], v11 offset:256
    v_mfma_f32_16x16x32_bf16 v[68:71], a[232:235], v[112:115], v[68:71]
    ds_read_b64_tr_b16 a[206:207], v11 offset:8448
    v_mfma_f32_16x16x32_bf16 v[68:71], a[236:239], v[120:123], v[68:71]
    s_waitcnt lgkmcnt(4)
    v_mfma_f32_16x16x32_bf16 v[76:79], a[192:195], v[112:115], v[76:79]
    ds_read_b64_tr_b16 a[208:209], v12 offset:0
    v_mfma_f32_16x16x32_bf16 v[76:79], a[196:199], v[120:123], v[76:79]
    ds_read_b64_tr_b16 a[210:211], v12 offset:8192
    buffer_load_dwordx4 a[16:19], v45, s[24:27], s52 offen offset:1024 sc1
    v_mfma_f32_16x16x32_bf16 v[140:143], a[196:199], v[184:187], v[140:143]
    v_mfma_f32_16x16x32_bf16 v[140:143], a[192:195], v[176:179], v[140:143]
    ds_read_b64_tr_b16 a[212:213], v12 offset:256
    v_mfma_f32_16x16x32_bf16 v[204:207], a[192:195], v[240:243], v[204:207]
    ds_read_b64_tr_b16 a[214:215], v12 offset:8448
    v_mfma_f32_16x16x32_bf16 v[204:207], a[196:199], v[248:251], v[204:207]
    s_waitcnt lgkmcnt(4)
    v_mfma_f32_16x16x32_bf16 v[212:215], a[200:203], v[240:243], v[212:215]
    ds_read_b64_tr_b16 a[216:217], v13 offset:0
    v_mfma_f32_16x16x32_bf16 v[212:215], a[204:207], v[248:251], v[212:215]
    ds_read_b64_tr_b16 a[218:219], v13 offset:8192
    buffer_load_dwordx4 a[20:23], v45, s[24:27], s52 offen offset:2048 sc1
    v_mfma_f32_16x16x32_bf16 v[148:151], a[204:207], v[184:187], v[148:151]
    v_mfma_f32_16x16x32_bf16 v[148:151], a[200:203], v[176:179], v[148:151]
    ds_read_b64_tr_b16 a[220:221], v13 offset:256
    v_mfma_f32_16x16x32_bf16 v[84:87], a[200:203], v[112:115], v[84:87]
    ds_read_b64_tr_b16 a[222:223], v13 offset:8448
    v_mfma_f32_16x16x32_bf16 v[84:87], a[204:207], v[120:123], v[84:87]
    s_waitcnt lgkmcnt(4)
    v_mfma_f32_16x16x32_bf16 v[92:95], a[208:211], v[112:115], v[92:95]
    ds_read_b64_tr_b16 a[224:225], v14 offset:0
    v_mfma_f32_16x16x32_bf16 v[92:95], a[212:215], v[120:123], v[92:95]
    s_add_u32 s52, s90, 0
    ds_read_b64_tr_b16 a[226:227], v14 offset:8192
    buffer_load_dwordx4 a[24:27], v45, s[24:27], s52 offen sc1
    v_mfma_f32_16x16x32_bf16 v[156:159], a[212:215], v[184:187], v[156:159]
    v_mfma_f32_16x16x32_bf16 v[156:159], a[208:211], v[176:179], v[156:159]
    ds_read_b64_tr_b16 a[228:229], v14 offset:256
    v_mfma_f32_16x16x32_bf16 v[220:223], a[208:211], v[240:243], v[220:223]
    ds_read_b64_tr_b16 a[230:231], v14 offset:8448
    v_mfma_f32_16x16x32_bf16 v[220:223], a[212:215], v[248:251], v[220:223]
    s_waitcnt lgkmcnt(4)
    v_mfma_f32_16x16x32_bf16 v[228:231], a[216:219], v[240:243], v[228:231]
    ds_read_b64_tr_b16 a[232:233], v15 offset:0
    v_mfma_f32_16x16x32_bf16 v[228:231], a[220:223], v[248:251], v[228:231]
    s_add_u32 s3, s88, 12288
    ds_read_b64_tr_b16 a[234:235], v15 offset:8192
    buffer_store_dwordx4 v[96:99], v45, s[24:27], s3 offen sc1
    v_mfma_f32_16x16x32_bf16 v[164:167], a[220:223], v[184:187], v[164:167]
    buffer_load_dwordx4 a[28:31], v45, s[24:27], s52 offen offset:1024 sc1
    v_mfma_f32_16x16x32_bf16 v[164:167], a[216:219], v[176:179], v[164:167]
    ds_read_b64_tr_b16 a[236:237], v15 offset:256
    v_mfma_f32_16x16x32_bf16 v[100:103], a[216:219], v[112:115], v[100:103]
    ds_read_b64_tr_b16 a[238:239], v15 offset:8448
    v_mfma_f32_16x16x32_bf16 v[100:103], a[220:223], v[120:123], v[100:103]
    s_waitcnt lgkmcnt(4)
    s_waitcnt vmcnt(39)
    s_barrier
    v_mfma_f32_16x16x32_bf16 v[108:111], a[224:227], v[112:115], v[108:111]
    ds_read_b64_tr_b16 a[192:193], v9 offset:32768
    v_mfma_f32_16x16x32_bf16 v[108:111], a[228:231], v[120:123], v[108:111]
    ds_read_b64_tr_b16 a[194:195], v9 offset:40960
    v_mfma_f32_16x16x32_bf16 v[172:175], a[228:231], v[184:187], v[172:175]
    buffer_load_dwordx4 a[32:35], v45, s[24:27], s52 offen offset:2048 sc1
    v_mfma_f32_16x16x32_bf16 v[172:175], a[224:227], v[176:179], v[172:175]
    ds_read_b64_tr_b16 a[196:197], v9 offset:33024
    buffer_store_dwordx4 v[160:163], v45, s[24:27], s3 offen offset:1024 sc1
    v_mfma_f32_16x16x32_bf16 v[236:239], a[224:227], v[240:243], v[236:239]
    ds_read_b64_tr_b16 a[198:199], v9 offset:41216
    v_mfma_f32_16x16x32_bf16 v[236:239], a[228:231], v[248:251], v[236:239]
    s_waitcnt lgkmcnt(4)
    v_mfma_f32_16x16x32_bf16 v[244:247], a[232:235], v[240:243], v[244:247]
    ds_read_b64_tr_b16 a[200:201], v10 offset:32768
    v_mfma_f32_16x16x32_bf16 v[244:247], a[236:239], v[248:251], v[244:247]
    ds_read_b64_tr_b16 a[202:203], v10 offset:40960
    v_mfma_f32_16x16x32_bf16 v[180:183], a[236:239], v[184:187], v[180:183]
    s_add_u32 s52, s90, 3072
    buffer_load_dwordx4 a[36:39], v45, s[24:27], s52 offen sc1
    v_mfma_f32_16x16x32_bf16 v[180:183], a[232:235], v[176:179], v[180:183]
    ds_read_b64_tr_b16 a[204:205], v10 offset:33024
    v_mfma_f32_16x16x32_bf16 v[116:119], a[232:235], v[112:115], v[116:119]
    ds_read_b64_tr_b16 a[206:207], v10 offset:41216
    v_mfma_f32_16x16x32_bf16 v[116:119], a[236:239], v[120:123], v[116:119]
    s_waitcnt lgkmcnt(4)
    buffer_store_dwordx4 v[224:227], v45, s[24:27], s3 offen offset:2048 sc1
    s_waitcnt vmcnt(10)
    v_mfma_f32_16x16x32_bf16 v[68:71], a[192:195], a[0:3], v[68:71]
    ds_read_b64_tr_b16 a[208:209], v11 offset:32768
    s_waitcnt vmcnt(7)
    v_mfma_f32_16x16x32_bf16 v[68:71], a[196:199], a[12:15], v[68:71]
    ds_read_b64_tr_b16 a[210:211], v11 offset:40960
    v_mfma_f32_16x16x32_bf16 v[132:135], a[196:199], a[16:19], v[132:135]
    buffer_load_dwordx4 a[40:43], v45, s[24:27], s52 offen offset:1024 sc1
    v_mfma_f32_16x16x32_bf16 v[132:135], a[192:195], a[4:7], v[132:135]
    ds_read_b64_tr_b16 a[212:213], v11 offset:33024
    v_mfma_f32_16x16x32_bf16 v[196:199], a[192:195], a[8:11], v[196:199]
    ds_read_b64_tr_b16 a[214:215], v11 offset:41216
    v_mfma_f32_16x16x32_bf16 v[196:199], a[196:199], a[20:23], v[196:199]
    s_waitcnt lgkmcnt(4)
    v_mfma_f32_16x16x32_bf16 v[204:207], a[200:203], a[8:11], v[204:207]
    ds_read_b64_tr_b16 a[216:217], v12 offset:32768
    v_mfma_f32_16x16x32_bf16 v[204:207], a[204:207], a[20:23], v[204:207]
    ds_read_b64_tr_b16 a[218:219], v12 offset:40960
    v_mfma_f32_16x16x32_bf16 v[140:143], a[204:207], a[16:19], v[140:143]
    s_add_u32 s3, s88, 15360
    buffer_store_dwordx4 v[104:107], v45, s[24:27], s3 offen sc1
    buffer_load_dwordx4 a[44:47], v45, s[24:27], s52 offen offset:2048 sc1
    v_mfma_f32_16x16x32_bf16 v[140:143], a[200:203], a[4:7], v[140:143]
    ds_read_b64_tr_b16 a[220:221], v12 offset:33024
    v_mfma_f32_16x16x32_bf16 v[76:79], a[200:203], a[0:3], v[76:79]
    ds_read_b64_tr_b16 a[222:223], v12 offset:41216
    v_mfma_f32_16x16x32_bf16 v[76:79], a[204:207], a[12:15], v[76:79]
    s_waitcnt lgkmcnt(4)
    v_mfma_f32_16x16x32_bf16 v[84:87], a[208:211], a[0:3], v[84:87]
    ds_read_b64_tr_b16 a[224:225], v13 offset:32768
    v_mfma_f32_16x16x32_bf16 v[84:87], a[212:215], a[12:15], v[84:87]
    ds_read_b64_tr_b16 a[226:227], v13 offset:40960
    v_mfma_f32_16x16x32_bf16 v[148:151], a[212:215], a[16:19], v[148:151]
    s_add_u32 s52, s92, 0
    buffer_load_dwordx4 a[48:51], v45, s[24:27], s52 offen sc1
    v_mfma_f32_16x16x32_bf16 v[148:151], a[208:211], a[4:7], v[148:151]
    s_add_u32 m0, s28, 81920
    ds_read_b64_tr_b16 a[228:229], v13 offset:33024
    v_mfma_f32_16x16x32_bf16 v[212:215], a[208:211], a[8:11], v[212:215]
    s_add_u32 s29, s90, s95
    ds_read_b64_tr_b16 a[230:231], v13 offset:41216
    buffer_store_dwordx4 v[168:171], v45, s[24:27], s3 offen offset:1024 sc1
    v_mfma_f32_16x16x32_bf16 v[212:215], a[212:215], a[20:23], v[212:215]
    s_waitcnt lgkmcnt(4)
    buffer_load_dwordx4 v53, s[20:23], s29 offen lds
    v_mfma_f32_16x16x32_bf16 v[220:223], a[216:219], a[8:11], v[220:223]
    ds_read_b64_tr_b16 a[232:233], v14 offset:32768
    v_mfma_f32_16x16x32_bf16 v[220:223], a[220:223], a[20:23], v[220:223]
    ds_read_b64_tr_b16 a[234:235], v14 offset:40960
    v_mfma_f32_16x16x32_bf16 v[156:159], a[220:223], a[16:19], v[156:159]
    buffer_load_dwordx4 v54, s[20:23], s29 offen offset:1024 lds
    buffer_load_dwordx4 a[52:55], v45, s[24:27], s52 offen offset:1024 sc1
    v_mfma_f32_16x16x32_bf16 v[156:159], a[216:219], a[4:7], v[156:159]
    ds_read_b64_tr_b16 a[236:237], v14 offset:33024
    v_mfma_f32_16x16x32_bf16 v[92:95], a[216:219], a[0:3], v[92:95]
    ds_read_b64_tr_b16 a[238:239], v14 offset:41216
    v_mfma_f32_16x16x32_bf16 v[92:95], a[220:223], a[12:15], v[92:95]
    s_waitcnt lgkmcnt(4)
    buffer_load_dwordx4 v55, s[20:23], s29 offen offset:2048 lds
    v_mfma_f32_16x16x32_bf16 v[100:103], a[224:227], a[0:3], v[100:103]
    ds_read_b64_tr_b16 a[192:193], v15 offset:32768
    buffer_store_dwordx4 v[232:235], v45, s[24:27], s3 offen offset:2048 sc1
    v_mfma_f32_16x16x32_bf16 v[100:103], a[228:231], a[12:15], v[100:103]
    ds_read_b64_tr_b16 a[194:195], v15 offset:40960
    v_mfma_f32_16x16x32_bf16 v[164:167], a[228:231], a[16:19], v[164:167]
    buffer_load_dwordx4 v56, s[20:23], s29 offen offset:3072 lds
    buffer_load_dwordx4 a[56:59], v45, s[24:27], s52 offen offset:2048 sc1
    v_mfma_f32_16x16x32_bf16 v[164:167], a[224:227], a[4:7], v[164:167]
    s_load_dwordx4 s[84:87], s[36:37], s48 offset:0 glc
    ds_read_b64_tr_b16 a[196:197], v15 offset:33024
    v_mfma_f32_16x16x32_bf16 v[228:231], a[224:227], a[8:11], v[228:231]
    ds_read_b64_tr_b16 a[198:199], v15 offset:41216
    v_mfma_f32_16x16x32_bf16 v[228:231], a[228:231], a[20:23], v[228:231]
    s_waitcnt lgkmcnt(4)
    v_mfma_f32_16x16x32_bf16 v[236:239], a[232:235], a[8:11], v[236:239]
    ds_read_b64_tr_b16 a[200:201], v17 offset:0
    v_mfma_f32_16x16x32_bf16 v[236:239], a[236:239], a[20:23], v[236:239]
    ds_read_b64_tr_b16 a[202:203], v17 offset:8192
    v_mfma_f32_16x16x32_bf16 v[172:175], a[236:239], a[16:19], v[172:175]
    s_add_u32 s52, s92, 3072
    buffer_load_dwordx4 a[60:63], v45, s[24:27], s52 offen sc1
    v_mfma_f32_16x16x32_bf16 v[172:175], a[232:235], a[4:7], v[172:175]
    ds_read_b64_tr_b16 a[204:205], v17 offset:256
    v_mfma_f32_16x16x32_bf16 v[108:111], a[232:235], a[0:3], v[108:111]
    ds_read_b64_tr_b16 a[206:207], v17 offset:8448
    v_mfma_f32_16x16x32_bf16 v[108:111], a[236:239], a[12:15], v[108:111]
    s_waitcnt lgkmcnt(4)
    v_mfma_f32_16x16x32_bf16 v[116:119], a[192:195], a[0:3], v[116:119]
    ds_read_b64_tr_b16 a[208:209], v18 offset:0
    v_mfma_f32_16x16x32_bf16 v[116:119], a[196:199], a[12:15], v[116:119]
    ds_read_b64_tr_b16 a[210:211], v18 offset:8192
    v_mfma_f32_16x16x32_bf16 v[180:183], a[196:199], a[16:19], v[180:183]
    buffer_load_dwordx4 a[64:67], v45, s[24:27], s52 offen offset:1024 sc1
    v_mfma_f32_16x16x32_bf16 v[180:183], a[192:195], a[4:7], v[180:183]
    ds_read_b64_tr_b16 a[212:213], v18 offset:256
    v_mfma_f32_16x16x32_bf16 v[244:247], a[192:195], a[8:11], v[244:247]
    ds_read_b64_tr_b16 a[214:215], v18 offset:8448
    v_mfma_f32_16x16x32_bf16 v[244:247], a[196:199], a[20:23], v[244:247]
    s_waitcnt lgkmcnt(4)
    s_waitcnt vmcnt(17)
    v_mfma_f32_16x16x32_bf16 v[196:199], a[200:203], a[32:35], v[196:199]
    ds_read_b64_tr_b16 a[216:217], v19 offset:0
    s_waitcnt vmcnt(11)
    v_mfma_f32_16x16x32_bf16 v[196:199], a[204:207], a[44:47], v[196:199]
    ds_read_b64_tr_b16 a[218:219], v19 offset:8192
    v_mfma_f32_16x16x32_bf16 v[132:135], a[204:207], a[40:43], v[132:135]
    buffer_load_dwordx4 a[68:71], v45, s[24:27], s52 offen offset:2048 sc1
    v_mfma_f32_16x16x32_bf16 v[132:135], a[200:203], a[28:31], v[132:135]
    ds_read_b64_tr_b16 a[220:221], v19 offset:256
    v_mfma_f32_16x16x32_bf16 v[68:71], a[200:203], a[24:27], v[68:71]
    ds_read_b64_tr_b16 a[222:223], v19 offset:8448
    v_mfma_f32_16x16x32_bf16 v[68:71], a[204:207], a[36:39], v[68:71]
    s_waitcnt lgkmcnt(4)
    v_mfma_f32_16x16x32_bf16 v[76:79], a[208:211], a[24:27], v[76:79]
    ds_read_b64_tr_b16 a[224:225], v20 offset:0
    v_mfma_f32_16x16x32_bf16 v[76:79], a[212:215], a[36:39], v[76:79]
    ds_read_b64_tr_b16 a[226:227], v20 offset:8192
    v_mfma_f32_16x16x32_bf16 v[140:143], a[212:215], a[40:43], v[140:143]
    v_mfma_f32_16x16x32_bf16 v[140:143], a[208:211], a[28:31], v[140:143]
    ds_read_b64_tr_b16 a[228:229], v20 offset:256
    v_mfma_f32_16x16x32_bf16 v[204:207], a[208:211], a[32:35], v[204:207]
    ds_read_b64_tr_b16 a[230:231], v20 offset:8448
    v_mfma_f32_16x16x32_bf16 v[204:207], a[212:215], a[44:47], v[204:207]
    s_waitcnt lgkmcnt(4)
    v_mfma_f32_16x16x32_bf16 v[212:215], a[216:219], a[32:35], v[212:215]
    ds_read_b64_tr_b16 a[232:233], v21 offset:0
    v_mfma_f32_16x16x32_bf16 v[212:215], a[220:223], a[44:47], v[212:215]
    ds_read_b64_tr_b16 a[234:235], v21 offset:8192
    v_mfma_f32_16x16x32_bf16 v[148:151], a[220:223], a[40:43], v[148:151]
    v_mfma_f32_16x16x32_bf16 v[148:151], a[216:219], a[28:31], v[148:151]
    ds_read_b64_tr_b16 a[236:237], v21 offset:256
    s_min_u32 s33, s84, s85
    s_min_u32 s33, s33, s86
    s_min_u32 s33, s33, s87
    s_cmp_lt_u32 s33, 2
    s_cbranch_scc1 L_q1_spin
L_q1_ok:
    v_mfma_f32_16x16x32_bf16 v[84:87], a[216:219], a[24:27], v[84:87]
    s_add_u32 s52, s89, 6144
    ds_read_b64_tr_b16 a[238:239], v21 offset:8448
    buffer_load_dwordx4 a[72:75], v45, s[24:27], s52 offen sc1
    v_mfma_f32_16x16x32_bf16 v[84:87], a[220:223], a[36:39], v[84:87]
    s_waitcnt lgkmcnt(4)
    v_mfma_f32_16x16x32_bf16 v[92:95], a[224:227], a[24:27], v[92:95]
    ds_read_b64_tr_b16 a[192:193], v22 offset:0
    v_mfma_f32_16x16x32_bf16 v[92:95], a[228:231], a[36:39], v[92:95]
    ds_read_b64_tr_b16 a[194:195], v22 offset:8192
    v_mfma_f32_16x16x32_bf16 v[156:159], a[228:231], a[40:43], v[156:159]
    v_mfma_f32_16x16x32_bf16 v[156:159], a[224:227], a[28:31], v[156:159]
    ds_read_b64_tr_b16 a[196:197], v22 offset:256
    v_mfma_f32_16x16x32_bf16 v[220:223], a[224:227], a[32:35], v[220:223]
    ds_read_b64_tr_b16 a[198:199], v22 offset:8448
    buffer_load_dwordx4 a[76:79], v45, s[24:27], s52 offen offset:1024 sc1
    v_mfma_f32_16x16x32_bf16 v[220:223], a[228:231], a[44:47], v[220:223]
    s_waitcnt lgkmcnt(4)
    v_mfma_f32_16x16x32_bf16 v[228:231], a[232:235], a[32:35], v[228:231]
    ds_read_b64_tr_b16 a[200:201], v23 offset:0
    v_mfma_f32_16x16x32_bf16 v[228:231], a[236:239], a[44:47], v[228:231]
    ds_read_b64_tr_b16 a[202:203], v23 offset:8192
    v_mfma_f32_16x16x32_bf16 v[164:167], a[236:239], a[40:43], v[164:167]
    v_mfma_f32_16x16x32_bf16 v[164:167], a[232:235], a[28:31], v[164:167]
    ds_read_b64_tr_b16 a[204:205], v23 offset:256
    v_mfma_f32_16x16x32_bf16 v[100:103], a[232:235], a[24:27], v[100:103]
    ds_read_b64_tr_b16 a[206:207], v23 offset:8448
    buffer_load_dwordx4 a[80:83], v45, s[24:27], s52 offen offset:2048 sc1
    v_mfma_f32_16x16x32_bf16 v[100:103], a[236:239], a[36:39], v[100:103]
    s_waitcnt lgkmcnt(4)
    v_mfma_f32_16x16x32_bf16 v[108:111], a[192:195], a[24:27], v[108:111]
    ds_read_b64_tr_b16 a[208:209], v1 offset:16384
    v_mfma_f32_16x16x32_bf16 v[108:111], a[196:199], a[36:39], v[108:111]
    ds_read_b64_tr_b16 a[210:211], v1 offset:24576
    v_mfma_f32_16x16x32_bf16 v[172:175], a[196:199], a[40:43], v[172:175]
    v_mfma_f32_16x16x32_bf16 v[172:175], a[192:195], a[28:31], v[172:175]
    ds_read_b64_tr_b16 a[212:213], v1 offset:16640
    v_mfma_f32_16x16x32_bf16 v[236:239], a[192:195], a[32:35], v[236:239]
    s_add_u32 s52, s89, 9216
    ds_read_b64_tr_b16 a[214:215], v1 offset:24832
    buffer_load_dwordx4 a[84:87], v45, s[24:27], s52 offen sc1
    v_mfma_f32_16x16x32_bf16 v[236:239], a[196:199], a[44:47], v[236:239]
    s_waitcnt lgkmcnt(4)
    v_mfma_f32_16x16x32_bf16 v[244:247], a[200:203], a[32:35], v[244:247]
    ds_read_b64_tr_b16 a[216:217], v2 offset:16384
    v_mfma_f32_16x16x32_bf16 v[244:247], a[204:207], a[44:47], v[244:247]
    s_waitcnt vmcnt(9)
    ds_read_b64_tr_b16 a[218:219], v2 offset:24576
    v_mov_b32 v47, 3
    v_mfma_f32_16x16x32_bf16 v[180:183], a[204:207], a[40:43], v[180:183]
    buffer_store_dword v47, v46, s[36:39], s1 offen sc1
    v_mfma_f32_16x16x32_bf16 v[180:183], a[200:203], a[28:31], v[180:183]
    ds_read_b64_tr_b16 a[220:221], v2 offset:16640
    v_mfma_f32_16x16x32_bf16 v[116:119], a[200:203], a[24:27], v[116:119]
    ds_read_b64_tr_b16 a[222:223], v2 offset:24832
    buffer_load_dwordx4 a[88:91], v45, s[24:27], s52 offen offset:1024 sc1
    v_mfma_f32_16x16x32_bf16 v[116:119], a[204:207], a[36:39], v[116:119]
    s_waitcnt lgkmcnt(4)
    s_waitcnt vmcnt(9)
    v_mfma_f32_16x16x32_bf16 v[68:71], a[208:211], a[48:51], v[68:71]
    ds_read_b64_tr_b16 a[224:225], v3 offset:16384
    s_waitcnt vmcnt(6)
    v_mfma_f32_16x16x32_bf16 v[68:71], a[212:215], a[60:63], v[68:71]
    ds_read_b64_tr_b16 a[226:227], v3 offset:24576
    v_mfma_f32_16x16x32_bf16 v[132:135], a[212:215], a[64:67], v[132:135]
    v_mfma_f32_16x16x32_bf16 v[132:135], a[208:211], a[52:55], v[132:135]
    ds_read_b64_tr_b16 a[228:229], v3 offset:16640
    v_mfma_f32_16x16x32_bf16 v[196:199], a[208:211], a[56:59], v[196:199]
    ds_read_b64_tr_b16 a[230:231], v3 offset:24832
    buffer_load_dwordx4 a[92:95], v45, s[24:27], s52 offen offset:2048 sc1
    v_mfma_f32_16x16x32_bf16 v[196:199], a[212:215], a[68:71], v[196:199]
    s_waitcnt lgkmcnt(4)
    v_mfma_f32_16x16x32_bf16 v[204:207], a[216:219], a[56:59], v[204:207]
    ds_read_b64_tr_b16 a[232:233], v4 offset:16384
    v_mfma_f32_16x16x32_bf16 v[204:207], a[220:223], a[68:71], v[204:207]
    ds_read_b64_tr_b16 a[234:235], v4 offset:24576
    v_mfma_f32_16x16x32_bf16 v[140:143], a[220:223], a[64:67], v[140:143]
    v_mfma_f32_16x16x32_bf16 v[140:143], a[216:219], a[52:55], v[140:143]
    ds_read_b64_tr_b16 a[236:237], v4 offset:16640
    v_mfma_f32_16x16x32_bf16 v[76:79], a[216:219], a[48:51], v[76:79]
    s_add_u32 s52, s90, 6144
    ds_read_b64_tr_b16 a[238:239], v4 offset:24832
    buffer_load_dwordx4 a[96:99], v45, s[24:27], s52 offen sc1
    v_mfma_f32_16x16x32_bf16 v[76:79], a[220:223], a[60:63], v[76:79]
    s_waitcnt lgkmcnt(4)
    v_mfma_f32_16x16x32_bf16 v[84:87], a[224:227], a[48:51], v[84:87]
    ds_read_b64_tr_b16 a[192:193], v5 offset:16384
    v_mfma_f32_16x16x32_bf16 v[84:87], a[228:231], a[60:63], v[84:87]
    ds_read_b64_tr_b16 a[194:195], v5 offset:24576
    v_mfma_f32_16x16x32_bf16 v[148:151], a[228:231], a[64:67], v[148:151]
    v_mfma_f32_16x16x32_bf16 v[148:151], a[224:227], a[52:55], v[148:151]
    ds_read_b64_tr_b16 a[196:197], v5 offset:16640
    v_mfma_f32_16x16x32_bf16 v[212:215], a[224:227], a[56:59], v[212:215]
    ds_read_b64_tr_b16 a[198:199], v5 offset:24832
    buffer_load_dwordx4 a[100:103], v45, s[24:27], s52 offen offset:1024 sc1
    v_mfma_f32_16x16x32_bf16 v[212:215], a[228:231], a[68:71], v[212:215]
    s_waitcnt lgkmcnt(4)
    v_mfma_f32_16x16x32_bf16 v[220:223], a[232:235], a[56:59], v[220:223]
    ds_read_b64_tr_b16 a[200:201], v6 offset:16384
    v_mfma_f32_16x16x32_bf16 v[220:223], a[236:239], a[68:71], v[220:223]
    ds_read_b64_tr_b16 a[202:203], v6 offset:24576
    v_mfma_f32_16x16x32_bf16 v[156:159], a[236:239], a[64:67], v[156:159]
    v_mfma_f32_16x16x32_bf16 v[156:159], a[232:235], a[52:55], v[156:159]
    ds_read_b64_tr_b16 a[204:205], v6 offset:16640
    v_mfma_f32_16x16x32_bf16 v[92:95], a[232:235], a[48:51], v[92:95]
    ds_read_b64_tr_b16 a[206:207], v6 offset:24832
    buffer_load_dwordx4 a[104:107], v45, s[24:27], s52 offen offset:2048 sc1
    v_mfma_f32_16x16x32_bf16 v[92:95], a[236:239], a[60:63], v[92:95]
    s_waitcnt lgkmcnt(4)
    v_mfma_f32_16x16x32_bf16 v[100:103], a[192:195], a[48:51], v[100:103]
    ds_read_b64_tr_b16 a[208:209], v7 offset:16384
    v_mfma_f32_16x16x32_bf16 v[100:103], a[196:199], a[60:63], v[100:103]
    ds_read_b64_tr_b16 a[210:211], v7 offset:24576
    v_mfma_f32_16x16x32_bf16 v[164:167], a[196:199], a[64:67], v[164:167]
    v_mfma_f32_16x16x32_bf16 v[164:167], a[192:195], a[52:55], v[164:167]
    ds_read_b64_tr_b16 a[212:213], v7 offset:16640
    v_mfma_f32_16x16x32_bf16 v[228:231], a[192:195], a[56:59], v[228:231]
    s_add_u32 s52, s90, 9216
    ds_read_b64_tr_b16 a[214:215], v7 offset:24832
    buffer_load_dwordx4 a[108:111], v45, s[24:27], s52 offen sc1
    v_mfma_f32_16x16x32_bf16 v[228:231], a[196:199], a[68:71], v[228:231]
    s_waitcnt lgkmcnt(4)
    s_waitcnt vmcnt(47)
    s_add_u32 s3, s88, 18432
    s_barrier
    v_mfma_f32_16x16x32_bf16 v[236:239], a[200:203], a[56:59], v[236:239]
    ds_read_b64_tr_b16 a[216:217], v9 offset:49152
    buffer_store_dwordx4 v[112:115], v45, s[24:27], s3 offen sc1
    v_mfma_f32_16x16x32_bf16 v[236:239], a[204:207], a[68:71], v[236:239]
    ds_read_b64_tr_b16 a[218:219], v9 offset:57344
    v_mfma_f32_16x16x32_bf16 v[172:175], a[204:207], a[64:67], v[172:175]
    v_mfma_f32_16x16x32_bf16 v[172:175], a[200:203], a[52:55], v[172:175]
    ds_read_b64_tr_b16 a[220:221], v9 offset:49408
    v_mfma_f32_16x16x32_bf16 v[108:111], a[200:203], a[48:51], v[108:111]
    ds_read_b64_tr_b16 a[222:223], v9 offset:57600
    buffer_load_dwordx4 a[112:115], v45, s[24:27], s52 offen offset:1024 sc1
    v_mfma_f32_16x16x32_bf16 v[108:111], a[204:207], a[60:63], v[108:111]
    s_waitcnt lgkmcnt(4)
    v_mfma_f32_16x16x32_bf16 v[116:119], a[208:211], a[48:51], v[116:119]
    ds_read_b64_tr_b16 a[224:225], v10 offset:49152
    v_mfma_f32_16x16x32_bf16 v[116:119], a[212:215], a[60:63], v[116:119]
    ds_read_b64_tr_b16 a[226:227], v10 offset:57344
    v_mfma_f32_16x16x32_bf16 v[180:183], a[212:215], a[64:67], v[180:183]
    buffer_store_dwordx4 v[176:179], v45, s[24:27], s3 offen offset:1024 sc1
    v_mfma_f32_16x16x32_bf16 v[180:183], a[208:211], a[52:55], v[180:183]
    ds_read_b64_tr_b16 a[228:229], v10 offset:49408
    v_mfma_f32_16x16x32_bf16 v[244:247], a[208:211], a[56:59], v[244:247]
    ds_read_b64_tr_b16 a[230:231], v10 offset:57600
    buffer_load_dwordx4 a[116:119], v45, s[24:27], s52 offen offset:2048 sc1
    v_mfma_f32_16x16x32_bf16 v[244:247], a[212:215], a[68:71], v[244:247]
    s_waitcnt lgkmcnt(4)
    s_waitcnt vmcnt(12)
    v_mfma_f32_16x16x32_bf16 v[196:199], a[216:219], a[80:83], v[196:199]
    ds_read_b64_tr_b16 a[232:233], v11 offset:49152
    s_waitcnt vmcnt(8)
    v_mfma_f32_16x16x32_bf16 v[196:199], a[220:223], a[92:95], v[196:199]
    ds_read_b64_tr_b16 a[234:235], v11 offset:57344
    v_mfma_f32_16x16x32_bf16 v[132:135], a[220:223], a[88:91], v[132:135]
    v_mfma_f32_16x16x32_bf16 v[132:135], a[216:219], a[76:79], v[132:135]
    ds_read_b64_tr_b16 a[236:237], v11 offset:49408
    v_mfma_f32_16x16x32_bf16 v[68:71], a[216:219], a[72:75], v[68:71]
    s_add_u32 s52, s92, 6144
    ds_read_b64_tr_b16 a[238:239], v11 offset:57600
    buffer_store_dwordx4 v[240:243], v45, s[24:27], s3 offen offset:2048 sc1
    v_mfma_f32_16x16x32_bf16 v[68:71], a[220:223], a[84:87], v[68:71]
    s_waitcnt lgkmcnt(4)
    buffer_load_dwordx4 a[120:123], v45, s[24:27], s52 offen sc1
    v_mfma_f32_16x16x32_bf16 v[76:79], a[224:227], a[72:75], v[76:79]
    ds_read_b64_tr_b16 a[192:193], v12 offset:49152
    v_mfma_f32_16x16x32_bf16 v[76:79], a[228:231], a[84:87], v[76:79]
    ds_read_b64_tr_b16 a[194:195], v12 offset:57344
    v_mfma_f32_16x16x32_bf16 v[140:143], a[228:231], a[88:91], v[140:143]
    v_mfma_f32_16x16x32_bf16 v[140:143], a[224:227], a[76:79], v[140:143]
    s_add_u32 m0, s28, 147456
    ds_read_b64_tr_b16 a[196:197], v12 offset:49408
    v_mfma_f32_16x16x32_bf16 v[204:207], a[224:227], a[80:83], v[204:207]
    s_add_u32 s29, s92, s95
    ds_read_b64_tr_b16 a[198:199], v12 offset:57600
    v_mfma_f32_16x16x32_bf16 v[204:207], a[228:231], a[92:95], v[204:207]
    s_waitcnt lgkmcnt(4)
    buffer_load_dwordx4 v53, s[20:23], s29 offen lds
    buffer_load_dwordx4 a[124:127], v45, s[24:27], s52 offen offset:1024 sc1
    v_mfma_f32_16x16x32_bf16 v[212:215], a[232:235], a[80:83], v[212:215]
    ds_read_b64_tr_b16 a[200:201], v13 offset:49152
    v_mfma_f32_16x16x32_bf16 v[212:215], a[236:239], a[92:95], v[212:215]
    s_add_u32 s3, s88, 21504
    ds_read_b64_tr_b16 a[202:203], v13 offset:57344
    buffer_store_dwordx4 v[120:123], v45, s[24:27], s3 offen sc1
    v_mfma_f32_16x16x32_bf16 v[148:151], a[236:239], a[88:91], v[148:151]
    buffer_load_dwordx4 v54, s[20:23], s29 offen offset:1024 lds
    v_mfma_f32_16x16x32_bf16 v[148:151], a[232:235], a[76:79], v[148:151]
    ds_read_b64_tr_b16 a[204:205], v13 offset:49408
    v_mfma_f32_16x16x32_bf16 v[84:87], a[232:235], a[72:75], v[84:87]
    ds_read_b64_tr_b16 a[206:207], v13 offset:57600
    v_mfma_f32_16x16x32_bf16 v[84:87], a[236:239], a[84:87], v[84:87]
    s_waitcnt lgkmcnt(4)
    buffer_load_dwordx4 v55, s[20:23], s29 offen offset:2048 lds
    buffer_load_dwordx4 a[128:131], v45, s[24:27], s52 offen offset:2048 sc1
    v_mfma_f32_16x16x32_bf16 v[92:95], a[192:195], a[72:75], v[92:95]
    ds_read_b64_tr_b16 a[208:209], v14 offset:49152
    v_mfma_f32_16x16x32_bf16 v[92:95], a[196:199], a[84:87], v[92:95]
    ds_read_b64_tr_b16 a[210:211], v14 offset:57344
    v_mfma_f32_16x16x32_bf16 v[156:159], a[196:199], a[88:91], v[156:159]
    buffer_load_dwordx4 v56, s[20:23], s29 offen offset:3072 lds
    v_mfma_f32_16x16x32_bf16 v[156:159], a[192:195], a[76:79], v[156:159]
    ds_read_b64_tr_b16 a[212:213], v14 offset:49408
    buffer_store_dwordx4 v[184:187], v45, s[24:27], s3 offen offset:1024 sc1
    v_mfma_f32_16x16x32_bf16 v[220:223], a[192:195], a[80:83], v[220:223]
    ds_read_b64_tr_b16 a[214:215], v14 offset:57600
    v_mfma_f32_16x16x32_bf16 v[220:223], a[196:199], a[92:95], v[220:223]
    s_waitcnt lgkmcnt(4)
    s_add_u32 s52, s92, 9216
    buffer_load_dwordx4 a[132:135], v45, s[24:27], s52 offen sc1
    v_mfma_f32_16x16x32_bf16 v[228:231], a[200:203], a[80:83], v[228:231]
    ds_read_b64_tr_b16 a[216:217], v15 offset:49152
    v_mfma_f32_16x16x32_bf16 v[228:231], a[204:207], a[92:95], v[228:231]
    ds_read_b64_tr_b16 a[218:219], v15 offset:57344
    v_mfma_f32_16x16x32_bf16 v[164:167], a[204:207], a[88:91], v[164:167]
    s_load_dwordx4 s[84:87], s[36:37], s48 offset:0 glc
    v_mfma_f32_16x16x32_bf16 v[164:167], a[200:203], a[76:79], v[164:167]
    ds_read_b64_tr_b16 a[220:221], v15 offset:49408
    v_mfma_f32_16x16x32_bf16 v[100:103], a[200:203], a[72:75], v[100:103]
    ds_read_b64_tr_b16 a[222:223], v15 offset:57600
    v_mfma_f32_16x16x32_bf16 v[100:103], a[204:207], a[84:87], v[100:103]
    s_waitcnt lgkmcnt(4)
    buffer_store_dwordx4 v[248:251], v45, s[24:27], s3 offen offset:2048 sc1
    buffer_load_dwordx4 a[136:139], v45, s[24:27], s52 offen offset:1024 sc1
    v_mfma_f32_16x16x32_bf16 v[108:111], a[208:211], a[72:75], v[108:111]
    ds_read_b64_tr_b16 a[224:225], v1 offset:0
    v_mfma_f32_16x16x32_bf16 v[108:111], a[212:215], a[84:87], v[108:111]
    ds_read_b64_tr_b16 a[226:227], v1 offset:8192
    v_mfma_f32_16x16x32_bf16 v[172:175], a[212:215], a[88:91], v[172:175]
    v_mfma_f32_16x16x32_bf16 v[172:175], a[208:211], a[76:79], v[172:175]
    ds_read_b64_tr_b16 a[228:229], v1 offset:256
    v_mfma_f32_16x16x32_bf16 v[236:239], a[208:211], a[80:83], v[236:239]
    ds_read_b64_tr_b16 a[230:231], v1 offset:8448
    v_mfma_f32_16x16x32_bf16 v[236:239], a[212:215], a[92:95], v[236:239]
    s_waitcnt lgkmcnt(4)
    buffer_load_dwordx4 a[140:143], v45, s[24:27], s52 offen offset:2048 sc1
    v_mfma_f32_16x16x32_bf16 v[244:247], a[216:219], a[80:83], v[244:247]
    ds_read_b64_tr_b16 a[232:233], v2 offset:0
    v_mfma_f32_16x16x32_bf16 v[244:247], a[220:223], a[92:95], v[244:247]
    ds_read_b64_tr_b16 a[234:235], v2 offset:8192
    v_mfma_f32_16x16x32_bf16 v[180:183], a[220:223], a[88:91], v[180:183]
    v_mfma_f32_16x16x32_bf16 v[180:183], a[216:219], a[76:79], v[180:183]
    ds_read_b64_tr_b16 a[236:237], v2 offset:256
    v_mfma_f32_16x16x32_bf16 v[116:119], a[216:219], a[72:75], v[116:119]
    ds_read_b64_tr_b16 a[238:239], v2 offset:8448
    v_mfma_f32_16x16x32_bf16 v[116:119], a[220:223], a[84:87], v[116:119]
    s_waitcnt lgkmcnt(4)
    s_waitcnt vmcnt(19)
    v_mfma_f32_16x16x32_bf16 v[68:71], a[224:227], a[96:99], v[68:71]
    ds_read_b64_tr_b16 a[192:193], v3 offset:0
    s_waitcnt vmcnt(14)
    v_mfma_f32_16x16x32_bf16 v[68:71], a[228:231], a[108:111], v[68:71]
    ds_read_b64_tr_b16 a[194:195], v3 offset:8192
    v_mfma_f32_16x16x32_bf16 v[132:135], a[228:231], a[112:115], v[132:135]
    v_mfma_f32_16x16x32_bf16 v[132:135], a[224:227], a[100:103], v[132:135]
    ds_read_b64_tr_b16 a[196:197], v3 offset:256
    v_mfma_f32_16x16x32_bf16 v[196:199], a[224:227], a[104:107], v[196:199]
    ds_read_b64_tr_b16 a[198:199], v3 offset:8448
    v_mfma_f32_16x16x32_bf16 v[196:199], a[228:231], a[116:119], v[196:199]
    s_waitcnt lgkmcnt(4)
    v_mfma_f32_16x16x32_bf16 v[204:207], a[232:235], a[104:107], v[204:207]
    ds_read_b64_tr_b16 a[200:201], v4 offset:0
    v_mfma_f32_16x16x32_bf16 v[204:207], a[236:239], a[116:119], v[204:207]
    ds_read_b64_tr_b16 a[202:203], v4 offset:8192
    v_mfma_f32_16x16x32_bf16 v[140:143], a[236:239], a[112:115], v[140:143]
    v_mfma_f32_16x16x32_bf16 v[140:143], a[232:235], a[100:103], v[140:143]
    ds_read_b64_tr_b16 a[204:205], v4 offset:256
    v_mfma_f32_16x16x32_bf16 v[76:79], a[232:235], a[96:99], v[76:79]
    ds_read_b64_tr_b16 a[206:207], v4 offset:8448
    v_mfma_f32_16x16x32_bf16 v[76:79], a[236:239], a[108:111], v[76:79]
    s_waitcnt lgkmcnt(4)
    v_mfma_f32_16x16x32_bf16 v[84:87], a[192:195], a[96:99], v[84:87]
    ds_read_b64_tr_b16 a[208:209], v5 offset:0
    v_mfma_f32_16x16x32_bf16 v[84:87], a[196:199], a[108:111], v[84:87]
    ds_read_b64_tr_b16 a[210:211], v5 offset:8192
    v_mfma_f32_16x16x32_bf16 v[148:151], a[196:199], a[112:115], v[148:151]
    s_min_u32 s33, s84, s85
    s_min_u32 s33, s33, s86
    s_min_u32 s33, s33, s87
    s_cmp_lt_u32 s33, 3
    s_cbranch_scc1 L_q2_spin
L_q2_ok:
    v_mfma_f32_16x16x32_bf16 v[148:151], a[192:195], a[100:103], v[148:151]
    s_add_u32 s52, s89, 12288
    ds_read_b64_tr_b16 a[212:213], v5 offset:256
    buffer_load_dwordx4 a[144:147], v45, s[24:27], s52 offen sc1
    v_mfma_f32_16x16x32_bf16 v[212:215], a[192:195], a[104:107], v[212:215]
    ds_read_b64_tr_b16 a[214:215], v5 offset:8448
    v_mfma_f32_16x16x32_bf16 v[212:215], a[196:199], a[116:119], v[212:215]
    s_waitcnt lgkmcnt(4)
    v_mfma_f32_16x16x32_bf16 v[220:223], a[200:203], a[104:107], v[220:223]
    ds_read_b64_tr_b16 a[216:217], v6 offset:0
    v_mfma_f32_16x16x32_bf16 v[220:223], a[204:207], a[116:119], v[220:223]
    ds_read_b64_tr_b16 a[218:219], v6 offset:8192
    v_mfma_f32_16x16x32_bf16 v[156:159], a[204:207], a[112:115], v[156:159]
    v_mfma_f32_16x16x32_bf16 v[156:159], a[200:203], a[100:103], v[156:159]
    ds_read_b64_tr_b16 a[220:221], v6 offset:256
    buffer_load_dwordx4 a[148:151], v45, s[24:27], s52 offen offset:1024 sc1
    v_mfma_f32_16x16x32_bf16 v[92:95], a[200:203], a[96:99], v[92:95]
    ds_read_b64_tr_b16 a[222:223], v6 offset:8448
    v_mfma_f32_16x16x32_bf16 v[92:95], a[204:207], a[108:111], v[92:95]
    s_waitcnt lgkmcnt(4)
    v_mfma_f32_16x16x32_bf16 v[100:103], a[208:211], a[96:99], v[100:103]
    ds_read_b64_tr_b16 a[224:225], v7 offset:0
    v_mfma_f32_16x16x32_bf16 v[100:103], a[212:215], a[108:111], v[100:103]
    ds_read_b64_tr_b16 a[226:227], v7 offset:8192
    v_mfma_f32_16x16x32_bf16 v[164:167], a[212:215], a[112:115], v[164:167]
    v_mfma_f32_16x16x32_bf16 v[164:167], a[208:211], a[100:103], v[164:167]
    ds_read_b64_tr_b16 a[228:229], v7 offset:256
    buffer_load_dwordx4 a[152:155], v45, s[24:27], s52 offen offset:2048 sc1
    v_mfma_f32_16x16x32_bf16 v[228:231], a[208:211], a[104:107], v[228:231]
    ds_read_b64_tr_b16 a[230:231], v7 offset:8448
    v_mfma_f32_16x16x32_bf16 v[228:231], a[212:215], a[116:119], v[228:231]
    s_waitcnt lgkmcnt(4)
    v_mfma_f32_16x16x32_bf16 v[236:239], a[216:219], a[104:107], v[236:239]
    ds_read_b64_tr_b16 a[232:233], v1 offset:32768
    v_mfma_f32_16x16x32_bf16 v[236:239], a[220:223], a[116:119], v[236:239]
    ds_read_b64_tr_b16 a[234:235], v1 offset:40960
    v_mfma_f32_16x16x32_bf16 v[172:175], a[220:223], a[112:115], v[172:175]
    v_mfma_f32_16x16x32_bf16 v[172:175], a[216:219], a[100:103], v[172:175]
    s_add_u32 s52, s89, 15360
    ds_read_b64_tr_b16 a[236:237], v1 offset:33024
    buffer_load_dwordx4 a[156:159], v45, s[24:27], s52 offen sc1
    v_mfma_f32_16x16x32_bf16 v[108:111], a[216:219], a[96:99], v[108:111]
    ds_read_b64_tr_b16 a[238:239], v1 offset:41216
    v_mfma_f32_16x16x32_bf16 v[108:111], a[220:223], a[108:111], v[108:111]
    s_waitcnt lgkmcnt(4)
    v_mfma_f32_16x16x32_bf16 v[116:119], a[224:227], a[96:99], v[116:119]
    ds_read_b64_tr_b16 a[192:193], v2 offset:32768
    v_mfma_f32_16x16x32_bf16 v[116:119], a[228:231], a[108:111], v[116:119]
    ds_read_b64_tr_b16 a[194:195], v2 offset:40960
    v_mfma_f32_16x16x32_bf16 v[180:183], a[228:231], a[112:115], v[180:183]
    v_mfma_f32_16x16x32_bf16 v[180:183], a[224:227], a[100:103], v[180:183]
    ds_read_b64_tr_b16 a[196:197], v2 offset:33024
    buffer_load_dwordx4 a[160:163], v45, s[24:27], s52 offen offset:1024 sc1
    v_mfma_f32_16x16x32_bf16 v[244:247], a[224:227], a[104:107], v[244:247]
    ds_read_b64_tr_b16 a[198:199], v2 offset:41216
    v_mfma_f32_16x16x32_bf16 v[244:247], a[228:231], a[116:119], v[244:247]
    s_waitcnt lgkmcnt(4)
    s_waitcnt vmcnt(11)
    v_mfma_f32_16x16x32_bf16 v[196:199], a[232:235], a[128:131], v[196:199]
    s_waitcnt vmcnt(7)
    ds_read_b64_tr_b16 a[200:201], v3 offset:32768
    v_mov_b32 v47, 4
    s_waitcnt vmcnt(5)
    v_mfma_f32_16x16x32_bf16 v[196:199], a[236:239], a[140:143], v[196:199]
    ds_read_b64_tr_b16 a[202:203], v3 offset:40960
    buffer_store_dword v47, v46, s[36:39], s1 offen sc1
    v_mfma_f32_16x16x32_bf16 v[132:135], a[236:239], a[136:139], v[132:135]
    v_lshlrev_b32 v34, 16, v57
    v_lshlrev_b32 v35, 3, v57
    v_mfma_f32_16x16x32_bf16 v[132:135], a[232:235], a[124:127], v[132:135]
    ds_read_b64_tr_b16 a[204:205], v3 offset:33024
    buffer_load_dwordx4 a[164:167], v45, s[24:27], s52 offen offset:2048 sc1
    v_mfma_f32_16x16x32_bf16 v[68:71], a[232:235], a[120:123], v[68:71]
    ds_read_b64_tr_b16 a[206:207], v3 offset:41216
    v_and_b32 v37, 15, v57
    v_mfma_f32_16x16x32_bf16 v[68:71], a[236:239], a[132:135], v[68:71]
    s_waitcnt lgkmcnt(4)
    v_mul_u32_u24 v36, 1792, v37
    v_lshrrev_b32 v38, 4, v57
    v_mfma_f32_16x16x32_bf16 v[76:79], a[192:195], a[120:123], v[76:79]
    ds_read_b64_tr_b16 a[208:209], v4 offset:32768
    v_lshl_add_u32 v36, v38, 3, v36
    v_mfma_f32_16x16x32_bf16 v[76:79], a[196:199], a[132:135], v[76:79]
    ds_read_b64_tr_b16 a[210:211], v4 offset:40960
    v_lshrrev_b32 v37, 1, v37
    v_mfma_f32_16x16x32_bf16 v[140:143], a[196:199], a[136:139], v[140:143]
    v_lshlrev_b32 v38, 1, v38
    v_xor_b32 v37, v37, v38
    v_mfma_f32_16x16x32_bf16 v[140:143], a[192:195], a[124:127], v[140:143]
    s_add_u32 s52, s90, 12288
    ds_read_b64_tr_b16 a[212:213], v4 offset:33024
    buffer_load_dwordx4 a[168:171], v45, s[24:27], s52 offen sc1
    v_mfma_f32_16x16x32_bf16 v[204:207], a[192:195], a[128:131], v[204:207]
    ds_read_b64_tr_b16 a[214:215], v4 offset:41216
    v_and_b32 v38, 1, v57
    v_mfma_f32_16x16x32_bf16 v[204:207], a[196:199], a[140:143], v[204:207]
    s_waitcnt lgkmcnt(4)
    v_lshlrev_b32 v38, 4, v38
    v_lshlrev_b32 v38, v38, s51
    v_mfma_f32_16x16x32_bf16 v[212:215], a[200:203], a[128:131], v[212:215]
    ds_read_b64_tr_b16 a[216:217], v5 offset:32768
    v_mov_b32 v32, 0
    v_mfma_f32_16x16x32_bf16 v[212:215], a[204:207], a[140:143], v[212:215]
    ds_read_b64_tr_b16 a[218:219], v5 offset:40960
    v_mov_b32 v33, 0
    v_mfma_f32_16x16x32_bf16 v[148:151], a[204:207], a[136:139], v[148:151]
    v_cmp_eq_u32 vcc, 0, v37
    s_nop 1
    v_cndmask_b32 v30, 0, v38, vcc
    v_mfma_f32_16x16x32_bf16 v[148:151], a[200:203], a[124:127], v[148:151]
    ds_read_b64_tr_b16 a[220:221], v5 offset:33024
    buffer_load_dwordx4 a[172:175], v45, s[24:27], s52 offen offset:1024 sc1
    v_mfma_f32_16x16x32_bf16 v[84:87], a[200:203], a[120:123], v[84:87]
    ds_read_b64_tr_b16 a[222:223], v5 offset:41216
    v_cmp_eq_u32 vcc, 1, v37
    v_mfma_f32_16x16x32_bf16 v[84:87], a[204:207], a[132:135], v[84:87]
    s_waitcnt lgkmcnt(4)
    v_cndmask_b32 v31, 0, v38, vcc
    v_lshrrev_b32 v40, 4, v57
    v_mfma_f32_16x16x32_bf16 v[92:95], a[208:211], a[120:123], v[92:95]
    ds_read_b64_tr_b16 a[224:225], v6 offset:32768
    v_lshl_add_u32 v39, v40, 3, v36
    v_mfma_f32_16x16x32_bf16 v[92:95], a[212:215], a[132:135], v[92:95]
    ds_read_b64_tr_b16 a[226:227], v6 offset:40960
    v_lshlrev_b32 v40, 2, v40
    v_mfma_f32_16x16x32_bf16 v[156:159], a[212:215], a[136:139], v[156:159]
    v_and_b32 v41, 4, v57
    v_lshlrev_b32 v41, 1, v41
    v_mfma_f32_16x16x32_bf16 v[156:159], a[208:211], a[124:127], v[156:159]
    ds_read_b64_tr_b16 a[228:229], v6 offset:33024
    buffer_load_dwordx4 a[176:179], v45, s[24:27], s52 offen offset:2048 sc1
    v_mfma_f32_16x16x32_bf16 v[220:223], a[208:211], a[128:131], v[220:223]
    ds_read_b64_tr_b16 a[230:231], v6 offset:41216
    v_xor_b32 v40, v40, v41
    v_mfma_f32_16x16x32_bf16 v[220:223], a[212:215], a[140:143], v[220:223]
    s_waitcnt lgkmcnt(4)
    v_bfe_u32 v41, v57, 3, 1
    v_lshl_add_u32 v40, v41, 1, v40
    v_mfma_f32_16x16x32_bf16 v[228:231], a[216:219], a[128:131], v[228:231]
    ds_read_b64_tr_b16 a[232:233], v7 offset:32768
    v_bfe_u32 v41, v57, 1, 1
    v_mfma_f32_16x16x32_bf16 v[228:231], a[220:223], a[140:143], v[228:231]
    ds_read_b64_tr_b16 a[234:235], v7 offset:40960
    v_add_u32 v40, v40, v41
    v_mfma_f32_16x16x32_bf16 v[164:167], a[220:223], a[136:139], v[164:167]
    v_cmp_eq_u32 vcc, 0, v40
    s_nop 1
    v_cndmask_b32 v160, 0, v38, vcc
    v_mfma_f32_16x16x32_bf16 v[164:167], a[216:219], a[124:127], v[164:167]
    s_add_u32 s52, s90, 15360
    ds_read_b64_tr_b16 a[236:237], v7 offset:33024
    buffer_load_dwordx4 a[180:183], v45, s[24:27], s52 offen sc1
    v_mfma_f32_16x16x32_bf16 v[100:103], a[216:219], a[120:123], v[100:103]
    ds_read_b64_tr_b16 a[238:239], v7 offset:41216
    v_cmp_eq_u32 vcc, 1, v40
    v_mfma_f32_16x16x32_bf16 v[100:103], a[220:223], a[132:135], v[100:103]
    s_waitcnt lgkmcnt(4)
    s_waitcnt vmcnt(44)
    s_barrier
    v_mfma_f32_16x16x32_bf16 v[108:111], a[224:227], a[120:123], v[108:111]
    ds_read_b64_tr_b16 a[192:193], v1 offset:49152
    v_cndmask_b32 v161, 0, v38, vcc
    v_mfma_f32_16x16x32_bf16 v[108:111], a[228:231], a[132:135], v[108:111]
    ds_read_b64_tr_b16 a[194:195], v1 offset:57344
    v_cmp_eq_u32 vcc, 2, v40
    v_mfma_f32_16x16x32_bf16 v[172:175], a[228:231], a[136:139], v[172:175]
    s_nop 0
    v_cndmask_b32 v162, 0, v38, vcc
    v_cmp_eq_u32 vcc, 3, v40
    v_mfma_f32_16x16x32_bf16 v[172:175], a[224:227], a[124:127], v[172:175]
    ds_read_b64_tr_b16 a[196:197], v1 offset:49408
    buffer_load_dwordx4 a[184:187], v45, s[24:27], s52 offen offset:1024 sc1
    v_mfma_f32_16x16x32_bf16 v[236:239], a[224:227], a[128:131], v[236:239]
    ds_read_b64_tr_b16 a[198:199], v1 offset:57600
    v_cndmask_b32 v163, 0, v38, vcc
    v_mfma_f32_16x16x32_bf16 v[236:239], a[228:231], a[140:143], v[236:239]
    s_waitcnt lgkmcnt(4)
    v_cmp_eq_u32 vcc, 4, v40
    s_nop 1
    v_cndmask_b32 v168, 0, v38, vcc
    v_mfma_f32_16x16x32_bf16 v[244:247], a[232:235], a[128:131], v[244:247]
    ds_read_b64_tr_b16 a[200:201], v2 offset:49152
    v_cmp_eq_u32 vcc, 5, v40
    v_mfma_f32_16x16x32_bf16 v[244:247], a[236:239], a[140:143], v[244:247]
    ds_read_b64_tr_b16 a[202:203], v2 offset:57344
    v_cndmask_b32 v169, 0, v38, vcc
    v_mfma_f32_16x16x32_bf16 v[180:183], a[236:239], a[136:139], v[180:183]
    v_cmp_eq_u32 vcc, 6, v40
    s_nop 1
    v_cndmask_b32 v170, 0, v38, vcc
    v_mfma_f32_16x16x32_bf16 v[180:183], a[232:235], a[124:127], v[180:183]
    ds_read_b64_tr_b16 a[204:205], v2 offset:49408
    buffer_load_dwordx4 a[188:191], v45, s[24:27], s52 offen offset:2048 sc1
    v_mfma_f32_16x16x32_bf16 v[116:119], a[232:235], a[120:123], v[116:119]
    ds_read_b64_tr_b16 a[206:207], v2 offset:57600
    v_cmp_eq_u32 vcc, 7, v40
    v_mfma_f32_16x16x32_bf16 v[116:119], a[236:239], a[132:135], v[116:119]
    s_waitcnt lgkmcnt(4)
    v_cndmask_b32 v171, 0, v38, vcc
    s_waitcnt vmcnt(10)
    v_mfma_f32_16x16x32_bf16 v[68:71], a[192:195], a[144:147], v[68:71]
    s_lshr_b32 s62, s59, 2
    ds_read_b64_tr_b16 a[208:209], v3 offset:49152
    v_mov_b32 v90, 0
    s_waitcnt vmcnt(6)
    v_mfma_f32_16x16x32_bf16 v[68:71], a[196:199], a[156:159], v[68:71]
    ds_read_b64_tr_b16 a[210:211], v3 offset:57344
    v_mov_b32 v91, 0
    s_cmp_eq_u32 s62, s58
    s_cselect_b32 s96, 1073741824, s96
    v_mfma_f32_16x16x32_bf16 v[132:135], a[196:199], a[160:163], v[132:135]
    v_mov_b32 v154, 0
    v_mov_b32 v155, 0
    v_mfma_f32_16x16x32_bf16 v[132:135], a[192:195], a[148:151], v[132:135]
    s_add_u32 s52, s92, 12288
    ds_read_b64_tr_b16 a[212:213], v3 offset:49408
    buffer_load_dwordx4 a[0:3], v45, s[24:27], s52 offen sc1
    v_mfma_f32_16x16x32_bf16 v[196:199], a[192:195], a[152:155], v[196:199]
    ds_read_b64_tr_b16 a[214:215], v3 offset:57600
    v_mov_b32 v218, 0
    v_mfma_f32_16x16x32_bf16 v[196:199], a[196:199], a[164:167], v[196:199]
    s_waitcnt lgkmcnt(4)
    v_mov_b32 v219, 0
    v_mov_b32 v122, 0
    v_mfma_f32_16x16x32_bf16 v[204:207], a[200:203], a[152:155], v[204:207]
    s_add_u32 m0, s28, 65536
    ds_read_b64_tr_b16 a[216:217], v4 offset:49152
    v_mov_b32 v123, 0
    v_mfma_f32_16x16x32_bf16 v[204:207], a[204:207], a[164:167], v[204:207]
    s_add_u32 s29, s89, s0
    ds_read_b64_tr_b16 a[218:219], v4 offset:57344
    v_mfma_f32_16x16x32_bf16 v[140:143], a[204:207], a[160:163], v[140:143]
    buffer_load_dwordx4 v53, s[20:23], s29 offen lds
    v_mfma_f32_16x16x32_bf16 v[140:143], a[200:203], a[148:151], v[140:143]
    ds_read_b64_tr_b16 a[220:221], v4 offset:49408
    buffer_load_dwordx4 a[4:7], v45, s[24:27], s52 offen offset:1024 sc1
    v_mfma_f32_16x16x32_bf16 v[76:79], a[200:203], a[144:147], v[76:79]
    ds_read_b64_tr_b16 a[222:223], v4 offset:57600
    v_mfma_f32_16x16x32_bf16 v[76:79], a[204:207], a[156:159], v[76:79]
    s_waitcnt lgkmcnt(4)
    buffer_load_dwordx4 v54, s[20:23], s29 offen offset:1024 lds
    v_mfma_f32_16x16x32_bf16 v[84:87], a[208:211], a[144:147], v[84:87]
    ds_read_b64_tr_b16 a[224:225], v5 offset:49152
    v_mfma_f32_16x16x32_bf16 v[84:87], a[212:215], a[156:159], v[84:87]
    ds_read_b64_tr_b16 a[226:227], v5 offset:57344
    v_mfma_f32_16x16x32_bf16 v[148:151], a[212:215], a[160:163], v[148:151]
    buffer_load_dwordx4 v55, s[20:23], s29 offen offset:2048 lds
    v_mfma_f32_16x16x32_bf16 v[148:151], a[208:211], a[148:151], v[148:151]
    ds_read_b64_tr_b16 a[228:229], v5 offset:49408
    buffer_load_dwordx4 a[8:11], v45, s[24:27], s52 offen offset:2048 sc1
    v_mfma_f32_16x16x32_bf16 v[212:215], a[208:211], a[152:155], v[212:215]
    ds_read_b64_tr_b16 a[230:231], v5 offset:57600
    v_mfma_f32_16x16x32_bf16 v[212:215], a[212:215], a[164:167], v[212:215]
    s_waitcnt lgkmcnt(4)
    buffer_load_dwordx4 v56, s[20:23], s29 offen offset:3072 lds
    v_mfma_f32_16x16x32_bf16 v[220:223], a[216:219], a[152:155], v[220:223]
    ds_read_b64_tr_b16 a[232:233], v6 offset:49152
    v_mfma_f32_16x16x32_bf16 v[220:223], a[220:223], a[164:167], v[220:223]
    ds_read_b64_tr_b16 a[234:235], v6 offset:57344
    v_mfma_f32_16x16x32_bf16 v[156:159], a[220:223], a[160:163], v[156:159]
    v_mfma_f32_16x16x32_bf16 v[156:159], a[216:219], a[148:151], v[156:159]
    s_add_u32 s52, s92, 15360
    ds_read_b64_tr_b16 a[236:237], v6 offset:49408
    buffer_load_dwordx4 a[12:15], v45, s[24:27], s52 offen sc1
    v_mfma_f32_16x16x32_bf16 v[92:95], a[216:219], a[144:147], v[92:95]
    ds_read_b64_tr_b16 a[238:239], v6 offset:57600
    v_mfma_f32_16x16x32_bf16 v[92:95], a[220:223], a[156:159], v[92:95]
    s_waitcnt lgkmcnt(4)
    v_mfma_f32_16x16x32_bf16 v[100:103], a[224:227], a[144:147], v[100:103]
    ds_read_b64_tr_b16 a[192:193], v7 offset:49152
    v_mfma_f32_16x16x32_bf16 v[100:103], a[228:231], a[156:159], v[100:103]
    s_load_dwordx4 s[84:87], s[36:37], s48 offset:0 glc
    ds_read_b64_tr_b16 a[194:195], v7 offset:57344
    v_mfma_f32_16x16x32_bf16 v[164:167], a[228:231], a[160:163], v[164:167]
    v_mfma_f32_16x16x32_bf16 v[164:167], a[224:227], a[148:151], v[164:167]
    ds_read_b64_tr_b16 a[196:197], v7 offset:49408
    buffer_load_dwordx4 a[16:19], v45, s[24:27], s52 offen offset:1024 sc1
    v_mfma_f32_16x16x32_bf16 v[228:231], a[224:227], a[152:155], v[228:231]
    ds_read_b64_tr_b16 a[198:199], v7 offset:57600
    v_mfma_f32_16x16x32_bf16 v[228:231], a[228:231], a[164:167], v[228:231]
    s_waitcnt lgkmcnt(4)
    v_mfma_f32_16x16x32_bf16 v[236:239], a[232:235], a[152:155], v[236:239]
    s_add_u32 m0, s28, 98304
    ds_read_b64_tr_b16 a[200:201], v9 offset:16384
    v_mfma_f32_16x16x32_bf16 v[236:239], a[236:239], a[164:167], v[236:239]
    s_add_u32 s29, s90, s0
    ds_read_b64_tr_b16 a[202:203], v9 offset:24576
    v_mfma_f32_16x16x32_bf16 v[172:175], a[236:239], a[160:163], v[172:175]
    buffer_load_dwordx4 v53, s[20:23], s29 offen lds
    v_mfma_f32_16x16x32_bf16 v[172:175], a[232:235], a[148:151], v[172:175]
    ds_read_b64_tr_b16 a[204:205], v9 offset:16640
    buffer_load_dwordx4 a[20:23], v45, s[24:27], s52 offen offset:2048 sc1
    v_mfma_f32_16x16x32_bf16 v[108:111], a[232:235], a[144:147], v[108:111]
    ds_read_b64_tr_b16 a[206:207], v9 offset:24832
    v_mfma_f32_16x16x32_bf16 v[108:111], a[236:239], a[156:159], v[108:111]
    s_waitcnt lgkmcnt(4)
    buffer_load_dwordx4 v54, s[20:23], s29 offen offset:1024 lds
    v_mfma_f32_16x16x32_bf16 v[116:119], a[192:195], a[144:147], v[116:119]
    ds_read_b64_tr_b16 a[208:209], v10 offset:16384
    v_mfma_f32_16x16x32_bf16 v[116:119], a[196:199], a[156:159], v[116:119]
    ds_read_b64_tr_b16 a[210:211], v10 offset:24576
    v_mfma_f32_16x16x32_bf16 v[180:183], a[196:199], a[160:163], v[180:183]
    buffer_load_dwordx4 v55, s[20:23], s29 offen offset:2048 lds
    v_mfma_f32_16x16x32_bf16 v[180:183], a[192:195], a[148:151], v[180:183]
    ds_read_b64_tr_b16 a[212:213], v10 offset:16640
    v_mfma_f32_16x16x32_bf16 v[244:247], a[192:195], a[152:155], v[244:247]
    ds_read_b64_tr_b16 a[214:215], v10 offset:24832
    v_mfma_f32_16x16x32_bf16 v[244:247], a[196:199], a[164:167], v[244:247]
    s_waitcnt lgkmcnt(4)
    buffer_load_dwordx4 v56, s[20:23], s29 offen offset:3072 lds
    s_waitcnt vmcnt(17)
    v_mfma_f32_16x16x32_bf16 v[196:199], a[200:203], a[176:179], v[196:199]
    s_add_u32 s53, s96, 0
    ds_read_b64_tr_b16 a[216:217], v11 offset:16384
    s_waitcnt vmcnt(14)
    v_mfma_f32_16x16x32_bf16 v[196:199], a[204:207], a[188:191], v[196:199]
    s_add_u32 s54, s96, 4096
    ds_read_b64_tr_b16 a[218:219], v11 offset:24576
    v_mfma_f32_16x16x32_bf16 v[132:135], a[204:207], a[184:187], v[132:135]
    s_add_u32 s55, s96, 8192
    v_mfma_f32_16x16x32_bf16 v[132:135], a[200:203], a[172:175], v[132:135]
    ds_read_b64_tr_b16 a[220:221], v11 offset:16640
    v_mfma_f32_16x16x32_bf16 v[68:71], a[200:203], a[168:171], v[68:71]
    ds_read_b64_tr_b16 a[222:223], v11 offset:24832
    v_mfma_f32_16x16x32_bf16 v[68:71], a[204:207], a[180:183], v[68:71]
    s_waitcnt lgkmcnt(4)
    v_mfma_f32_16x16x32_bf16 v[76:79], a[208:211], a[168:171], v[76:79]
    ds_read_b64_tr_b16 a[224:225], v12 offset:16384
    v_mfma_f32_16x16x32_bf16 v[76:79], a[212:215], a[180:183], v[76:79]
    ds_read_b64_tr_b16 a[226:227], v12 offset:24576
    v_mfma_f32_16x16x32_bf16 v[140:143], a[212:215], a[184:187], v[140:143]
    v_mfma_f32_16x16x32_bf16 v[140:143], a[208:211], a[172:175], v[140:143]
    ds_read_b64_tr_b16 a[228:229], v12 offset:16640
    v_mfma_f32_16x16x32_bf16 v[204:207], a[208:211], a[176:179], v[204:207]
    ds_read_b64_tr_b16 a[230:231], v12 offset:24832
    v_mfma_f32_16x16x32_bf16 v[204:207], a[212:215], a[188:191], v[204:207]
    s_waitcnt lgkmcnt(4)
    v_mfma_f32_16x16x32_bf16 v[212:215], a[216:219], a[176:179], v[212:215]
    ds_read_b64_tr_b16 a[232:233], v13 offset:16384
    v_mfma_f32_16x16x32_bf16 v[212:215], a[220:223], a[188:191], v[212:215]
    ds_read_b64_tr_b16 a[234:235], v13 offset:24576
    s_min_u32 s33, s84, s85
    s_min_u32 s33, s33, s86
    s_min_u32 s33, s33, s87
    s_cmp_lt_u32 s33, 4
    s_cbranch_scc1 L_q3_spin
L_q3_ok:
    v_mfma_f32_16x16x32_bf16 v[148:151], a[220:223], a[184:187], v[148:151]
    s_add_u32 s52, s89, 18432
    buffer_load_dwordx4 a[24:27], v45, s[24:27], s52 offen sc1
    v_mfma_f32_16x16x32_bf16 v[148:151], a[216:219], a[172:175], v[148:151]
    ds_read_b64_tr_b16 a[236:237], v13 offset:16640
    v_mfma_f32_16x16x32_bf16 v[84:87], a[216:219], a[168:171], v[84:87]
    ds_read_b64_tr_b16 a[238:239], v13 offset:24832
    v_mfma_f32_16x16x32_bf16 v[84:87], a[220:223], a[180:183], v[84:87]
    s_waitcnt lgkmcnt(4)
    v_mfma_f32_16x16x32_bf16 v[92:95], a[224:227], a[168:171], v[92:95]
    ds_read_b64_tr_b16 a[192:193], v14 offset:16384
    v_mfma_f32_16x16x32_bf16 v[92:95], a[228:231], a[180:183], v[92:95]
    ds_read_b64_tr_b16 a[194:195], v14 offset:24576
    v_mfma_f32_16x16x32_bf16 v[156:159], a[228:231], a[184:187], v[156:159]
    buffer_load_dwordx4 a[28:31], v45, s[24:27], s52 offen offset:1024 sc1
    v_mfma_f32_16x16x32_bf16 v[156:159], a[224:227], a[172:175], v[156:159]
    ds_read_b64_tr_b16 a[196:197], v14 offset:16640
    v_mfma_f32_16x16x32_bf16 v[220:223], a[224:227], a[176:179], v[220:223]
    ds_read_b64_tr_b16 a[198:199], v14 offset:24832
    v_mfma_f32_16x16x32_bf16 v[220:223], a[228:231], a[188:191], v[220:223]
    s_waitcnt lgkmcnt(4)
    v_mfma_f32_16x16x32_bf16 v[228:231], a[232:235], a[176:179], v[228:231]
    ds_read_b64_tr_b16 a[200:201], v15 offset:16384
    v_mfma_f32_16x16x32_bf16 v[228:231], a[236:239], a[188:191], v[228:231]
    ds_read_b64_tr_b16 a[202:203], v15 offset:24576
    v_mfma_f32_16x16x32_bf16 v[164:167], a[236:239], a[184:187], v[164:167]
    buffer_load_dwordx4 a[32:35], v45, s[24:27], s52 offen offset:2048 sc1
    v_mfma_f32_16x16x32_bf16 v[164:167], a[232:235], a[172:175], v[164:167]
    ds_read_b64_tr_b16 a[204:205], v15 offset:16640
    v_mfma_f32_16x16x32_bf16 v[100:103], a[232:235], a[168:171], v[100:103]
    ds_read_b64_tr_b16 a[206:207], v15 offset:24832
    v_mfma_f32_16x16x32_bf16 v[100:103], a[236:239], a[180:183], v[100:103]
    s_waitcnt lgkmcnt(4)
    s_waitcnt vmcnt(35)
    s_barrier
    v_mfma_f32_16x16x32_bf16 v[108:111], a[192:195], a[168:171], v[108:111]
    ds_read_b64_tr_b16 a[208:209], v17 offset:16384
    v_mfma_f32_16x16x32_bf16 v[108:111], a[196:199], a[180:183], v[108:111]
    ds_read_b64_tr_b16 a[210:211], v17 offset:24576
    v_mfma_f32_16x16x32_bf16 v[172:175], a[196:199], a[184:187], v[172:175]
    s_add_u32 s52, s89, 21504
    buffer_load_dwordx4 a[36:39], v45, s[24:27], s52 offen sc1
    v_mfma_f32_16x16x32_bf16 v[172:175], a[192:195], a[172:175], v[172:175]
    ds_read_b64_tr_b16 a[212:213], v17 offset:16640
    v_mfma_f32_16x16x32_bf16 v[236:239], a[192:195], a[176:179], v[236:239]
    ds_read_b64_tr_b16 a[214:215], v17 offset:24832
    v_mfma_f32_16x16x32_bf16 v[236:239], a[196:199], a[188:191], v[236:239]
    s_waitcnt lgkmcnt(4)
    v_mfma_f32_16x16x32_bf16 v[244:247], a[200:203], a[176:179], v[244:247]
    ds_read_b64_tr_b16 a[216:217], v18 offset:16384
    v_mfma_f32_16x16x32_bf16 v[244:247], a[204:207], a[188:191], v[244:247]
    ds_read_b64_tr_b16 a[218:219], v18 offset:24576
    v_mfma_f32_16x16x32_bf16 v[180:183], a[204:207], a[184:187], v[180:183]
    buffer_load_dwordx4 a[40:43], v45, s[24:27], s52 offen offset:1024 sc1
    v_mfma_f32_16x16x32_bf16 v[180:183], a[200:203], a[172:175], v[180:183]
    ds_read_b64_tr_b16 a[220:221], v18 offset:16640
    v_mfma_f32_16x16x32_bf16 v[116:119], a[200:203], a[168:171], v[116:119]
    ds_read_b64_tr_b16 a[222:223], v18 offset:24832
    v_mfma_f32_16x16x32_bf16 v[116:119], a[204:207], a[180:183], v[116:119]
    s_waitcnt lgkmcnt(4)
    s_waitcnt vmcnt(13)
    v_mfma_f32_16x16x32_bf16 v[68:71], a[208:211], a[0:3], v[68:71]
    ds_read_b64_tr_b16 a[224:225], v19 offset:16384
    s_waitcnt vmcnt(8)
    v_mfma_f32_16x16x32_bf16 v[68:71], a[212:215], a[12:15], v[68:71]
    ds_read_b64_tr_b16 a[226:227], v19 offset:24576
    v_mfma_f32_16x16x32_bf16 v[132:135], a[212:215], a[16:19], v[132:135]
    buffer_load_dwordx4 a[44:47], v45, s[24:27], s52 offen offset:2048 sc1
    v_mfma_f32_16x16x32_bf16 v[132:135], a[208:211], a[4:7], v[132:135]
    ds_read_b64_tr_b16 a[228:229], v19 offset:16640
    v_mfma_f32_16x16x32_bf16 v[196:199], a[208:211], a[8:11], v[196:199]
    ds_read_b64_tr_b16 a[230:231], v19 offset:24832
    v_mfma_f32_16x16x32_bf16 v[196:199], a[212:215], a[20:23], v[196:199]
    s_waitcnt lgkmcnt(4)
    v_mfma_f32_16x16x32_bf16 v[204:207], a[216:219], a[8:11], v[204:207]
    ds_read_b64_tr_b16 a[232:233], v20 offset:16384
    v_mfma_f32_16x16x32_bf16 v[204:207], a[220:223], a[20:23], v[204:207]
    ds_read_b64_tr_b16 a[234:235], v20 offset:24576
    v_mfma_f32_16x16x32_bf16 v[140:143], a[220:223], a[16:19], v[140:143]
    s_add_u32 s52, s90, 18432
    buffer_load_dwordx4 a[48:51], v45, s[24:27], s52 offen sc1
    v_mfma_f32_16x16x32_bf16 v[140:143], a[216:219], a[4:7], v[140:143]
    ds_read_b64_tr_b16 a[236:237], v20 offset:16640
    v_mfma_f32_16x16x32_bf16 v[76:79], a[216:219], a[0:3], v[76:79]
    ds_read_b64_tr_b16 a[238:239], v20 offset:24832
    v_mfma_f32_16x16x32_bf16 v[76:79], a[220:223], a[12:15], v[76:79]
    s_waitcnt lgkmcnt(4)
    v_mfma_f32_16x16x32_bf16 v[84:87], a[224:227], a[0:3], v[84:87]
    ds_read_b64_tr_b16 a[192:193], v21 offset:16384
    v_mfma_f32_16x16x32_bf16 v[84:87], a[228:231], a[12:15], v[84:87]
    ds_read_b64_tr_b16 a[194:195], v21 offset:24576
    v_mfma_f32_16x16x32_bf16 v[148:151], a[228:231], a[16:19], v[148:151]
    buffer_load_dwordx4 a[52:55], v45, s[24:27], s52 offen offset:1024 sc1
    v_mfma_f32_16x16x32_bf16 v[148:151], a[224:227], a[4:7], v[148:151]
    ds_read_b64_tr_b16 a[196:197], v21 offset:16640
    v_mfma_f32_16x16x32_bf16 v[212:215], a[224:227], a[8:11], v[212:215]
    ds_read_b64_tr_b16 a[198:199], v21 offset:24832
    v_mfma_f32_16x16x32_bf16 v[212:215], a[228:231], a[20:23], v[212:215]
    s_waitcnt lgkmcnt(4)
    v_mfma_f32_16x16x32_bf16 v[220:223], a[232:235], a[8:11], v[220:223]
    ds_read_b64_tr_b16 a[200:201], v22 offset:16384
    v_mfma_f32_16x16x32_bf16 v[220:223], a[236:239], a[20:23], v[220:223]
    ds_read_b64_tr_b16 a[202:203], v22 offset:24576
    v_mfma_f32_16x16x32_bf16 v[156:159], a[236:239], a[16:19], v[156:159]
    buffer_load_dwordx4 a[56:59], v45, s[24:27], s52 offen offset:2048 sc1
    v_mfma_f32_16x16x32_bf16 v[156:159], a[232:235], a[4:7], v[156:159]
    ds_read_b64_tr_b16 a[204:205], v22 offset:16640
    v_mfma_f32_16x16x32_bf16 v[92:95], a[232:235], a[0:3], v[92:95]
    ds_read_b64_tr_b16 a[206:207], v22 offset:24832
    v_mfma_f32_16x16x32_bf16 v[92:95], a[236:239], a[12:15], v[92:95]
    s_waitcnt lgkmcnt(4)
    v_mfma_f32_16x16x32_bf16 v[100:103], a[192:195], a[0:3], v[100:103]
    ds_read_b64_tr_b16 a[208:209], v23 offset:16384
    v_mfma_f32_16x16x32_bf16 v[100:103], a[196:199], a[12:15], v[100:103]
    ds_read_b64_tr_b16 a[210:211], v23 offset:24576
    v_mfma_f32_16x16x32_bf16 v[164:167], a[196:199], a[16:19], v[164:167]
    s_add_u32 s52, s90, 21504
    buffer_load_dwordx4 a[60:63], v45, s[24:27], s52 offen sc1
    v_mfma_f32_16x16x32_bf16 v[164:167], a[192:195], a[4:7], v[164:167]
    ds_read_b64_tr_b16 a[212:213], v23 offset:16640
    v_mfma_f32_16x16x32_bf16 v[228:231], a[192:195], a[8:11], v[228:231]
    ds_read_b64_tr_b16 a[214:215], v23 offset:24832
    v_mfma_f32_16x16x32_bf16 v[228:231], a[196:199], a[20:23], v[228:231]
    s_waitcnt lgkmcnt(4)
    s_waitcnt vmcnt(17)
    s_barrier
    v_mfma_f32_16x16x32_bf16 v[236:239], a[200:203], a[8:11], v[236:239]
    ds_read_b64_tr_b16 a[216:217], v9 offset:0
    v_mfma_f32_16x16x32_bf16 v[236:239], a[204:207], a[20:23], v[236:239]
    ds_read_b64_tr_b16 a[218:219], v9 offset:8192
    v_mfma_f32_16x16x32_bf16 v[172:175], a[204:207], a[16:19], v[172:175]
    buffer_load_dwordx4 a[64:67], v45, s[24:27], s52 offen offset:1024 sc1
    v_mfma_f32_16x16x32_bf16 v[172:175], a[200:203], a[4:7], v[172:175]
    ds_read_b64_tr_b16 a[220:221], v9 offset:256
    v_mfma_f32_16x16x32_bf16 v[108:111], a[200:203], a[0:3], v[108:111]
    ds_read_b64_tr_b16 a[222:223], v9 offset:8448
    v_mfma_f32_16x16x32_bf16 v[108:111], a[204:207], a[12:15], v[108:111]
    s_waitcnt lgkmcnt(4)
    v_mfma_f32_16x16x32_bf16 v[116:119], a[208:211], a[0:3], v[116:119]
    ds_read_b64_tr_b16 a[224:225], v10 offset:0
    v_mfma_f32_16x16x32_bf16 v[116:119], a[212:215], a[12:15], v[116:119]
    ds_read_b64_tr_b16 a[226:227], v10 offset:8192
    v_mfma_f32_16x16x32_bf16 v[180:183], a[212:215], a[16:19], v[180:183]
    buffer_load_dwordx4 a[68:71], v45, s[24:27], s52 offen offset:2048 sc1
    v_mfma_f32_16x16x32_bf16 v[180:183], a[208:211], a[4:7], v[180:183]
    s_add_u32 m0, s28, 131072
    ds_read_b64_tr_b16 a[228:229], v10 offset:256
    v_mfma_f32_16x16x32_bf16 v[244:247], a[208:211], a[8:11], v[244:247]
    s_add_u32 s29, s92, s0
    ds_read_b64_tr_b16 a[230:231], v10 offset:8448
    v_mfma_f32_16x16x32_bf16 v[244:247], a[212:215], a[20:23], v[244:247]
    s_waitcnt lgkmcnt(4)
    buffer_load_dwordx4 v53, s[20:23], s29 offen lds
    s_waitcnt vmcnt(10)
    v_mfma_f32_16x16x32_bf16 v[196:199], a[216:219], a[32:35], v[196:199]
    ds_read_b64_tr_b16 a[232:233], v11 offset:0
    s_waitcnt vmcnt(7)
    v_mfma_f32_16x16x32_bf16 v[196:199], a[220:223], a[44:47], v[196:199]
    ds_read_b64_tr_b16 a[234:235], v11 offset:8192
    v_mfma_f32_16x16x32_bf16 v[132:135], a[220:223], a[40:43], v[132:135]
    s_add_u32 s52, s92, 18432
    buffer_load_dwordx4 v54, s[20:23], s29 offen offset:1024 lds
    buffer_load_dwordx4 a[72:75], v45, s[24:27], s52 offen sc1
    v_mfma_f32_16x16x32_bf16 v[132:135], a[216:219], a[28:31], v[132:135]
    ds_read_b64_tr_b16 a[236:237], v11 offset:256
    v_mfma_f32_16x16x32_bf16 v[68:71], a[216:219], a[24:27], v[68:71]
    ds_read_b64_tr_b16 a[238:239], v11 offset:8448
    v_mfma_f32_16x16x32_bf16 v[68:71], a[220:223], a[36:39], v[68:71]
    s_waitcnt lgkmcnt(4)
    buffer_load_dwordx4 v55, s[20:23], s29 offen offset:2048 lds
    v_mfma_f32_16x16x32_bf16 v[76:79], a[224:227], a[24:27], v[76:79]
    ds_read_b64_tr_b16 a[192:193], v12 offset:0
    v_mfma_f32_16x16x32_bf16 v[76:79], a[228:231], a[36:39], v[76:79]
    ds_read_b64_tr_b16 a[194:195], v12 offset:8192
    v_mfma_f32_16x16x32_bf16 v[140:143], a[228:231], a[40:43], v[140:143]
    buffer_load_dwordx4 v56, s[20:23], s29 offen offset:3072 lds
    buffer_load_dwordx4 a[76:79], v45, s[24:27], s52 offen offset:1024 sc1
    v_mfma_f32_16x16x32_bf16 v[140:143], a[224:227], a[28:31], v[140:143]
    ds_read_b64_tr_b16 a[196:197], v12 offset:256
    v_mfma_f32_16x16x32_bf16 v[204:207], a[224:227], a[32:35], v[204:207]
    ds_read_b64_tr_b16 a[198:199], v12 offset:8448
    v_mfma_f32_16x16x32_bf16 v[204:207], a[228:231], a[44:47], v[204:207]
    s_waitcnt lgkmcnt(4)
    v_mfma_f32_16x16x32_bf16 v[212:215], a[232:235], a[32:35], v[212:215]
    ds_read_b64_tr_b16 a[200:201], v13 offset:0
    v_mfma_f32_16x16x32_bf16 v[212:215], a[236:239], a[44:47], v[212:215]
    ds_read_b64_tr_b16 a[202:203], v13 offset:8192
    v_mfma_f32_16x16x32_bf16 v[148:151], a[236:239], a[40:43], v[148:151]
    buffer_load_dwordx4 a[80:83], v45, s[24:27], s52 offen offset:2048 sc1
    v_mfma_f32_16x16x32_bf16 v[148:151], a[232:235], a[28:31], v[148:151]
    ds_read_b64_tr_b16 a[204:205], v13 offset:256
    v_mfma_f32_16x16x32_bf16 v[84:87], a[232:235], a[24:27], v[84:87]
    ds_read_b64_tr_b16 a[206:207], v13 offset:8448
    v_mfma_f32_16x16x32_bf16 v[84:87], a[236:239], a[36:39], v[84:87]
    s_waitcnt lgkmcnt(4)
    v_mfma_f32_16x16x32_bf16 v[92:95], a[192:195], a[24:27], v[92:95]
    ds_read_b64_tr_b16 a[208:209], v14 offset:0
    v_mfma_f32_16x16x32_bf16 v[92:95], a[196:199], a[36:39], v[92:95]
    ds_read_b64_tr_b16 a[210:211], v14 offset:8192
    v_mfma_f32_16x16x32_bf16 v[156:159], a[196:199], a[40:43], v[156:159]
    s_add_u32 s52, s92, 21504
    buffer_load_dwordx4 a[84:87], v45, s[24:27], s52 offen sc1
    v_mfma_f32_16x16x32_bf16 v[156:159], a[192:195], a[28:31], v[156:159]
    ds_read_b64_tr_b16 a[212:213], v14 offset:256
    v_mfma_f32_16x16x32_bf16 v[220:223], a[192:195], a[32:35], v[220:223]
    ds_read_b64_tr_b16 a[214:215], v14 offset:8448
    v_mfma_f32_16x16x32_bf16 v[220:223], a[196:199], a[44:47], v[220:223]
    s_waitcnt lgkmcnt(4)
    v_mfma_f32_16x16x32_bf16 v[228:231], a[200:203], a[32:35], v[228:231]
    ds_read_b64_tr_b16 a[216:217], v15 offset:0
    v_mfma_f32_16x16x32_bf16 v[228:231], a[204:207], a[44:47], v[228:231]
    ds_read_b64_tr_b16 a[218:219], v15 offset:8192
    v_mfma_f32_16x16x32_bf16 v[164:167], a[204:207], a[40:43], v[164:167]
    buffer_load_dwordx4 a[88:91], v45, s[24:27], s52 offen offset:1024 sc1
    v_mfma_f32_16x16x32_bf16 v[164:167], a[200:203], a[28:31], v[164:167]
    ds_read_b64_tr_b16 a[220:221], v15 offset:256
    v_mfma_f32_16x16x32_bf16 v[100:103], a[200:203], a[24:27], v[100:103]
    ds_read_b64_tr_b16 a[222:223], v15 offset:8448
    v_mfma_f32_16x16x32_bf16 v[100:103], a[204:207], a[36:39], v[100:103]
    s_waitcnt lgkmcnt(4)
    s_waitcnt vmcnt(21)
    s_barrier
    v_mfma_f32_16x16x32_bf16 v[108:111], a[208:211], a[24:27], v[108:111]
    ds_read_b64_tr_b16 a[224:225], v9 offset:32768
    v_mfma_f32_16x16x32_bf16 v[108:111], a[212:215], a[36:39], v[108:111]
    ds_read_b64_tr_b16 a[226:227], v9 offset:40960
    v_mfma_f32_16x16x32_bf16 v[172:175], a[212:215], a[40:43], v[172:175]
    buffer_load_dwordx4 a[92:95], v45, s[24:27], s52 offen offset:2048 sc1
    v_mfma_f32_16x16x32_bf16 v[172:175], a[208:211], a[28:31], v[172:175]
    ds_read_b64_tr_b16 a[228:229], v9 offset:33024
    v_mfma_f32_16x16x32_bf16 v[236:239], a[208:211], a[32:35], v[236:239]
    ds_read_b64_tr_b16 a[230:231], v9 offset:41216
    v_mfma_f32_16x16x32_bf16 v[236:239], a[212:215], a[44:47], v[236:239]
    s_waitcnt lgkmcnt(4)
    v_mfma_f32_16x16x32_bf16 v[244:247], a[216:219], a[32:35], v[244:247]
    ds_read_b64_tr_b16 a[232:233], v10 offset:32768
    v_mfma_f32_16x16x32_bf16 v[244:247], a[220:223], a[44:47], v[244:247]
    ds_read_b64_tr_b16 a[234:235], v10 offset:40960
    v_mfma_f32_16x16x32_bf16 v[180:183], a[220:223], a[40:43], v[180:183]
    v_mfma_f32_16x16x32_bf16 v[180:183], a[216:219], a[28:31], v[180:183]
    ds_read_b64_tr_b16 a[236:237], v10 offset:33024
    v_mfma_f32_16x16x32_bf16 v[116:119], a[216:219], a[24:27], v[116:119]
    ds_read_b64_tr_b16 a[238:239], v10 offset:41216
    v_mfma_f32_16x16x32_bf16 v[116:119], a[220:223], a[36:39], v[116:119]
    s_waitcnt lgkmcnt(4)
    s_waitcnt vmcnt(13)
    v_mfma_f32_16x16x32_bf16 v[68:71], a[224:227], a[48:51], v[68:71]
    ds_read_b64_tr_b16 a[192:193], v11 offset:32768
    s_waitcnt vmcnt(10)
    v_mfma_f32_16x16x32_bf16 v[68:71], a[228:231], a[60:63], v[68:71]
    ds_read_b64_tr_b16 a[194:195], v11 offset:40960
    v_mfma_f32_16x16x32_bf16 v[132:135], a[228:231], a[64:67], v[132:135]
    v_mfma_f32_16x16x32_bf16 v[132:135], a[224:227], a[52:55], v[132:135]
    ds_read_b64_tr_b16 a[196:197], v11 offset:33024
    v_mfma_f32_16x16x32_bf16 v[196:199], a[224:227], a[56:59], v[196:199]
    ds_read_b64_tr_b16 a[198:199], v11 offset:41216
    v_mfma_f32_16x16x32_bf16 v[196:199], a[228:231], a[68:71], v[196:199]
    s_waitcnt lgkmcnt(4)
    v_mfma_f32_16x16x32_bf16 v[204:207], a[232:235], a[56:59], v[204:207]
    ds_read_b64_tr_b16 a[200:201], v12 offset:32768
    v_mfma_f32_16x16x32_bf16 v[204:207], a[236:239], a[68:71], v[204:207]
    ds_read_b64_tr_b16 a[202:203], v12 offset:40960
    v_mfma_f32_16x16x32_bf16 v[140:143], a[236:239], a[64:67], v[140:143]
    v_mfma_f32_16x16x32_bf16 v[140:143], a[232:235], a[52:55], v[140:143]
    ds_read_b64_tr_b16 a[204:205], v12 offset:33024
    v_mfma_f32_16x16x32_bf16 v[76:79], a[232:235], a[48:51], v[76:79]
    ds_read_b64_tr_b16 a[206:207], v12 offset:41216
    v_mfma_f32_16x16x32_bf16 v[76:79], a[236:239], a[60:63], v[76:79]
    s_waitcnt lgkmcnt(4)
    v_mfma_f32_16x16x32_bf16 v[84:87], a[192:195], a[48:51], v[84:87]
    ds_read_b64_tr_b16 a[208:209], v13 offset:32768
    v_mfma_f32_16x16x32_bf16 v[84:87], a[196:199], a[60:63], v[84:87]
    ds_read_b64_tr_b16 a[210:211], v13 offset:40960
    v_mfma_f32_16x16x32_bf16 v[148:151], a[196:199], a[64:67], v[148:151]
    v_mfma_f32_16x16x32_bf16 v[148:151], a[192:195], a[52:55], v[148:151]
    ds_read_b64_tr_b16 a[212:213], v13 offset:33024
    v_mfma_f32_16x16x32_bf16 v[212:215], a[192:195], a[56:59], v[212:215]
    ds_read_b64_tr_b16 a[214:215], v13 offset:41216
    v_mfma_f32_16x16x32_bf16 v[212:215], a[196:199], a[68:71], v[212:215]
    s_waitcnt lgkmcnt(4)
    v_mfma_f32_16x16x32_bf16 v[220:223], a[200:203], a[56:59], v[220:223]
    ds_read_b64_tr_b16 a[216:217], v14 offset:32768
    v_mfma_f32_16x16x32_bf16 v[220:223], a[204:207], a[68:71], v[220:223]
    ds_read_b64_tr_b16 a[218:219], v14 offset:40960
    v_mfma_f32_16x16x32_bf16 v[156:159], a[204:207], a[64:67], v[156:159]
    v_mfma_f32_16x16x32_bf16 v[156:159], a[200:203], a[52:55], v[156:159]
    ds_read_b64_tr_b16 a[220:221], v14 offset:33024
    v_mfma_f32_16x16x32_bf16 v[92:95], a[200:203], a[48:51], v[92:95]
    ds_read_b64_tr_b16 a[222:223], v14 offset:41216
    v_mfma_f32_16x16x32_bf16 v[92:95], a[204:207], a[60:63], v[92:95]
    s_waitcnt lgkmcnt(4)
    v_mfma_f32_16x16x32_bf16 v[100:103], a[208:211], a[48:51], v[100:103]
    ds_read_b64_tr_b16 a[224:225], v15 offset:32768
    v_mfma_f32_16x16x32_bf16 v[100:103], a[212:215], a[60:63], v[100:103]
    ds_read_b64_tr_b16 a[226:227], v15 offset:40960
    v_mfma_f32_16x16x32_bf16 v[164:167], a[212:215], a[64:67], v[164:167]
    v_mfma_f32_16x16x32_bf16 v[164:167], a[208:211], a[52:55], v[164:167]
    ds_read_b64_tr_b16 a[228:229], v15 offset:33024
    v_mfma_f32_16x16x32_bf16 v[228:231], a[208:211], a[56:59], v[228:231]
    ds_read_b64_tr_b16 a[230:231], v15 offset:41216
    v_mfma_f32_16x16x32_bf16 v[228:231], a[212:215], a[68:71], v[228:231]
    s_waitcnt lgkmcnt(4)
    s_waitcnt vmcnt(5)
    s_barrier
    v_mfma_f32_16x16x32_bf16 v[236:239], a[216:219], a[56:59], v[236:239]
    ds_read_b64_tr_b16 a[232:233], v17 offset:0
    v_mfma_f32_16x16x32_bf16 v[236:239], a[220:223], a[68:71], v[236:239]
    ds_read_b64_tr_b16 a[234:235], v17 offset:8192
    v_mfma_f32_16x16x32_bf16 v[172:175], a[220:223], a[64:67], v[172:175]
    v_mfma_f32_16x16x32_bf16 v[172:175], a[216:219], a[52:55], v[172:175]
    ds_read_b64_tr_b16 a[236:237], v17 offset:256
    v_mfma_f32_16x16x32_bf16 v[108:111], a[216:219], a[48:51], v[108:111]
    ds_read_b64_tr_b16 a[238:239], v17 offset:8448
    v_mfma_f32_16x16x32_bf16 v[108:111], a[220:223], a[60:63], v[108:111]
    s_waitcnt lgkmcnt(4)
    v_mfma_f32_16x16x32_bf16 v[116:119], a[224:227], a[48:51], v[116:119]
    ds_read_b64_tr_b16 a[192:193], v18 offset:0
    v_mfma_f32_16x16x32_bf16 v[116:119], a[228:231], a[60:63], v[116:119]
    ds_read_b64_tr_b16 a[194:195], v18 offset:8192
    v_mfma_f32_16x16x32_bf16 v[180:183], a[228:231], a[64:67], v[180:183]
    v_mfma_f32_16x16x32_bf16 v[180:183], a[224:227], a[52:55], v[180:183]
    ds_read_b64_tr_b16 a[196:197], v18 offset:256
    v_mfma_f32_16x16x32_bf16 v[244:247], a[224:227], a[56:59], v[244:247]
    ds_read_b64_tr_b16 a[198:199], v18 offset:8448
    v_mfma_f32_16x16x32_bf16 v[244:247], a[228:231], a[68:71], v[244:247]
    s_waitcnt lgkmcnt(4)
    s_waitcnt vmcnt(3)
    v_mfma_f32_16x16x32_bf16 v[196:199], a[232:235], a[80:83], v[196:199]
    ds_read_b64_tr_b16 a[200:201], v19 offset:0
    s_waitcnt vmcnt(0)
    v_mfma_f32_16x16x32_bf16 v[196:199], a[236:239], a[92:95], v[196:199]
    ds_read_b64_tr_b16 a[202:203], v19 offset:8192
    v_mfma_f32_16x16x32_bf16 v[132:135], a[236:239], a[88:91], v[132:135]
    v_mfma_f32_16x16x32_bf16 v[132:135], a[232:235], a[76:79], v[132:135]
    ds_read_b64_tr_b16 a[204:205], v19 offset:256
    v_mfma_f32_16x16x32_bf16 v[68:71], a[232:235], a[72:75], v[68:71]
    ds_read_b64_tr_b16 a[206:207], v19 offset:8448
    v_mfma_f32_16x16x32_bf16 v[68:71], a[236:239], a[84:87], v[68:71]
    s_waitcnt lgkmcnt(4)
    v_mfma_f32_16x16x32_bf16 v[76:79], a[192:195], a[72:75], v[76:79]
    ds_read_b64_tr_b16 a[208:209], v20 offset:0
    v_mfma_f32_16x16x32_bf16 v[76:79], a[196:199], a[84:87], v[76:79]
    ds_read_b64_tr_b16 a[210:211], v20 offset:8192
    v_mfma_f32_16x16x32_bf16 v[140:143], a[196:199], a[88:91], v[140:143]
    v_mfma_f32_16x16x32_bf16 v[140:143], a[192:195], a[76:79], v[140:143]
    ds_read_b64_tr_b16 a[212:213], v20 offset:256
    v_mfma_f32_16x16x32_bf16 v[204:207], a[192:195], a[80:83], v[204:207]
    ds_read_b64_tr_b16 a[214:215], v20 offset:8448
    v_mfma_f32_16x16x32_bf16 v[204:207], a[196:199], a[92:95], v[204:207]
    s_waitcnt lgkmcnt(4)
    v_cvt_pk_bf16_f32 v68, v68, v69
    v_cvt_pk_bf16_f32 v69, v70, v71
    v_mfma_f32_16x16x32_bf16 v[212:215], a[200:203], a[80:83], v[212:215]
    ds_read_b64_tr_b16 a[216:217], v21 offset:0
    v_cvt_pk_bf16_f32 v70, v76, v77
    v_mfma_f32_16x16x32_bf16 v[212:215], a[204:207], a[92:95], v[212:215]
    ds_read_b64_tr_b16 a[218:219], v21 offset:8192
    v_cvt_pk_bf16_f32 v71, v78, v79
    v_mfma_f32_16x16x32_bf16 v[148:151], a[204:207], a[88:91], v[148:151]
    buffer_store_dwordx4 v[68:71], v48, s[24:27], s53 offen sc1
    v_cvt_pk_bf16_f32 v132, v132, v133
    v_mfma_f32_16x16x32_bf16 v[148:151], a[200:203], a[76:79], v[148:151]
    ds_read_b64_tr_b16 a[220:221], v21 offset:256
    v_cvt_pk_bf16_f32 v133, v134, v135
    v_mfma_f32_16x16x32_bf16 v[84:87], a[200:203], a[72:75], v[84:87]
    ds_read_b64_tr_b16 a[222:223], v21 offset:8448
    v_cvt_pk_bf16_f32 v134, v140, v141
    v_mfma_f32_16x16x32_bf16 v[84:87], a[204:207], a[84:87], v[84:87]
    s_waitcnt lgkmcnt(4)
    v_cvt_pk_bf16_f32 v135, v142, v143
    buffer_store_dwordx4 v[132:135], v48, s[24:27], s54 offen sc1
    v_mfma_f32_16x16x32_bf16 v[92:95], a[208:211], a[72:75], v[92:95]
    ds_read_b64_tr_b16 a[224:225], v22 offset:0
    v_cvt_pk_bf16_f32 v196, v196, v197
    v_mfma_f32_16x16x32_bf16 v[92:95], a[212:215], a[84:87], v[92:95]
    ds_read_b64_tr_b16 a[226:227], v22 offset:8192
    v_cvt_pk_bf16_f32 v197, v198, v199
    v_mfma_f32_16x16x32_bf16 v[156:159], a[212:215], a[88:91], v[156:159]
    v_cvt_pk_bf16_f32 v198, v204, v205
    v_cvt_pk_bf16_f32 v199, v206, v207
    v_mfma_f32_16x16x32_bf16 v[156:159], a[208:211], a[76:79], v[156:159]
    ds_read_b64_tr_b16 a[228:229], v22 offset:256
    buffer_store_dwordx4 v[196:199], v48, s[24:27], s55 offen sc1
    v_mfma_f32_16x16x32_bf16 v[220:223], a[208:211], a[80:83], v[220:223]
    ds_read_b64_tr_b16 a[230:231], v22 offset:8448
    v_mfma_f32_16x16x32_bf16 v[220:223], a[212:215], a[92:95], v[220:223]
    s_waitcnt lgkmcnt(4)
    v_cvt_pk_bf16_f32 v84, v84, v85
    v_cvt_pk_bf16_f32 v85, v86, v87
    v_mfma_f32_16x16x32_bf16 v[228:231], a[216:219], a[80:83], v[228:231]
    ds_read_b64_tr_b16 a[232:233], v23 offset:0
    v_cvt_pk_bf16_f32 v86, v92, v93
    v_mfma_f32_16x16x32_bf16 v[228:231], a[220:223], a[92:95], v[228:231]
    ds_read_b64_tr_b16 a[234:235], v23 offset:8192
    v_cvt_pk_bf16_f32 v87, v94, v95
    v_mfma_f32_16x16x32_bf16 v[164:167], a[220:223], a[88:91], v[164:167]
    buffer_store_dwordx4 v[84:87], v48, s[24:27], s53 offen offset:1024 sc1
    v_cvt_pk_bf16_f32 v148, v148, v149
    v_mfma_f32_16x16x32_bf16 v[164:167], a[216:219], a[76:79], v[164:167]
    ds_read_b64_tr_b16 a[236:237], v23 offset:256
    v_cvt_pk_bf16_f32 v149, v150, v151
    v_mfma_f32_16x16x32_bf16 v[100:103], a[216:219], a[72:75], v[100:103]
    ds_read_b64_tr_b16 a[238:239], v23 offset:8448
    v_cvt_pk_bf16_f32 v150, v156, v157
    v_mfma_f32_16x16x32_bf16 v[100:103], a[220:223], a[84:87], v[100:103]
    s_waitcnt lgkmcnt(4)
    v_cvt_pk_bf16_f32 v151, v158, v159
    buffer_store_dwordx4 v[148:151], v48, s[24:27], s54 offen offset:1024 sc1
    v_mfma_f32_16x16x32_bf16 v[108:111], a[224:227], a[72:75], v[108:111]
    v_cvt_pk_bf16_f32 v212, v212, v213
    v_cvt_pk_bf16_f32 v213, v214, v215
    v_mfma_f32_16x16x32_bf16 v[108:111], a[228:231], a[84:87], v[108:111]
    v_cvt_pk_bf16_f32 v214, v220, v221
    v_cvt_pk_bf16_f32 v215, v222, v223
    v_mfma_f32_16x16x32_bf16 v[172:175], a[228:231], a[88:91], v[172:175]
    buffer_store_dwordx4 v[212:215], v48, s[24:27], s55 offen offset:1024 sc1
    v_mfma_f32_16x16x32_bf16 v[172:175], a[224:227], a[76:79], v[172:175]
    v_mfma_f32_16x16x32_bf16 v[236:239], a[224:227], a[80:83], v[236:239]
    v_mfma_f32_16x16x32_bf16 v[236:239], a[228:231], a[92:95], v[236:239]
    s_waitcnt lgkmcnt(0)
    v_cvt_pk_bf16_f32 v100, v100, v101
    v_cvt_pk_bf16_f32 v101, v102, v103
    v_mfma_f32_16x16x32_bf16 v[244:247], a[232:235], a[80:83], v[244:247]
    v_cvt_pk_bf16_f32 v102, v108, v109
    v_cvt_pk_bf16_f32 v103, v110, v111
    v_mfma_f32_16x16x32_bf16 v[244:247], a[236:239], a[92:95], v[244:247]
    buffer_store_dwordx4 v[100:103], v48, s[24:27], s53 offen offset:2048 sc1
    v_cvt_pk_bf16_f32 v164, v164, v165
    v_mfma_f32_16x16x32_bf16 v[180:183], a[236:239], a[88:91], v[180:183]
    v_cvt_pk_bf16_f32 v165, v166, v167
    v_cvt_pk_bf16_f32 v166, v172, v173
    v_mfma_f32_16x16x32_bf16 v[180:183], a[232:235], a[76:79], v[180:183]
    v_cvt_pk_bf16_f32 v167, v174, v175
    buffer_store_dwordx4 v[164:167], v48, s[24:27], s54 offen offset:2048 sc1
    v_mfma_f32_16x16x32_bf16 v[116:119], a[232:235], a[72:75], v[116:119]
    v_cvt_pk_bf16_f32 v228, v228, v229
    v_cvt_pk_bf16_f32 v229, v230, v231
    v_mfma_f32_16x16x32_bf16 v[116:119], a[236:239], a[84:87], v[116:119]
    v_cvt_pk_bf16_f32 v230, v236, v237
    v_cvt_pk_bf16_f32 v231, v238, v239
    buffer_store_dwordx4 v[228:231], v48, s[24:27], s55 offen offset:2048 sc1
    s_nop 4
    v_cvt_pk_bf16_f32 v116, v116, v117
    v_cvt_pk_bf16_f32 v117, v118, v119
    buffer_store_dwordx2 v[116:117], v35, s[24:27], s53 offen offset:3072 sc1
    v_cvt_pk_bf16_f32 v180, v180, v181
    v_cvt_pk_bf16_f32 v181, v182, v183
    buffer_store_dwordx2 v[180:181], v35, s[24:27], s54 offen offset:3072 sc1
    v_cvt_pk_bf16_f32 v244, v244, v245
    v_cvt_pk_bf16_f32 v245, v246, v247
    buffer_store_dwordx2 v[244:245], v35, s[24:27], s55 offen offset:3072 sc1
    s_cmp_lg_u32 s62, s58
    s_cbranch_scc1 L_sent
    ds_write_b128 v48, v[68:71] offset:0
    ds_write_b128 v48, v[84:87] offset:1024
    ds_write_b128 v48, v[100:103] offset:2048
    ds_write_b64 v35, v[116:117] offset:3072
    ds_write_b128 v48, v[132:135] offset:4096
    ds_write_b128 v48, v[148:151] offset:5120
    ds_write_b128 v48, v[164:167] offset:6144
    ds_write_b64 v35, v[180:181] offset:7168
    ds_write_b128 v48, v[196:199] offset:8192
    ds_write_b128 v48, v[212:215] offset:9216
    ds_write_b128 v48, v[228:231] offset:10240
    ds_write_b64 v35, v[244:245] offset:11264
L_sent:
    v_mov_b32 v47, 1
    s_waitcnt vmcnt(0)
    buffer_store_dword v47, v34, s[36:39], s49 offen sc1
    s_waitcnt lgkmcnt(0)
    s_barrier
    s_cmp_eq_u32 s58, 3
    s_cbranch_scc1 L_fin
    s_mov_b32 s48, s63
    s_mov_b32 s34, 1
    v_add_u32 v42, s28, v48
    v_add_u32 v43, s28, v35
    ds_read_b128 v[64:67], v42 offset:0
    ds_read_b128 v[72:75], v42 offset:1024
    ds_read_b128 v[80:83], v42 offset:2048
    ds_read_b64 v[88:89], v43 offset:3072
    s_waitcnt lgkmcnt(0)
    v_mfma_f32_16x16x32_bf16 v[68:71], v[160:163], v[64:67], 0
    v_mfma_f32_16x16x32_bf16 v[76:79], v[168:171], v[64:67], 0
    v_mfma_f32_16x16x32_bf16 v[84:87], v[160:163], v[72:75], 0
    v_mfma_f32_16x16x32_bf16 v[92:95], v[168:171], v[72:75], 0
    v_mfma_f32_16x16x32_bf16 v[100:103], v[160:163], v[80:83], 0
    v_mfma_f32_16x16x32_bf16 v[108:111], v[168:171], v[80:83], 0
    v_mfma_f32_16x16x32_bf16 v[116:119], v[30:33], v[88:91], 0
    s_call_b64 s[30:31], L_poll
    s_xor_b32 s29, s62, 1
    s_mul_i32 s29, s29, 12288
    s_add_u32 s29, s29, s97
    buffer_load_dwordx4 v[128:131], v48, s[24:27], s29 offen sc1
    buffer_load_dwordx4 v[136:139], v48, s[24:27], s29 offen offset:1024 sc1
    buffer_load_dwordx4 v[144:147], v48, s[24:27], s29 offen offset:2048 sc1
    buffer_load_dwordx2 v[152:153], v35, s[24:27], s29 offen offset:3072 sc1
    s_xor_b32 s29, s62, 2
    s_mul_i32 s29, s29, 12288
    s_add_u32 s29, s29, s97
    buffer_load_dwordx4 v[192:195], v48, s[24:27], s29 offen sc1
    buffer_load_dwordx4 v[200:203], v48, s[24:27], s29 offen offset:1024 sc1
    buffer_load_dwordx4 v[208:211], v48, s[24:27], s29 offen offset:2048 sc1
    buffer_load_dwordx2 v[216:217], v35, s[24:27], s29 offen offset:3072 sc1
    s_xor_b32 s29, s62, 3
    s_mul_i32 s29, s29, 12288
    s_add_u32 s29, s29, s97
    buffer_load_dwordx4 v[96:99], v48, s[24:27], s29 offen sc1
    buffer_load_dwordx4 v[104:107], v48, s[24:27], s29 offen offset:1024 sc1
    buffer_load_dwordx4 v[112:115], v48, s[24:27], s29 offen offset:2048 sc1
    buffer_load_dwordx2 v[120:121], v35, s[24:27], s29 offen offset:3072 sc1
    s_waitcnt vmcnt(11)
    v_mfma_f32_16x16x32_bf16 v[68:71], v[160:163], v[128:131], v[68:71]
    v_mfma_f32_16x16x32_bf16 v[76:79], v[168:171], v[128:131], v[76:79]
    s_waitcnt vmcnt(10)
    v_mfma_f32_16x16x32_bf16 v[84:87], v[160:163], v[136:139], v[84:87]
    v_mfma_f32_16x16x32_bf16 v[92:95], v[168:171], v[136:139], v[92:95]
    s_waitcnt vmcnt(9)
    v_mfma_f32_16x16x32_bf16 v[100:103], v[160:163], v[144:147], v[100:103]
    v_mfma_f32_16x16x32_bf16 v[108:111], v[168:171], v[144:147], v[108:111]
    s_waitcnt vmcnt(8)
    v_mfma_f32_16x16x32_bf16 v[116:119], v[30:33], v[152:155], v[116:119]
    s_waitcnt vmcnt(7)
    v_mfma_f32_16x16x32_bf16 v[68:71], v[160:163], v[192:195], v[68:71]
    v_mfma_f32_16x16x32_bf16 v[76:79], v[168:171], v[192:195], v[76:79]
    s_waitcnt vmcnt(6)
    v_mfma_f32_16x16x32_bf16 v[84:87], v[160:163], v[200:203], v[84:87]
    v_mfma_f32_16x16x32_bf16 v[92:95], v[168:171], v[200:203], v[92:95]
    s_waitcnt vmcnt(5)
    v_mfma_f32_16x16x32_bf16 v[100:103], v[160:163], v[208:211], v[100:103]
    v_mfma_f32_16x16x32_bf16 v[108:111], v[168:171], v[208:211], v[108:111]
    s_waitcnt vmcnt(4)
    v_mfma_f32_16x16x32_bf16 v[116:119], v[30:33], v[216:219], v[116:119]
    s_waitcnt vmcnt(3)
    v_mfma_f32_16x16x32_bf16 v[68:71], v[160:163], v[96:99], v[68:71]
    v_mfma_f32_16x16x32_bf16 v[76:79], v[168:171], v[96:99], v[76:79]
    s_waitcnt vmcnt(2)
    v_mfma_f32_16x16x32_bf16 v[84:87], v[160:163], v[104:107], v[84:87]
    v_mfma_f32_16x16x32_bf16 v[92:95], v[168:171], v[104:107], v[92:95]
    s_waitcnt vmcnt(1)
    v_mfma_f32_16x16x32_bf16 v[100:103], v[160:163], v[112:115], v[100:103]
    v_mfma_f32_16x16x32_bf16 v[108:111], v[168:171], v[112:115], v[108:111]
    s_waitcnt vmcnt(0)
    v_mfma_f32_16x16x32_bf16 v[116:119], v[30:33], v[120:123], v[116:119]
    v_cvt_pk_bf16_f32 v68, v68, v69
    v_cvt_pk_bf16_f32 v69, v70, v71
    v_cvt_pk_bf16_f32 v70, v76, v77
    v_cvt_pk_bf16_f32 v71, v78, v79
    buffer_store_dwordx4 v[68:71], v39, s[44:47], s50 offen
    v_cvt_pk_bf16_f32 v84, v84, v85
    v_cvt_pk_bf16_f32 v85, v86, v87
    v_cvt_pk_bf16_f32 v86, v92, v93
    v_cvt_pk_bf16_f32 v87, v94, v95
    buffer_store_dwordx4 v[84:87], v39, s[44:47], s50 offen offset:64
    v_cvt_pk_bf16_f32 v100, v100, v101
    v_cvt_pk_bf16_f32 v101, v102, v103
    v_cvt_pk_bf16_f32 v102, v108, v109
    v_cvt_pk_bf16_f32 v103, v110, v111
    buffer_store_dwordx4 v[100:103], v39, s[44:47], s50 offen offset:128
    v_cvt_pk_bf16_f32 v116, v116, v117
    v_cvt_pk_bf16_f32 v117, v118, v119
    buffer_store_dwordx2 v[116:117], v36, s[44:47], s50 offen offset:192
L_fin:
L_end:
    s_endpgm
L_poll:
    s_add_u32 s91, s91, 1
    s_cmp_gt_u32 s91, 262144
    s_cbranch_scc1 L_wait_end
    s_load_dwordx4 s[84:87], s[36:37], s48 offset:0 glc
L_wait:
    s_waitcnt lgkmcnt(0)
    s_min_u32 s33, s84, s85
    s_min_u32 s33, s33, s86
    s_min_u32 s33, s33, s87
    s_cmp_lt_u32 s33, s34
    s_cbranch_scc1 L_poll
L_wait_end:
    s_setpc_b64 s[30:31]
L_rare1:
    s_call_b64 s[30:31], L_rescale
    s_branch L_ret1
L_rare2:
    s_call_b64 s[30:31], L_rescale
    s_branch L_ret2
L_rare3:
    s_call_b64 s[30:31], L_rescale
    s_branch L_ret3
L_rare4:
    s_call_b64 s[30:31], L_rescale
    s_branch L_ret4
L_rare5:
    s_call_b64 s[30:31], L_rescale
    s_branch L_ret5
L_rare6:
    s_call_b64 s[30:31], L_rescale
    s_branch L_ret6
L_rare7:
    s_call_b64 s[30:31], L_rescale
    s_branch L_ret7
L_rare8:
    s_call_b64 s[30:31], L_rescale
    s_branch L_ret8
L_rare9:
    s_call_b64 s[30:31], L_rescale
    s_branch L_ret9
L_rare10:
    s_call_b64 s[30:31], L_rescale
    s_branch L_ret10
L_rare11:
    s_call_b64 s[30:31], L_rescale
    s_branch L_ret11
L_rare12:
    s_call_b64 s[30:31], L_rescale
    s_branch L_ret12
L_rare13:
    s_call_b64 s[30:31], L_rescale
    s_branch L_ret13
L_rare14:
    s_call_b64 s[30:31], L_rescale
    s_branch L_ret14
L_rare15:
    s_call_b64 s[30:31], L_rescale
    s_branch L_ret15
L_cnt_spin:
    s_add_u32 s91, s91, 1
    s_cmp_gt_u32 s91, 262144
    s_cbranch_scc1 L_cnt_ok
    s_sleep 2
    buffer_load_dword v135, v134, s[40:43], s85 offen sc1
    s_waitcnt vmcnt(0)
    v_cmp_gt_u32 vcc, 32, v135
    s_cbranch_vccnz L_cnt_spin
    s_branch L_cnt_ok
L_gd_poll:
    s_add_u32 s91, s91, 1
    s_cmp_gt_u32 s91, 262144
    s_cbranch_scc1 L_gd_ok
    s_load_dwordx4 s[84:87], s[36:37], s63 offset:128 glc
L_gd_spin:
    s_waitcnt lgkmcnt(0)
    s_min_u32 s33, s84, s85
    s_min_u32 s33, s33, s86
    s_min_u32 s33, s33, s87
    s_cmp_eq_u32 s33, 16843009
    s_cbranch_scc0 L_gd_poll
    s_branch L_gd_ok
L_q0_spin:
    s_mov_b32 s34, 1
    s_call_b64 s[30:31], L_wait
    s_branch L_q0_ok
L_q1_spin:
    s_mov_b32 s34, 2
    s_call_b64 s[30:31], L_wait
    s_branch L_q1_ok
L_q2_spin:
    s_mov_b32 s34, 3
    s_call_b64 s[30:31], L_wait
    s_branch L_q2_ok
L_q3_spin:
    s_mov_b32 s34, 4
    s_call_b64 s[30:31], L_wait
    s_branch L_q3_ok
L_code_end:
L_rescale:
    s_nop 15
    v_max3_f32 v61, v84, v85, 0
    v_max3_f32 v61, v61, v86, v87
    v_max3_f32 v61, v61, v92, v93
    v_max3_f32 v61, v61, v94, v95
    v_mov_b32 v0, v61
    s_nop 1
    v_permlane32_swap_b32 v61, v0
    v_max_f32 v61, v61, v0
    v_mov_b32 v0, v61
    s_nop 1
    v_permlane16_swap_b32 v61, v0
    v_max_f32 v61, v61, v0
    v_exp_f32 v0, -v61
    v_sub_f32 v124, v124, v61
    v_sub_f32 v125, v125, v61
    v_sub_f32 v126, v126, v61
    v_sub_f32 v127, v127, v61
    v_mul_f32 v58, v58, v0
    v_accvgpr_read_b32 v100, a0
    v_accvgpr_read_b32 v101, a1
    v_accvgpr_read_b32 v102, a2
    v_accvgpr_read_b32 v103, a3
    v_accvgpr_read_b32 v108, a12
    v_accvgpr_read_b32 v109, a13
    v_accvgpr_read_b32 v110, a14
    v_accvgpr_read_b32 v111, a15
    v_mul_f32 v100, v0, v100
    v_mul_f32 v101, v0, v101
    v_mul_f32 v102, v0, v102
    v_mul_f32 v103, v0, v103
    v_mul_f32 v108, v0, v108
    v_mul_f32 v109, v0, v109
    v_mul_f32 v110, v0, v110
    v_mul_f32 v111, v0, v111
    v_accvgpr_write_b32 a0, v100
    v_accvgpr_write_b32 a1, v101
    v_accvgpr_write_b32 a2, v102
    v_accvgpr_write_b32 a3, v103
    v_accvgpr_write_b32 a12, v108
    v_accvgpr_write_b32 a13, v109
    v_accvgpr_write_b32 a14, v110
    v_accvgpr_write_b32 a15, v111
    v_accvgpr_read_b32 v100, a24
    v_accvgpr_read_b32 v101, a25
    v_accvgpr_read_b32 v102, a26
    v_accvgpr_read_b32 v103, a27
    v_accvgpr_read_b32 v108, a36
    v_accvgpr_read_b32 v109, a37
    v_accvgpr_read_b32 v110, a38
    v_accvgpr_read_b32 v111, a39
    v_mul_f32 v100, v0, v100
    v_mul_f32 v101, v0, v101
    v_mul_f32 v102, v0, v102
    v_mul_f32 v103, v0, v103
    v_mul_f32 v108, v0, v108
    v_mul_f32 v109, v0, v109
    v_mul_f32 v110, v0, v110
    v_mul_f32 v111, v0, v111
    v_accvgpr_write_b32 a24, v100
    v_accvgpr_write_b32 a25, v101
    v_accvgpr_write_b32 a26, v102
    v_accvgpr_write_b32 a27, v103
    v_accvgpr_write_b32 a36, v108
    v_accvgpr_write_b32 a37, v109
    v_accvgpr_write_b32 a38, v110
    v_accvgpr_write_b32 a39, v111
    v_accvgpr_read_b32 v100, a48
    v_accvgpr_read_b32 v101, a49
    v_accvgpr_read_b32 v102, a50
    v_accvgpr_read_b32 v103, a51
    v_accvgpr_read_b32 v108, a60
    v_accvgpr_read_b32 v109, a61
    v_accvgpr_read_b32 v110, a62
    v_accvgpr_read_b32 v111, a63
    v_mul_f32 v100, v0, v100
    v_mul_f32 v101, v0, v101
    v_mul_f32 v102, v0, v102
    v_mul_f32 v103, v0, v103
    v_mul_f32 v108, v0, v108
    v_mul_f32 v109, v0, v109
    v_mul_f32 v110, v0, v110
    v_mul_f32 v111, v0, v111
    v_accvgpr_write_b32 a48, v100
    v_accvgpr_write_b32 a49, v101
    v_accvgpr_write_b32 a50, v102
    v_accvgpr_write_b32 a51, v103
    v_accvgpr_write_b32 a60, v108
    v_accvgpr_write_b32 a61, v109
    v_accvgpr_write_b32 a62, v110
    v_accvgpr_write_b32 a63, v111
    v_accvgpr_read_b32 v100, a72
    v_accvgpr_read_b32 v101, a73
    v_accvgpr_read_b32 v102, a74
    v_accvgpr_read_b32 v103, a75
    v_accvgpr_read_b32 v108, a84
    v_accvgpr_read_b32 v109, a85
    v_accvgpr_read_b32 v110, a86
    v_accvgpr_read_b32 v111, a87
    v_mul_f32 v100, v0, v100
    v_mul_f32 v101, v0, v101
    v_mul_f32 v102, v0, v102
    v_mul_f32 v103, v0, v103
    v_mul_f32 v108, v0, v108
    v_mul_f32 v109, v0, v109
    v_mul_f32 v110, v0, v110
    v_mul_f32 v111, v0, v111
    v_accvgpr_write_b32 a72, v100
    v_accvgpr_write_b32 a73, v101
    v_accvgpr_write_b32 a74, v102
    v_accvgpr_write_b32 a75, v103
    v_accvgpr_write_b32 a84, v108
    v_accvgpr_write_b32 a85, v109
    v_accvgpr_write_b32 a86, v110
    v_accvgpr_write_b32 a87, v111
    v_accvgpr_read_b32 v100, a96
    v_accvgpr_read_b32 v101, a97
    v_accvgpr_read_b32 v102, a98
    v_accvgpr_read_b32 v103, a99
    v_accvgpr_read_b32 v108, a108
    v_accvgpr_read_b32 v109, a109
    v_accvgpr_read_b32 v110, a110
    v_accvgpr_read_b32 v111, a111
    v_mul_f32 v100, v0, v100
    v_mul_f32 v101, v0, v101
    v_mul_f32 v102, v0, v102
    v_mul_f32 v103, v0, v103
    v_mul_f32 v108, v0, v108
    v_mul_f32 v109, v0, v109
    v_mul_f32 v110, v0, v110
    v_mul_f32 v111, v0, v111
    v_accvgpr_write_b32 a96, v100
    v_accvgpr_write_b32 a97, v101
    v_accvgpr_write_b32 a98, v102
    v_accvgpr_write_b32 a99, v103
    v_accvgpr_write_b32 a108, v108
    v_accvgpr_write_b32 a109, v109
    v_accvgpr_write_b32 a110, v110
    v_accvgpr_write_b32 a111, v111
    v_accvgpr_read_b32 v100, a120
    v_accvgpr_read_b32 v101, a121
    v_accvgpr_read_b32 v102, a122
    v_accvgpr_read_b32 v103, a123
    v_accvgpr_read_b32 v108, a132
    v_accvgpr_read_b32 v109, a133
    v_accvgpr_read_b32 v110, a134
    v_accvgpr_read_b32 v111, a135
    v_mul_f32 v100, v0, v100
    v_mul_f32 v101, v0, v101
    v_mul_f32 v102, v0, v102
    v_mul_f32 v103, v0, v103
    v_mul_f32 v108, v0, v108
    v_mul_f32 v109, v0, v109
    v_mul_f32 v110, v0, v110
    v_mul_f32 v111, v0, v111
    v_accvgpr_write_b32 a120, v100
    v_accvgpr_write_b32 a121, v101
    v_accvgpr_write_b32 a122, v102
    v_accvgpr_write_b32 a123, v103
    v_accvgpr_write_b32 a132, v108
    v_accvgpr_write_b32 a133, v109
    v_accvgpr_write_b32 a134, v110
    v_accvgpr_write_b32 a135, v111
    v_accvgpr_read_b32 v100, a144
    v_accvgpr_read_b32 v101, a145
    v_accvgpr_read_b32 v102, a146
    v_accvgpr_read_b32 v103, a147
    v_accvgpr_read_b32 v108, a156
    v_accvgpr_read_b32 v109, a157
    v_accvgpr_read_b32 v110, a158
    v_accvgpr_read_b32 v111, a159
    v_mul_f32 v100, v0, v100
    v_mul_f32 v101, v0, v101
    v_mul_f32 v102, v0, v102
    v_mul_f32 v103, v0, v103
    v_mul_f32 v108, v0, v108
    v_mul_f32 v109, v0, v109
    v_mul_f32 v110, v0, v110
    v_mul_f32 v111, v0, v111
    v_accvgpr_write_b32 a144, v100
    v_accvgpr_write_b32 a145, v101
    v_accvgpr_write_b32 a146, v102
    v_accvgpr_write_b32 a147, v103
    v_accvgpr_write_b32 a156, v108
    v_accvgpr_write_b32 a157, v109
    v_accvgpr_write_b32 a158, v110
    v_accvgpr_write_b32 a159, v111
    v_accvgpr_read_b32 v100, a168
    v_accvgpr_read_b32 v101, a169
    v_accvgpr_read_b32 v102, a170
    v_accvgpr_read_b32 v103, a171
    v_accvgpr_read_b32 v108, a180
    v_accvgpr_read_b32 v109, a181
    v_accvgpr_read_b32 v110, a182
    v_accvgpr_read_b32 v111, a183
    v_mul_f32 v100, v0, v100
    v_mul_f32 v101, v0, v101
    v_mul_f32 v102, v0, v102
    v_mul_f32 v103, v0, v103
    v_mul_f32 v108, v0, v108
    v_mul_f32 v109, v0, v109
    v_mul_f32 v110, v0, v110
    v_mul_f32 v111, v0, v111
    v_accvgpr_write_b32 a168, v100
    v_accvgpr_write_b32 a169, v101
    v_accvgpr_write_b32 a170, v102
    v_accvgpr_write_b32 a171, v103
    v_accvgpr_write_b32 a180, v108
    v_accvgpr_write_b32 a181, v109
    v_accvgpr_write_b32 a182, v110
    v_accvgpr_write_b32 a183, v111
    v_sub_f32 v84, v84, v61
    v_sub_f32 v85, v85, v61
    v_sub_f32 v86, v86, v61
    v_sub_f32 v87, v87, v61
    v_sub_f32 v92, v92, v61
    v_sub_f32 v93, v93, v61
    v_sub_f32 v94, v94, v61
    v_sub_f32 v95, v95, v61
    v_exp_f32 v100, v84
    v_exp_f32 v101, v85
    v_exp_f32 v102, v86
    v_exp_f32 v103, v87
    v_exp_f32 v108, v92
    v_exp_f32 v109, v93
    v_exp_f32 v110, v94
    v_exp_f32 v111, v95
    v_add_f32 v61, v100, v101
    v_add_f32 v61, v61, v102
    v_add_f32 v61, v61, v103
    v_add_f32 v61, v61, v108
    v_add_f32 v61, v61, v109
    v_add_f32 v61, v61, v110
    v_add_f32 v61, v61, v111
    v_max3_f32 v62, v148, v149, 0
    v_max3_f32 v62, v62, v150, v151
    v_max3_f32 v62, v62, v156, v157
    v_max3_f32 v62, v62, v158, v159
    v_mov_b32 v0, v62
    s_nop 1
    v_permlane32_swap_b32 v62, v0
    v_max_f32 v62, v62, v0
    v_mov_b32 v0, v62
    s_nop 1
    v_permlane16_swap_b32 v62, v0
    v_max_f32 v62, v62, v0
    v_exp_f32 v0, -v62
    v_sub_f32 v188, v188, v62
    v_sub_f32 v189, v189, v62
    v_sub_f32 v190, v190, v62
    v_sub_f32 v191, v191, v62
    v_mul_f32 v59, v59, v0
    v_accvgpr_read_b32 v164, a4
    v_accvgpr_read_b32 v165, a5
    v_accvgpr_read_b32 v166, a6
    v_accvgpr_read_b32 v167, a7
    v_accvgpr_read_b32 v172, a16
    v_accvgpr_read_b32 v173, a17
    v_accvgpr_read_b32 v174, a18
    v_accvgpr_read_b32 v175, a19
    v_mul_f32 v164, v0, v164
    v_mul_f32 v165, v0, v165
    v_mul_f32 v166, v0, v166
    v_mul_f32 v167, v0, v167
    v_mul_f32 v172, v0, v172
    v_mul_f32 v173, v0, v173
    v_mul_f32 v174, v0, v174
    v_mul_f32 v175, v0, v175
    v_accvgpr_write_b32 a4, v164
    v_accvgpr_write_b32 a5, v165
    v_accvgpr_write_b32 a6, v166
    v_accvgpr_write_b32 a7, v167
    v_accvgpr_write_b32 a16, v172
    v_accvgpr_write_b32 a17, v173
    v_accvgpr_write_b32 a18, v174
    v_accvgpr_write_b32 a19, v175
    v_accvgpr_read_b32 v164, a28
    v_accvgpr_read_b32 v165, a29
    v_accvgpr_read_b32 v166, a30
    v_accvgpr_read_b32 v167, a31
    v_accvgpr_read_b32 v172, a40
    v_accvgpr_read_b32 v173, a41
    v_accvgpr_read_b32 v174, a42
    v_accvgpr_read_b32 v175, a43
    v_mul_f32 v164, v0, v164
    v_mul_f32 v165, v0, v165
    v_mul_f32 v166, v0, v166
    v_mul_f32 v167, v0, v167
    v_mul_f32 v172, v0, v172
    v_mul_f32 v173, v0, v173
    v_mul_f32 v174, v0, v174
    v_mul_f32 v175, v0, v175
    v_accvgpr_write_b32 a28, v164
    v_accvgpr_write_b32 a29, v165
    v_accvgpr_write_b32 a30, v166
    v_accvgpr_write_b32 a31, v167
    v_accvgpr_write_b32 a40, v172
    v_accvgpr_write_b32 a41, v173
    v_accvgpr_write_b32 a42, v174
    v_accvgpr_write_b32 a43, v175
    v_accvgpr_read_b32 v164, a52
    v_accvgpr_read_b32 v165, a53
    v_accvgpr_read_b32 v166, a54
    v_accvgpr_read_b32 v167, a55
    v_accvgpr_read_b32 v172, a64
    v_accvgpr_read_b32 v173, a65
    v_accvgpr_read_b32 v174, a66
    v_accvgpr_read_b32 v175, a67
    v_mul_f32 v164, v0, v164
    v_mul_f32 v165, v0, v165
    v_mul_f32 v166, v0, v166
    v_mul_f32 v167, v0, v167
    v_mul_f32 v172, v0, v172
    v_mul_f32 v173, v0, v173
    v_mul_f32 v174, v0, v174
    v_mul_f32 v175, v0, v175
    v_accvgpr_write_b32 a52, v164
    v_accvgpr_write_b32 a53, v165
    v_accvgpr_write_b32 a54, v166
    v_accvgpr_write_b32 a55, v167
    v_accvgpr_write_b32 a64, v172
    v_accvgpr_write_b32 a65, v173
    v_accvgpr_write_b32 a66, v174
    v_accvgpr_write_b32 a67, v175
    v_accvgpr_read_b32 v164, a76
    v_accvgpr_read_b32 v165, a77
    v_accvgpr_read_b32 v166, a78
    v_accvgpr_read_b32 v167, a79
    v_accvgpr_read_b32 v172, a88
    v_accvgpr_read_b32 v173, a89
    v_accvgpr_read_b32 v174, a90
    v_accvgpr_read_b32 v175, a91
    v_mul_f32 v164, v0, v164
    v_mul_f32 v165, v0, v165
    v_mul_f32 v166, v0, v166
    v_mul_f32 v167, v0, v167
    v_mul_f32 v172, v0, v172
    v_mul_f32 v173, v0, v173
    v_mul_f32 v174, v0, v174
    v_mul_f32 v175, v0, v175
    v_accvgpr_write_b32 a76, v164
    v_accvgpr_write_b32 a77, v165
    v_accvgpr_write_b32 a78, v166
    v_accvgpr_write_b32 a79, v167
    v_accvgpr_write_b32 a88, v172
    v_accvgpr_write_b32 a89, v173
    v_accvgpr_write_b32 a90, v174
    v_accvgpr_write_b32 a91, v175
    v_accvgpr_read_b32 v164, a100
    v_accvgpr_read_b32 v165, a101
    v_accvgpr_read_b32 v166, a102
    v_accvgpr_read_b32 v167, a103
    v_accvgpr_read_b32 v172, a112
    v_accvgpr_read_b32 v173, a113
    v_accvgpr_read_b32 v174, a114
    v_accvgpr_read_b32 v175, a115
    v_mul_f32 v164, v0, v164
    v_mul_f32 v165, v0, v165
    v_mul_f32 v166, v0, v166
    v_mul_f32 v167, v0, v167
    v_mul_f32 v172, v0, v172
    v_mul_f32 v173, v0, v173
    v_mul_f32 v174, v0, v174
    v_mul_f32 v175, v0, v175
    v_accvgpr_write_b32 a100, v164
    v_accvgpr_write_b32 a101, v165
    v_accvgpr_write_b32 a102, v166
    v_accvgpr_write_b32 a103, v167
    v_accvgpr_write_b32 a112, v172
    v_accvgpr_write_b32 a113, v173
    v_accvgpr_write_b32 a114, v174
    v_accvgpr_write_b32 a115, v175
    v_accvgpr_read_b32 v164, a124
    v_accvgpr_read_b32 v165, a125
    v_accvgpr_read_b32 v166, a126
    v_accvgpr_read_b32 v167, a127
    v_accvgpr_read_b32 v172, a136
    v_accvgpr_read_b32 v173, a137
    v_accvgpr_read_b32 v174, a138
    v_accvgpr_read_b32 v175, a139
    v_mul_f32 v164, v0, v164
    v_mul_f32 v165, v0, v165
    v_mul_f32 v166, v0, v166
    v_mul_f32 v167, v0, v167
    v_mul_f32 v172, v0, v172
    v_mul_f32 v173, v0, v173
    v_mul_f32 v174, v0, v174
    v_mul_f32 v175, v0, v175
    v_accvgpr_write_b32 a124, v164
    v_accvgpr_write_b32 a125, v165
    v_accvgpr_write_b32 a126, v166
    v_accvgpr_write_b32 a127, v167
    v_accvgpr_write_b32 a136, v172
    v_accvgpr_write_b32 a137, v173
    v_accvgpr_write_b32 a138, v174
    v_accvgpr_write_b32 a139, v175
    v_accvgpr_read_b32 v164, a148
    v_accvgpr_read_b32 v165, a149
    v_accvgpr_read_b32 v166, a150
    v_accvgpr_read_b32 v167, a151
    v_accvgpr_read_b32 v172, a160
    v_accvgpr_read_b32 v173, a161
    v_accvgpr_read_b32 v174, a162
    v_accvgpr_read_b32 v175, a163
    v_mul_f32 v164, v0, v164
    v_mul_f32 v165, v0, v165
    v_mul_f32 v166, v0, v166
    v_mul_f32 v167, v0, v167
    v_mul_f32 v172, v0, v172
    v_mul_f32 v173, v0, v173
    v_mul_f32 v174, v0, v174
    v_mul_f32 v175, v0, v175
    v_accvgpr_write_b32 a148, v164
    v_accvgpr_write_b32 a149, v165
    v_accvgpr_write_b32 a150, v166
    v_accvgpr_write_b32 a151, v167
    v_accvgpr_write_b32 a160, v172
    v_accvgpr_write_b32 a161, v173
    v_accvgpr_write_b32 a162, v174
    v_accvgpr_write_b32 a163, v175
    v_accvgpr_read_b32 v164, a172
    v_accvgpr_read_b32 v165, a173
    v_accvgpr_read_b32 v166, a174
    v_accvgpr_read_b32 v167, a175
    v_accvgpr_read_b32 v172, a184
    v_accvgpr_read_b32 v173, a185
    v_accvgpr_read_b32 v174, a186
    v_accvgpr_read_b32 v175, a187
    v_mul_f32 v164, v0, v164
    v_mul_f32 v165, v0, v165
    v_mul_f32 v166, v0, v166
    v_mul_f32 v167, v0, v167
    v_mul_f32 v172, v0, v172
    v_mul_f32 v173, v0, v173
    v_mul_f32 v174, v0, v174
    v_mul_f32 v175, v0, v175
    v_accvgpr_write_b32 a172, v164
    v_accvgpr_write_b32 a173, v165
    v_accvgpr_write_b32 a174, v166
    v_accvgpr_write_b32 a175, v167
    v_accvgpr_write_b32 a184, v172
    v_accvgpr_write_b32 a185, v173
    v_accvgpr_write_b32 a186, v174
    v_accvgpr_write_b32 a187, v175
    v_sub_f32 v148, v148, v62
    v_sub_f32 v149, v149, v62
    v_sub_f32 v150, v150, v62
    v_sub_f32 v151, v151, v62
    v_sub_f32 v156, v156, v62
    v_sub_f32 v157, v157, v62
    v_sub_f32 v158, v158, v62
    v_sub_f32 v159, v159, v62
    v_exp_f32 v164, v148
    v_exp_f32 v165, v149
    v_exp_f32 v166, v150
    v_exp_f32 v167, v151
    v_exp_f32 v172, v156
    v_exp_f32 v173, v157
    v_exp_f32 v174, v158
    v_exp_f32 v175, v159
    v_add_f32 v62, v164, v165
    v_add_f32 v62, v62, v166
    v_add_f32 v62, v62, v167
    v_add_f32 v62, v62, v172
    v_add_f32 v62, v62, v173
    v_add_f32 v62, v62, v174
    v_add_f32 v62, v62, v175
    v_max3_f32 v63, v212, v213, 0
    v_max3_f32 v63, v63, v214, v215
    v_max3_f32 v63, v63, v220, v221
    v_max3_f32 v63, v63, v222, v223
    v_mov_b32 v0, v63
    s_nop 1
    v_permlane32_swap_b32 v63, v0
    v_max_f32 v63, v63, v0
    v_mov_b32 v0, v63
    s_nop 1
    v_permlane16_swap_b32 v63, v0
    v_max_f32 v63, v63, v0
    v_exp_f32 v0, -v63
    v_sub_f32 v252, v252, v63
    v_sub_f32 v253, v253, v63
    v_sub_f32 v254, v254, v63
    v_sub_f32 v255, v255, v63
    v_mul_f32 v60, v60, v0
    v_accvgpr_read_b32 v228, a8
    v_accvgpr_read_b32 v229, a9
    v_accvgpr_read_b32 v230, a10
    v_accvgpr_read_b32 v231, a11
    v_accvgpr_read_b32 v236, a20
    v_accvgpr_read_b32 v237, a21
    v_accvgpr_read_b32 v238, a22
    v_accvgpr_read_b32 v239, a23
    v_mul_f32 v228, v0, v228
    v_mul_f32 v229, v0, v229
    v_mul_f32 v230, v0, v230
    v_mul_f32 v231, v0, v231
    v_mul_f32 v236, v0, v236
    v_mul_f32 v237, v0, v237
    v_mul_f32 v238, v0, v238
    v_mul_f32 v239, v0, v239
    v_accvgpr_write_b32 a8, v228
    v_accvgpr_write_b32 a9, v229
    v_accvgpr_write_b32 a10, v230
    v_accvgpr_write_b32 a11, v231
    v_accvgpr_write_b32 a20, v236
    v_accvgpr_write_b32 a21, v237
    v_accvgpr_write_b32 a22, v238
    v_accvgpr_write_b32 a23, v239
    v_accvgpr_read_b32 v228, a32
    v_accvgpr_read_b32 v229, a33
    v_accvgpr_read_b32 v230, a34
    v_accvgpr_read_b32 v231, a35
    v_accvgpr_read_b32 v236, a44
    v_accvgpr_read_b32 v237, a45
    v_accvgpr_read_b32 v238, a46
    v_accvgpr_read_b32 v239, a47
    v_mul_f32 v228, v0, v228
    v_mul_f32 v229, v0, v229
    v_mul_f32 v230, v0, v230
    v_mul_f32 v231, v0, v231
    v_mul_f32 v236, v0, v236
    v_mul_f32 v237, v0, v237
    v_mul_f32 v238, v0, v238
    v_mul_f32 v239, v0, v239
    v_accvgpr_write_b32 a32, v228
    v_accvgpr_write_b32 a33, v229
    v_accvgpr_write_b32 a34, v230
    v_accvgpr_write_b32 a35, v231
    v_accvgpr_write_b32 a44, v236
    v_accvgpr_write_b32 a45, v237
    v_accvgpr_write_b32 a46, v238
    v_accvgpr_write_b32 a47, v239
    v_accvgpr_read_b32 v228, a56
    v_accvgpr_read_b32 v229, a57
    v_accvgpr_read_b32 v230, a58
    v_accvgpr_read_b32 v231, a59
    v_accvgpr_read_b32 v236, a68
    v_accvgpr_read_b32 v237, a69
    v_accvgpr_read_b32 v238, a70
    v_accvgpr_read_b32 v239, a71
    v_mul_f32 v228, v0, v228
    v_mul_f32 v229, v0, v229
    v_mul_f32 v230, v0, v230
    v_mul_f32 v231, v0, v231
    v_mul_f32 v236, v0, v236
    v_mul_f32 v237, v0, v237
    v_mul_f32 v238, v0, v238
    v_mul_f32 v239, v0, v239
    v_accvgpr_write_b32 a56, v228
    v_accvgpr_write_b32 a57, v229
    v_accvgpr_write_b32 a58, v230
    v_accvgpr_write_b32 a59, v231
    v_accvgpr_write_b32 a68, v236
    v_accvgpr_write_b32 a69, v237
    v_accvgpr_write_b32 a70, v238
    v_accvgpr_write_b32 a71, v239
    v_accvgpr_read_b32 v228, a80
    v_accvgpr_read_b32 v229, a81
    v_accvgpr_read_b32 v230, a82
    v_accvgpr_read_b32 v231, a83
    v_accvgpr_read_b32 v236, a92
    v_accvgpr_read_b32 v237, a93
    v_accvgpr_read_b32 v238, a94
    v_accvgpr_read_b32 v239, a95
    v_mul_f32 v228, v0, v228
    v_mul_f32 v229, v0, v229
    v_mul_f32 v230, v0, v230
    v_mul_f32 v231, v0, v231
    v_mul_f32 v236, v0, v236
    v_mul_f32 v237, v0, v237
    v_mul_f32 v238, v0, v238
    v_mul_f32 v239, v0, v239
    v_accvgpr_write_b32 a80, v228
    v_accvgpr_write_b32 a81, v229
    v_accvgpr_write_b32 a82, v230
    v_accvgpr_write_b32 a83, v231
    v_accvgpr_write_b32 a92, v236
    v_accvgpr_write_b32 a93, v237
    v_accvgpr_write_b32 a94, v238
    v_accvgpr_write_b32 a95, v239
    v_accvgpr_read_b32 v228, a104
    v_accvgpr_read_b32 v229, a105
    v_accvgpr_read_b32 v230, a106
    v_accvgpr_read_b32 v231, a107
    v_accvgpr_read_b32 v236, a116
    v_accvgpr_read_b32 v237, a117
    v_accvgpr_read_b32 v238, a118
    v_accvgpr_read_b32 v239, a119
    v_mul_f32 v228, v0, v228
    v_mul_f32 v229, v0, v229
    v_mul_f32 v230, v0, v230
    v_mul_f32 v231, v0, v231
    v_mul_f32 v236, v0, v236
    v_mul_f32 v237, v0, v237
    v_mul_f32 v238, v0, v238
    v_mul_f32 v239, v0, v239
    v_accvgpr_write_b32 a104, v228
    v_accvgpr_write_b32 a105, v229
    v_accvgpr_write_b32 a106, v230
    v_accvgpr_write_b32 a107, v231
    v_accvgpr_write_b32 a116, v236
    v_accvgpr_write_b32 a117, v237
    v_accvgpr_write_b32 a118, v238
    v_accvgpr_write_b32 a119, v239
    v_accvgpr_read_b32 v228, a128
    v_accvgpr_read_b32 v229, a129
    v_accvgpr_read_b32 v230, a130
    v_accvgpr_read_b32 v231, a131
    v_accvgpr_read_b32 v236, a140
    v_accvgpr_read_b32 v237, a141
    v_accvgpr_read_b32 v238, a142
    v_accvgpr_read_b32 v239, a143
    v_mul_f32 v228, v0, v228
    v_mul_f32 v229, v0, v229
    v_mul_f32 v230, v0, v230
    v_mul_f32 v231, v0, v231
    v_mul_f32 v236, v0, v236
    v_mul_f32 v237, v0, v237
    v_mul_f32 v238, v0, v238
    v_mul_f32 v239, v0, v239
    v_accvgpr_write_b32 a128, v228
    v_accvgpr_write_b32 a129, v229
    v_accvgpr_write_b32 a130, v230
    v_accvgpr_write_b32 a131, v231
    v_accvgpr_write_b32 a140, v236
    v_accvgpr_write_b32 a141, v237
    v_accvgpr_write_b32 a142, v238
    v_accvgpr_write_b32 a143, v239
    v_accvgpr_read_b32 v228, a152
    v_accvgpr_read_b32 v229, a153
    v_accvgpr_read_b32 v230, a154
    v_accvgpr_read_b32 v231, a155
    v_accvgpr_read_b32 v236, a164
    v_accvgpr_read_b32 v237, a165
    v_accvgpr_read_b32 v238, a166
    v_accvgpr_read_b32 v239, a167
    v_mul_f32 v228, v0, v228
    v_mul_f32 v229, v0, v229
    v_mul_f32 v230, v0, v230
    v_mul_f32 v231, v0, v231
    v_mul_f32 v236, v0, v236
    v_mul_f32 v237, v0, v237
    v_mul_f32 v238, v0, v238
    v_mul_f32 v239, v0, v239
    v_accvgpr_write_b32 a152, v228
    v_accvgpr_write_b32 a153, v229
    v_accvgpr_write_b32 a154, v230
    v_accvgpr_write_b32 a155, v231
    v_accvgpr_write_b32 a164, v236
    v_accvgpr_write_b32 a165, v237
    v_accvgpr_write_b32 a166, v238
    v_accvgpr_write_b32 a167, v239
    v_accvgpr_read_b32 v228, a176
    v_accvgpr_read_b32 v229, a177
    v_accvgpr_read_b32 v230, a178
    v_accvgpr_read_b32 v231, a179
    v_accvgpr_read_b32 v236, a188
    v_accvgpr_read_b32 v237, a189
    v_accvgpr_read_b32 v238, a190
    v_accvgpr_read_b32 v239, a191
    v_mul_f32 v228, v0, v228
    v_mul_f32 v229, v0, v229
    v_mul_f32 v230, v0, v230
    v_mul_f32 v231, v0, v231
    v_mul_f32 v236, v0, v236
    v_mul_f32 v237, v0, v237
    v_mul_f32 v238, v0, v238
    v_mul_f32 v239, v0, v239
    v_accvgpr_write_b32 a176, v228
    v_accvgpr_write_b32 a177, v229
    v_accvgpr_write_b32 a178, v230
    v_accvgpr_write_b32 a179, v231
    v_accvgpr_write_b32 a188, v236
    v_accvgpr_write_b32 a189, v237
    v_accvgpr_write_b32 a190, v238
    v_accvgpr_write_b32 a191, v239
    v_sub_f32 v212, v212, v63
    v_sub_f32 v213, v213, v63
    v_sub_f32 v214, v214, v63
    v_sub_f32 v215, v215, v63
    v_sub_f32 v220, v220, v63
    v_sub_f32 v221, v221, v63
    v_sub_f32 v222, v222, v63
    v_sub_f32 v223, v223, v63
    v_exp_f32 v228, v212
    v_exp_f32 v229, v213
    v_exp_f32 v230, v214
    v_exp_f32 v231, v215
    v_exp_f32 v236, v220
    v_exp_f32 v237, v221
    v_exp_f32 v238, v222
    v_exp_f32 v239, v223
    v_add_f32 v63, v228, v229
    v_add_f32 v63, v63, v230
    v_add_f32 v63, v63, v231
    v_add_f32 v63, v63, v236
    v_add_f32 v63, v63, v237
    v_add_f32 v63, v63, v238
    v_add_f32 v63, v63, v239
    s_nop 3
    s_setpc_b64 s[30:31]
.section .rodata,"a"
.p2align 6
.amdhsa_kernel concat_heads__mha_block_cached__gqa_block_cached__near_ridge_kernel
  .amdhsa_next_free_vgpr 512
  .amdhsa_next_free_sgpr 102
  .amdhsa_accum_offset 256
  .amdhsa_group_segment_fixed_size 0
  .amdhsa_kernarg_size 104
  .amdhsa_user_sgpr_count 2
  .amdhsa_user_sgpr_kernarg_segment_ptr 1
  .amdhsa_system_sgpr_workgroup_id_x 1
  .amdhsa_float_denorm_mode_32 3
.end_amdhsa_kernel
```
